```python
import torch

def _softmax(x, axis=-1):
    return torch.softmax(x, dim=axis)
def _gelu(x):
    return torch.nn.functional.gelu(x, approximate="tanh")
def _silu(x):
    return torch.nn.functional.silu(x)
def _sigmoid(x):
    return torch.sigmoid(x)
def _layernorm(x, axis=-1, eps=1e-5):
    m = x.mean(dim=axis, keepdim=True)
    v = x.var(dim=axis, keepdim=True, unbiased=False)
    return (x - m) / torch.sqrt(v + eps)
def _scatter_add(tgt, idx, src, axis=0):
    return tgt.clone().index_add_(axis, idx, src)
def _segment_sum(src, seg, n):
    out = torch.zeros((n,) + src.shape[1:], dtype=src.dtype)
    return out.index_add_(0, seg, src)
def _pad(x, pw):
    flat = tuple(v for pair in reversed(pw) for v in pair)
    return torch.nn.functional.pad(x, flat)

kernel_name = 'sequential_preLN__spectral_gfnet__dense_activation_mish__prompt'

def setup_inputs():

    _w = (lambda a: (lambda t: t.to(torch.bfloat16) if t.is_floating_point() else t)(torch.as_tensor(a)))
    def _A_setup():
        B, S, D = 1, 2048, 1024
        Df = D // 2 + 1
        return {
            "x": _w((lambda *s: torch.randn(*s, dtype=torch.bfloat16) * 0.05)(B, S, D)),
            "w_r": _w((lambda *s: torch.randn(*s, dtype=torch.bfloat16) * 0.4)(S, Df) * 0.02),
            "w_i": _w((lambda *s: torch.randn(*s, dtype=torch.bfloat16) * 0.4)(S, Df) * 0.02),
        }
    _A_in = _A_setup()

    def _B_setup():
        B, S, D, F = 1, 2048, 1024, 3584
        return {
            "x": _w((lambda *s: torch.randn(*s, dtype=torch.bfloat16) * 0.05)(B, S, D)),
            "w1": _w((lambda *s: torch.randn(*s, dtype=torch.bfloat16) * 0.8)(D, F) * (D ** -0.5)),
            "b1": _w((lambda *s: torch.randn(*s, dtype=torch.bfloat16) * 0.2)(F)),
            "w2": _w((lambda *s: torch.randn(*s, dtype=torch.bfloat16) * 0.1)(F, D) * (F ** -0.5)),
        }
    _B_in = _B_setup()

    return {
        "A_x": _A_in["x"],
        "A_w_r": _A_in["w_r"],
        "A_w_i": _A_in["w_i"],
        "B_x": _B_in["x"],
        "B_w1": _B_in["w1"],
        "B_b1": _B_in["b1"],
        "B_w2": _B_in["w2"],
    }

def reference(A_x, A_w_r, A_w_i, B_x, B_w1, B_b1, B_w2):
    def _A_ref(x, w_r, w_i):
        B, S, D = x.shape
        X = (lambda x, axes=(-2,-1): torch.fft.rfft2(x.float(), dim=axes))(x, axes=(-2, -1))
        W = w_r + 1j * w_i
        X = X * W
        y = (lambda x, s, axes=(-2,-1): torch.fft.irfft2(x, s=s, dim=axes).to(torch.bfloat16))(X, (S, D), axes=(-2, -1))
        return y

    def _B_ref(x, w1, b1, w2):
        h = torch.einsum("bsd,df->bsf", x, w1) + b1
        sp = torch.log1p(torch.exp(-torch.abs(h))) + torch.where(h > 0, h, torch.zeros_like(h))
        act = h * torch.tanh(sp)
        return torch.einsum("bsf,fd->bsd", act, w2)

    x = A_x
    h = x + _A_ref(_layernorm(x, axis=-1), A_w_r, A_w_i)
    h2 = h + _B_ref(_layernorm(h, axis=-1), B_w1, B_b1, B_w2)
    return h2
```

```asm
; @launch kernel=fft_a_kernel grid=(512,1,1) block=(256,1,1) lds=35072
; @launch kernel=fft_b_kernel grid=(513,1,1) block=(256,1,1) lds=18432
; @launch kernel=fft_c_kernel grid=(256,1,1) block=(256,1,1) lds=35072
; @launch kernel=gemm1_kernel grid=(256,1,1) block=(512,1,1) lds=147456
; @launch kernel=gemm2_kernel grid=(256,1,1) block=(512,1,1) lds=147456
.amdgcn_target "amdgcn-amd-amdhsa--gfx950"
.text
.globl fft_a_kernel
.p2align 8
.type fft_a_kernel,@function
fft_a_kernel:
    s_load_dwordx2 s[4:5], s[0:1], 0
    s_load_dwordx2 s[6:7], s[0:1], 72
    s_load_dwordx4 s[64:67], s[0:1], 8
    s_cmp_ge_u32 s2, 512
    s_cbranch_scc1 fa_end
    s_waitcnt lgkmcnt(0)
    s_mov_b32 s8, s4
    s_and_b32 s9, s5, 0xffff
    s_mov_b32 s10, 4194304
    s_mov_b32 s11, 0x00020000
    s_mov_b32 s12, s6
    s_and_b32 s13, s7, 0xffff
    s_mov_b32 s14, 8404992
    s_mov_b32 s15, 0x00020000
    s_mov_b32 s24, s64
    s_and_b32 s25, s65, 0xffff
    s_mov_b32 s26, 2101248
    s_mov_b32 s27, 0x00020000
    s_mov_b32 s28, s66
    s_and_b32 s29, s67, 0xffff
    s_mov_b32 s30, 2101248
    s_mov_b32 s31, 0x00020000
    s_add_u32 s32, s6, 50331648
    s_addc_u32 s33, s7, 0
    s_and_b32 s33, s33, 0xffff
    s_mov_b32 s34, 8404992
    s_mov_b32 s35, 0x00020000
    s_add_u32 s36, s6, 62914560
    s_addc_u32 s37, s7, 0
    s_and_b32 s37, s37, 0xffff
    s_mov_b32 s38, 131072
    s_mov_b32 s39, 0x00020000
    s_cmp_ge_u32 s2, 256
    s_cbranch_scc1 fa_aux
    s_mov_b32 s40, 0x3f6c835e
    s_mov_b32 s41, 0xbec3ef15
    s_mov_b32 s42, 0x3f3504f3
    s_mov_b32 s43, 0xbf3504f3
    s_mov_b32 s44, 0x3ec3ef15
    s_mov_b32 s45, 0xbf6c835e
    s_mov_b32 s46, 0x00000000
    s_mov_b32 s47, 0xbf800000
    s_mov_b32 s48, 0xbf3504f3
    s_mov_b32 s49, 0xbf3504f3
    s_mov_b32 s50, 0xbf6c835e
    s_mov_b32 s51, 0x3ec3ef15
    v_and_b32 v1, 63, v0
    v_lshrrev_b32 v2, 6, v0
    s_lshl_b32 s16, s2, 3
    v_lshl_add_u32 v3, v2, 1, s16
    v_lshlrev_b32 v3, 11, v3
    v_lshl_add_u32 v3, v1, 1, v3
    buffer_load_ushort v16, v3, s[8:11], 0 offen offset:0
    buffer_load_ushort v17, v3, s[8:11], 0 offen offset:2048
    buffer_load_ushort v18, v3, s[8:11], 0 offen offset:128
    buffer_load_ushort v19, v3, s[8:11], 0 offen offset:2176
    buffer_load_ushort v20, v3, s[8:11], 0 offen offset:256
    buffer_load_ushort v21, v3, s[8:11], 0 offen offset:2304
    buffer_load_ushort v22, v3, s[8:11], 0 offen offset:384
    buffer_load_ushort v23, v3, s[8:11], 0 offen offset:2432
    buffer_load_ushort v24, v3, s[8:11], 0 offen offset:512
    buffer_load_ushort v25, v3, s[8:11], 0 offen offset:2560
    buffer_load_ushort v26, v3, s[8:11], 0 offen offset:640
    buffer_load_ushort v27, v3, s[8:11], 0 offen offset:2688
    buffer_load_ushort v28, v3, s[8:11], 0 offen offset:768
    buffer_load_ushort v29, v3, s[8:11], 0 offen offset:2816
    buffer_load_ushort v30, v3, s[8:11], 0 offen offset:896
    buffer_load_ushort v31, v3, s[8:11], 0 offen offset:2944
    buffer_load_ushort v32, v3, s[8:11], 0 offen offset:1024
    buffer_load_ushort v33, v3, s[8:11], 0 offen offset:3072
    buffer_load_ushort v34, v3, s[8:11], 0 offen offset:1152
    buffer_load_ushort v35, v3, s[8:11], 0 offen offset:3200
    buffer_load_ushort v36, v3, s[8:11], 0 offen offset:1280
    buffer_load_ushort v37, v3, s[8:11], 0 offen offset:3328
    buffer_load_ushort v38, v3, s[8:11], 0 offen offset:1408
    buffer_load_ushort v39, v3, s[8:11], 0 offen offset:3456
    buffer_load_ushort v40, v3, s[8:11], 0 offen offset:1536
    buffer_load_ushort v41, v3, s[8:11], 0 offen offset:3584
    buffer_load_ushort v42, v3, s[8:11], 0 offen offset:1664
    buffer_load_ushort v43, v3, s[8:11], 0 offen offset:3712
    buffer_load_ushort v44, v3, s[8:11], 0 offen offset:1792
    buffer_load_ushort v45, v3, s[8:11], 0 offen offset:3840
    buffer_load_ushort v46, v3, s[8:11], 0 offen offset:1920
    buffer_load_ushort v47, v3, s[8:11], 0 offen offset:3968
    s_waitcnt vmcnt(0)
    v_mul_u32_u24 v4, 8768, v2
    v_lshlrev_b32 v16, 16, v16
    v_lshlrev_b32 v17, 16, v17
    v_lshlrev_b32 v18, 16, v18
    v_lshlrev_b32 v19, 16, v19
    v_lshlrev_b32 v20, 16, v20
    v_lshlrev_b32 v21, 16, v21
    v_lshlrev_b32 v22, 16, v22
    v_lshlrev_b32 v23, 16, v23
    v_lshlrev_b32 v24, 16, v24
    v_lshlrev_b32 v25, 16, v25
    v_lshlrev_b32 v26, 16, v26
    v_lshlrev_b32 v27, 16, v27
    v_lshlrev_b32 v28, 16, v28
    v_lshlrev_b32 v29, 16, v29
    v_lshlrev_b32 v30, 16, v30
    v_lshlrev_b32 v31, 16, v31
    v_lshlrev_b32 v32, 16, v32
    v_lshlrev_b32 v33, 16, v33
    v_lshlrev_b32 v34, 16, v34
    v_lshlrev_b32 v35, 16, v35
    v_lshlrev_b32 v36, 16, v36
    v_lshlrev_b32 v37, 16, v37
    v_lshlrev_b32 v38, 16, v38
    v_lshlrev_b32 v39, 16, v39
    v_lshlrev_b32 v40, 16, v40
    v_lshlrev_b32 v41, 16, v41
    v_lshlrev_b32 v42, 16, v42
    v_lshlrev_b32 v43, 16, v43
    v_lshlrev_b32 v44, 16, v44
    v_lshlrev_b32 v45, 16, v45
    v_lshlrev_b32 v46, 16, v46
    v_lshlrev_b32 v47, 16, v47
    v_add_f32 v5, v16, v18
    v_add_f32 v5, v5, v20
    v_add_f32 v5, v5, v22
    v_add_f32 v5, v5, v24
    v_add_f32 v5, v5, v26
    v_add_f32 v5, v5, v28
    v_add_f32 v5, v5, v30
    v_add_f32 v5, v5, v32
    v_add_f32 v5, v5, v34
    v_add_f32 v5, v5, v36
    v_add_f32 v5, v5, v38
    v_add_f32 v5, v5, v40
    v_add_f32 v5, v5, v42
    v_add_f32 v5, v5, v44
    v_add_f32 v5, v5, v46
    s_nop 1
    v_add_f32_dpp v5, v5, v5 quad_perm:[1,0,3,2] row_mask:0xf bank_mask:0xf
    s_nop 1
    v_add_f32_dpp v5, v5, v5 quad_perm:[2,3,0,1] row_mask:0xf bank_mask:0xf
    s_nop 1
    v_add_f32_dpp v5, v5, v5 row_half_mirror row_mask:0xf bank_mask:0xf
    s_nop 1
    v_add_f32_dpp v5, v5, v5 row_mirror row_mask:0xf bank_mask:0xf
    s_nop 1
    v_add_f32_dpp v5, v5, v5 row_bcast:15 row_mask:0xa bank_mask:0xf
    s_nop 1
    v_add_f32_dpp v5, v5, v5 row_bcast:31 row_mask:0xc bank_mask:0xf
    s_nop 0
    v_readlane_b32 s20, v5, 63
    v_mov_b32 v6, 0x3a800000
    s_nop 0
    v_mul_f32 v6, s20, v6
    v_sub_f32 v5, v16, v6
    v_mul_f32 v5, v5, v5
    v_add_f32 v7, v17, v19
    v_add_f32 v7, v7, v21
    v_add_f32 v7, v7, v23
    v_add_f32 v7, v7, v25
    v_add_f32 v7, v7, v27
    v_add_f32 v7, v7, v29
    v_add_f32 v7, v7, v31
    v_add_f32 v7, v7, v33
    v_add_f32 v7, v7, v35
    v_add_f32 v7, v7, v37
    v_add_f32 v7, v7, v39
    v_add_f32 v7, v7, v41
    v_add_f32 v7, v7, v43
    v_add_f32 v7, v7, v45
    v_add_f32 v7, v7, v47
    s_nop 1
    v_add_f32_dpp v7, v7, v7 quad_perm:[1,0,3,2] row_mask:0xf bank_mask:0xf
    s_nop 1
    v_add_f32_dpp v7, v7, v7 quad_perm:[2,3,0,1] row_mask:0xf bank_mask:0xf
    s_nop 1
    v_add_f32_dpp v7, v7, v7 row_half_mirror row_mask:0xf bank_mask:0xf
    s_nop 1
    v_add_f32_dpp v7, v7, v7 row_mirror row_mask:0xf bank_mask:0xf
    s_nop 1
    v_add_f32_dpp v7, v7, v7 row_bcast:15 row_mask:0xa bank_mask:0xf
    s_nop 1
    v_add_f32_dpp v7, v7, v7 row_bcast:31 row_mask:0xc bank_mask:0xf
    s_nop 0
    v_readlane_b32 s22, v7, 63
    v_mov_b32 v8, 0x3a800000
    s_nop 0
    v_mul_f32 v8, s22, v8
    v_sub_f32 v7, v17, v8
    v_mul_f32 v7, v7, v7
    v_sub_f32 v9, v18, v6
    v_fmac_f32 v5, v9, v9
    v_sub_f32 v9, v20, v6
    v_fmac_f32 v5, v9, v9
    v_sub_f32 v9, v22, v6
    v_fmac_f32 v5, v9, v9
    v_sub_f32 v9, v24, v6
    v_fmac_f32 v5, v9, v9
    v_sub_f32 v9, v26, v6
    v_fmac_f32 v5, v9, v9
    v_sub_f32 v9, v28, v6
    v_fmac_f32 v5, v9, v9
    v_sub_f32 v9, v30, v6
    v_fmac_f32 v5, v9, v9
    v_sub_f32 v9, v32, v6
    v_fmac_f32 v5, v9, v9
    v_sub_f32 v9, v34, v6
    v_fmac_f32 v5, v9, v9
    v_sub_f32 v9, v36, v6
    v_fmac_f32 v5, v9, v9
    v_sub_f32 v9, v38, v6
    v_fmac_f32 v5, v9, v9
    v_sub_f32 v9, v40, v6
    v_fmac_f32 v5, v9, v9
    v_sub_f32 v9, v42, v6
    v_fmac_f32 v5, v9, v9
    v_sub_f32 v9, v44, v6
    v_fmac_f32 v5, v9, v9
    v_sub_f32 v9, v46, v6
    v_fmac_f32 v5, v9, v9
    s_nop 1
    v_add_f32_dpp v5, v5, v5 quad_perm:[1,0,3,2] row_mask:0xf bank_mask:0xf
    s_nop 1
    v_add_f32_dpp v5, v5, v5 quad_perm:[2,3,0,1] row_mask:0xf bank_mask:0xf
    s_nop 1
    v_add_f32_dpp v5, v5, v5 row_half_mirror row_mask:0xf bank_mask:0xf
    s_nop 1
    v_add_f32_dpp v5, v5, v5 row_mirror row_mask:0xf bank_mask:0xf
    s_nop 1
    v_add_f32_dpp v5, v5, v5 row_bcast:15 row_mask:0xa bank_mask:0xf
    s_nop 1
    v_add_f32_dpp v5, v5, v5 row_bcast:31 row_mask:0xc bank_mask:0xf
    s_nop 0
    v_readlane_b32 s20, v5, 63
    v_mov_b32 v5, 0x3a800000
    s_nop 0
    v_mul_f32 v5, s20, v5
    v_cvt_pk_bf16_f32 v5, v5, v5
    v_lshlrev_b32 v5, 16, v5
    v_add_f32 v5, 0x3727c5ac, v5
    v_cvt_pk_bf16_f32 v5, v5, v5
    v_lshlrev_b32 v5, 16, v5
    v_sqrt_f32 v5, v5
    s_nop 0
    v_cvt_pk_bf16_f32 v5, v5, v5
    v_lshlrev_b32 v5, 16, v5
    v_rcp_f32 v5, v5
    v_cvt_pk_bf16_f32 v6, v6, v6
    v_lshlrev_b32 v6, 16, v6
    v_sub_f32 v16, v16, v6
    v_sub_f32 v18, v18, v6
    v_cvt_pk_bf16_f32 v9, v16, v18
    v_lshlrev_b32 v16, 16, v9
    v_and_b32 v18, 0xffff0000, v9
    v_mul_f32 v16, v16, v5
    v_mul_f32 v18, v18, v5
    v_cvt_pk_bf16_f32 v9, v16, v18
    v_lshlrev_b32 v16, 16, v9
    v_and_b32 v18, 0xffff0000, v9
    v_sub_f32 v20, v20, v6
    v_sub_f32 v22, v22, v6
    v_cvt_pk_bf16_f32 v9, v20, v22
    v_lshlrev_b32 v20, 16, v9
    v_and_b32 v22, 0xffff0000, v9
    v_mul_f32 v20, v20, v5
    v_mul_f32 v22, v22, v5
    v_cvt_pk_bf16_f32 v9, v20, v22
    v_lshlrev_b32 v20, 16, v9
    v_and_b32 v22, 0xffff0000, v9
    v_sub_f32 v24, v24, v6
    v_sub_f32 v26, v26, v6
    v_cvt_pk_bf16_f32 v9, v24, v26
    v_lshlrev_b32 v24, 16, v9
    v_and_b32 v26, 0xffff0000, v9
    v_mul_f32 v24, v24, v5
    v_mul_f32 v26, v26, v5
    v_cvt_pk_bf16_f32 v9, v24, v26
    v_lshlrev_b32 v24, 16, v9
    v_and_b32 v26, 0xffff0000, v9
    v_sub_f32 v28, v28, v6
    v_sub_f32 v30, v30, v6
    v_cvt_pk_bf16_f32 v9, v28, v30
    v_lshlrev_b32 v28, 16, v9
    v_and_b32 v30, 0xffff0000, v9
    v_mul_f32 v28, v28, v5
    v_mul_f32 v30, v30, v5
    v_cvt_pk_bf16_f32 v9, v28, v30
    v_lshlrev_b32 v28, 16, v9
    v_and_b32 v30, 0xffff0000, v9
    v_sub_f32 v32, v32, v6
    v_sub_f32 v34, v34, v6
    v_cvt_pk_bf16_f32 v9, v32, v34
    v_lshlrev_b32 v32, 16, v9
    v_and_b32 v34, 0xffff0000, v9
    v_mul_f32 v32, v32, v5
    v_mul_f32 v34, v34, v5
    v_cvt_pk_bf16_f32 v9, v32, v34
    v_lshlrev_b32 v32, 16, v9
    v_and_b32 v34, 0xffff0000, v9
    v_sub_f32 v36, v36, v6
    v_sub_f32 v38, v38, v6
    v_cvt_pk_bf16_f32 v9, v36, v38
    v_lshlrev_b32 v36, 16, v9
    v_and_b32 v38, 0xffff0000, v9
    v_mul_f32 v36, v36, v5
    v_mul_f32 v38, v38, v5
    v_cvt_pk_bf16_f32 v9, v36, v38
    v_lshlrev_b32 v36, 16, v9
    v_and_b32 v38, 0xffff0000, v9
    v_sub_f32 v40, v40, v6
    v_sub_f32 v42, v42, v6
    v_cvt_pk_bf16_f32 v9, v40, v42
    v_lshlrev_b32 v40, 16, v9
    v_and_b32 v42, 0xffff0000, v9
    v_mul_f32 v40, v40, v5
    v_mul_f32 v42, v42, v5
    v_cvt_pk_bf16_f32 v9, v40, v42
    v_lshlrev_b32 v40, 16, v9
    v_and_b32 v42, 0xffff0000, v9
    v_sub_f32 v44, v44, v6
    v_sub_f32 v46, v46, v6
    v_cvt_pk_bf16_f32 v9, v44, v46
    v_lshlrev_b32 v44, 16, v9
    v_and_b32 v46, 0xffff0000, v9
    v_mul_f32 v44, v44, v5
    v_mul_f32 v46, v46, v5
    v_cvt_pk_bf16_f32 v9, v44, v46
    v_lshlrev_b32 v44, 16, v9
    v_and_b32 v46, 0xffff0000, v9
    v_sub_f32 v10, v19, v8
    v_fmac_f32 v7, v10, v10
    v_sub_f32 v10, v21, v8
    v_fmac_f32 v7, v10, v10
    v_sub_f32 v10, v23, v8
    v_fmac_f32 v7, v10, v10
    v_sub_f32 v10, v25, v8
    v_fmac_f32 v7, v10, v10
    v_sub_f32 v10, v27, v8
    v_fmac_f32 v7, v10, v10
    v_sub_f32 v10, v29, v8
    v_fmac_f32 v7, v10, v10
    v_sub_f32 v10, v31, v8
    v_fmac_f32 v7, v10, v10
    v_sub_f32 v10, v33, v8
    v_fmac_f32 v7, v10, v10
    v_sub_f32 v10, v35, v8
    v_fmac_f32 v7, v10, v10
    v_sub_f32 v10, v37, v8
    v_fmac_f32 v7, v10, v10
    v_sub_f32 v10, v39, v8
    v_fmac_f32 v7, v10, v10
    v_sub_f32 v10, v41, v8
    v_fmac_f32 v7, v10, v10
    v_sub_f32 v10, v43, v8
    v_fmac_f32 v7, v10, v10
    v_sub_f32 v10, v45, v8
    v_fmac_f32 v7, v10, v10
    v_sub_f32 v10, v47, v8
    v_fmac_f32 v7, v10, v10
    s_nop 1
    v_add_f32_dpp v7, v7, v7 quad_perm:[1,0,3,2] row_mask:0xf bank_mask:0xf
    s_nop 1
    v_add_f32_dpp v7, v7, v7 quad_perm:[2,3,0,1] row_mask:0xf bank_mask:0xf
    s_nop 1
    v_add_f32_dpp v7, v7, v7 row_half_mirror row_mask:0xf bank_mask:0xf
    s_nop 1
    v_add_f32_dpp v7, v7, v7 row_mirror row_mask:0xf bank_mask:0xf
    s_nop 1
    v_add_f32_dpp v7, v7, v7 row_bcast:15 row_mask:0xa bank_mask:0xf
    s_nop 1
    v_add_f32_dpp v7, v7, v7 row_bcast:31 row_mask:0xc bank_mask:0xf
    s_nop 0
    v_readlane_b32 s22, v7, 63
    v_mov_b32 v7, 0x3a800000
    s_nop 0
    v_mul_f32 v7, s22, v7
    v_cvt_pk_bf16_f32 v7, v7, v7
    v_lshlrev_b32 v7, 16, v7
    v_add_f32 v7, 0x3727c5ac, v7
    v_cvt_pk_bf16_f32 v7, v7, v7
    v_lshlrev_b32 v7, 16, v7
    v_sqrt_f32 v7, v7
    s_nop 0
    v_cvt_pk_bf16_f32 v7, v7, v7
    v_lshlrev_b32 v7, 16, v7
    v_rcp_f32 v7, v7
    v_cvt_pk_bf16_f32 v8, v8, v8
    v_lshlrev_b32 v8, 16, v8
    v_sub_f32 v17, v17, v8
    v_sub_f32 v19, v19, v8
    v_cvt_pk_bf16_f32 v10, v17, v19
    v_lshlrev_b32 v17, 16, v10
    v_and_b32 v19, 0xffff0000, v10
    v_mul_f32 v17, v17, v7
    v_mul_f32 v19, v19, v7
    v_cvt_pk_bf16_f32 v10, v17, v19
    v_lshlrev_b32 v17, 16, v10
    v_and_b32 v19, 0xffff0000, v10
    v_sub_f32 v21, v21, v8
    v_sub_f32 v23, v23, v8
    v_cvt_pk_bf16_f32 v10, v21, v23
    v_lshlrev_b32 v21, 16, v10
    v_and_b32 v23, 0xffff0000, v10
    v_mul_f32 v21, v21, v7
    v_mul_f32 v23, v23, v7
    v_cvt_pk_bf16_f32 v10, v21, v23
    v_lshlrev_b32 v21, 16, v10
    v_and_b32 v23, 0xffff0000, v10
    v_sub_f32 v25, v25, v8
    v_sub_f32 v27, v27, v8
    v_cvt_pk_bf16_f32 v10, v25, v27
    v_lshlrev_b32 v25, 16, v10
    v_and_b32 v27, 0xffff0000, v10
    v_mul_f32 v25, v25, v7
    v_mul_f32 v27, v27, v7
    v_cvt_pk_bf16_f32 v10, v25, v27
    v_lshlrev_b32 v25, 16, v10
    v_and_b32 v27, 0xffff0000, v10
    v_sub_f32 v29, v29, v8
    v_sub_f32 v31, v31, v8
    v_cvt_pk_bf16_f32 v10, v29, v31
    v_lshlrev_b32 v29, 16, v10
    v_and_b32 v31, 0xffff0000, v10
    v_mul_f32 v29, v29, v7
    v_mul_f32 v31, v31, v7
    v_cvt_pk_bf16_f32 v10, v29, v31
    v_lshlrev_b32 v29, 16, v10
    v_and_b32 v31, 0xffff0000, v10
    v_sub_f32 v33, v33, v8
    v_sub_f32 v35, v35, v8
    v_cvt_pk_bf16_f32 v10, v33, v35
    v_lshlrev_b32 v33, 16, v10
    v_and_b32 v35, 0xffff0000, v10
    v_mul_f32 v33, v33, v7
    v_mul_f32 v35, v35, v7
    v_cvt_pk_bf16_f32 v10, v33, v35
    v_lshlrev_b32 v33, 16, v10
    v_and_b32 v35, 0xffff0000, v10
    v_sub_f32 v37, v37, v8
    v_sub_f32 v39, v39, v8
    v_cvt_pk_bf16_f32 v10, v37, v39
    v_lshlrev_b32 v37, 16, v10
    v_and_b32 v39, 0xffff0000, v10
    v_mul_f32 v37, v37, v7
    v_mul_f32 v39, v39, v7
    v_cvt_pk_bf16_f32 v10, v37, v39
    v_lshlrev_b32 v37, 16, v10
    v_and_b32 v39, 0xffff0000, v10
    v_sub_f32 v41, v41, v8
    v_sub_f32 v43, v43, v8
    v_cvt_pk_bf16_f32 v10, v41, v43
    v_lshlrev_b32 v41, 16, v10
    v_and_b32 v43, 0xffff0000, v10
    v_mul_f32 v41, v41, v7
    v_mul_f32 v43, v43, v7
    v_cvt_pk_bf16_f32 v10, v41, v43
    v_lshlrev_b32 v41, 16, v10
    v_and_b32 v43, 0xffff0000, v10
    v_sub_f32 v45, v45, v8
    v_sub_f32 v47, v47, v8
    v_cvt_pk_bf16_f32 v10, v45, v47
    v_lshlrev_b32 v45, 16, v10
    v_and_b32 v47, 0xffff0000, v10
    v_mul_f32 v45, v45, v7
    v_mul_f32 v47, v47, v7
    v_cvt_pk_bf16_f32 v10, v45, v47
    v_lshlrev_b32 v45, 16, v10
    v_and_b32 v47, 0xffff0000, v10
    v_pk_add_f32 v[48:49], v[16:17], v[32:33]
    v_pk_add_f32 v[50:51], v[16:17], v[32:33] neg_lo:[0,1] neg_hi:[0,1]
    v_pk_add_f32 v[52:53], v[24:25], v[40:41]
    v_pk_add_f32 v[54:55], v[24:25], v[40:41] neg_lo:[0,1] neg_hi:[0,1]
    v_pk_add_f32 v[16:17], v[48:49], v[52:53]
    v_pk_add_f32 v[24:25], v[48:49], v[52:53] neg_lo:[0,1] neg_hi:[0,1]
    v_pk_add_f32 v[32:33], v[50:51], v[54:55] op_sel:[0,1] op_sel_hi:[1,0] neg_hi:[0,1]
    v_pk_add_f32 v[40:41], v[50:51], v[54:55] op_sel:[0,1] op_sel_hi:[1,0] neg_lo:[0,1]
    v_pk_add_f32 v[48:49], v[18:19], v[34:35]
    v_pk_add_f32 v[50:51], v[18:19], v[34:35] neg_lo:[0,1] neg_hi:[0,1]
    v_pk_add_f32 v[52:53], v[26:27], v[42:43]
    v_pk_add_f32 v[54:55], v[26:27], v[42:43] neg_lo:[0,1] neg_hi:[0,1]
    v_pk_add_f32 v[18:19], v[48:49], v[52:53]
    v_pk_add_f32 v[26:27], v[48:49], v[52:53] neg_lo:[0,1] neg_hi:[0,1]
    v_pk_add_f32 v[34:35], v[50:51], v[54:55] op_sel:[0,1] op_sel_hi:[1,0] neg_hi:[0,1]
    v_pk_add_f32 v[42:43], v[50:51], v[54:55] op_sel:[0,1] op_sel_hi:[1,0] neg_lo:[0,1]
    v_pk_mul_f32 v[48:49], v[34:35], s[40:41] op_sel:[0,0] op_sel_hi:[1,0]
    v_pk_fma_f32 v[50:51], v[34:35], s[40:41], v[48:49] op_sel:[1,1,0] op_sel_hi:[0,1,1] neg_lo:[1,0,0]
    v_pk_mul_f32 v[34:35], v[26:27], s[42:43] op_sel:[0,0] op_sel_hi:[1,0]
    v_pk_fma_f32 v[48:49], v[26:27], s[42:43], v[34:35] op_sel:[1,1,0] op_sel_hi:[0,1,1] neg_lo:[1,0,0]
    v_pk_mul_f32 v[26:27], v[42:43], s[44:45] op_sel:[0,0] op_sel_hi:[1,0]
    v_pk_fma_f32 v[34:35], v[42:43], s[44:45], v[26:27] op_sel:[1,1,0] op_sel_hi:[0,1,1] neg_lo:[1,0,0]
    v_pk_add_f32 v[26:27], v[20:21], v[36:37]
    v_pk_add_f32 v[42:43], v[20:21], v[36:37] neg_lo:[0,1] neg_hi:[0,1]
    v_pk_add_f32 v[52:53], v[28:29], v[44:45]
    v_pk_add_f32 v[54:55], v[28:29], v[44:45] neg_lo:[0,1] neg_hi:[0,1]
    v_pk_add_f32 v[20:21], v[26:27], v[52:53]
    v_pk_add_f32 v[28:29], v[26:27], v[52:53] neg_lo:[0,1] neg_hi:[0,1]
    v_pk_add_f32 v[36:37], v[42:43], v[54:55] op_sel:[0,1] op_sel_hi:[1,0] neg_hi:[0,1]
    v_pk_add_f32 v[44:45], v[42:43], v[54:55] op_sel:[0,1] op_sel_hi:[1,0] neg_lo:[0,1]
    v_pk_mul_f32 v[26:27], v[36:37], s[42:43] op_sel:[0,0] op_sel_hi:[1,0]
    v_pk_fma_f32 v[42:43], v[36:37], s[42:43], v[26:27] op_sel:[1,1,0] op_sel_hi:[0,1,1] neg_lo:[1,0,0]
    v_pk_mul_f32 v[26:27], v[28:29], s[46:47] op_sel:[0,0] op_sel_hi:[1,0]
    v_pk_fma_f32 v[36:37], v[28:29], s[46:47], v[26:27] op_sel:[1,1,0] op_sel_hi:[0,1,1] neg_lo:[1,0,0]
    v_pk_mul_f32 v[26:27], v[44:45], s[48:49] op_sel:[0,0] op_sel_hi:[1,0]
    v_pk_fma_f32 v[28:29], v[44:45], s[48:49], v[26:27] op_sel:[1,1,0] op_sel_hi:[0,1,1] neg_lo:[1,0,0]
    v_pk_add_f32 v[26:27], v[22:23], v[38:39]
    v_pk_add_f32 v[44:45], v[22:23], v[38:39] neg_lo:[0,1] neg_hi:[0,1]
    v_pk_add_f32 v[52:53], v[30:31], v[46:47]
    v_pk_add_f32 v[54:55], v[30:31], v[46:47] neg_lo:[0,1] neg_hi:[0,1]
    v_pk_add_f32 v[22:23], v[26:27], v[52:53]
    v_pk_add_f32 v[30:31], v[26:27], v[52:53] neg_lo:[0,1] neg_hi:[0,1]
    v_pk_add_f32 v[38:39], v[44:45], v[54:55] op_sel:[0,1] op_sel_hi:[1,0] neg_hi:[0,1]
    v_pk_add_f32 v[46:47], v[44:45], v[54:55] op_sel:[0,1] op_sel_hi:[1,0] neg_lo:[0,1]
    v_pk_mul_f32 v[26:27], v[38:39], s[44:45] op_sel:[0,0] op_sel_hi:[1,0]
    v_pk_fma_f32 v[44:45], v[38:39], s[44:45], v[26:27] op_sel:[1,1,0] op_sel_hi:[0,1,1] neg_lo:[1,0,0]
    v_pk_mul_f32 v[26:27], v[30:31], s[48:49] op_sel:[0,0] op_sel_hi:[1,0]
    v_pk_fma_f32 v[38:39], v[30:31], s[48:49], v[26:27] op_sel:[1,1,0] op_sel_hi:[0,1,1] neg_lo:[1,0,0]
    v_pk_mul_f32 v[26:27], v[46:47], s[50:51] op_sel:[0,0] op_sel_hi:[1,0]
    v_pk_fma_f32 v[30:31], v[46:47], s[50:51], v[26:27] op_sel:[1,1,0] op_sel_hi:[0,1,1] neg_lo:[1,0,0]
    v_pk_add_f32 v[26:27], v[16:17], v[20:21]
    v_pk_add_f32 v[46:47], v[16:17], v[20:21] neg_lo:[0,1] neg_hi:[0,1]
    v_pk_add_f32 v[52:53], v[18:19], v[22:23]
    v_pk_add_f32 v[54:55], v[18:19], v[22:23] neg_lo:[0,1] neg_hi:[0,1]
    v_pk_add_f32 v[16:17], v[26:27], v[52:53]
    v_pk_add_f32 v[18:19], v[26:27], v[52:53] neg_lo:[0,1] neg_hi:[0,1]
    v_pk_add_f32 v[20:21], v[46:47], v[54:55] op_sel:[0,1] op_sel_hi:[1,0] neg_hi:[0,1]
    v_pk_add_f32 v[22:23], v[46:47], v[54:55] op_sel:[0,1] op_sel_hi:[1,0] neg_lo:[0,1]
    v_pk_add_f32 v[26:27], v[32:33], v[42:43]
    v_pk_add_f32 v[46:47], v[32:33], v[42:43] neg_lo:[0,1] neg_hi:[0,1]
    v_pk_add_f32 v[52:53], v[50:51], v[44:45]
    v_pk_add_f32 v[54:55], v[50:51], v[44:45] neg_lo:[0,1] neg_hi:[0,1]
    v_pk_add_f32 v[32:33], v[26:27], v[52:53]
    v_pk_add_f32 v[42:43], v[26:27], v[52:53] neg_lo:[0,1] neg_hi:[0,1]
    v_pk_add_f32 v[44:45], v[46:47], v[54:55] op_sel:[0,1] op_sel_hi:[1,0] neg_hi:[0,1]
    v_pk_add_f32 v[50:51], v[46:47], v[54:55] op_sel:[0,1] op_sel_hi:[1,0] neg_lo:[0,1]
    v_pk_add_f32 v[26:27], v[24:25], v[36:37]
    v_pk_add_f32 v[46:47], v[24:25], v[36:37] neg_lo:[0,1] neg_hi:[0,1]
    v_pk_add_f32 v[52:53], v[48:49], v[38:39]
    v_pk_add_f32 v[54:55], v[48:49], v[38:39] neg_lo:[0,1] neg_hi:[0,1]
    v_pk_add_f32 v[24:25], v[26:27], v[52:53]
    v_pk_add_f32 v[36:37], v[26:27], v[52:53] neg_lo:[0,1] neg_hi:[0,1]
    v_pk_add_f32 v[38:39], v[46:47], v[54:55] op_sel:[0,1] op_sel_hi:[1,0] neg_hi:[0,1]
    v_pk_add_f32 v[48:49], v[46:47], v[54:55] op_sel:[0,1] op_sel_hi:[1,0] neg_lo:[0,1]
    v_pk_add_f32 v[26:27], v[40:41], v[28:29]
    v_pk_add_f32 v[46:47], v[40:41], v[28:29] neg_lo:[0,1] neg_hi:[0,1]
    v_pk_add_f32 v[52:53], v[34:35], v[30:31]
    v_pk_add_f32 v[54:55], v[34:35], v[30:31] neg_lo:[0,1] neg_hi:[0,1]
    v_pk_add_f32 v[28:29], v[26:27], v[52:53]
    v_pk_add_f32 v[30:31], v[26:27], v[52:53] neg_lo:[0,1] neg_hi:[0,1]
    v_pk_add_f32 v[34:35], v[46:47], v[54:55] op_sel:[0,1] op_sel_hi:[1,0] neg_hi:[0,1]
    v_pk_add_f32 v[40:41], v[46:47], v[54:55] op_sel:[0,1] op_sel_hi:[1,0] neg_lo:[0,1]
    v_cvt_f32_u32 v5, v1
    v_mul_f32 v7, 0xba800000, v5
    v_cos_f32 v26, v7
    v_sin_f32 v27, v7
    s_nop 0
    v_pk_mul_f32 v[46:47], v[32:33], v[26:27] op_sel:[0,0] op_sel_hi:[1,0]
    v_pk_fma_f32 v[52:53], v[32:33], v[26:27], v[46:47] op_sel:[1,1,0] op_sel_hi:[0,1,1] neg_lo:[1,0,0]
    v_mul_f32 v7, 0xbb000000, v5
    v_cos_f32 v26, v7
    v_sin_f32 v27, v7
    s_nop 0
    v_pk_mul_f32 v[32:33], v[24:25], v[26:27] op_sel:[0,0] op_sel_hi:[1,0]
    v_pk_fma_f32 v[46:47], v[24:25], v[26:27], v[32:33] op_sel:[1,1,0] op_sel_hi:[0,1,1] neg_lo:[1,0,0]
    v_mul_f32 v7, 0xbb400000, v5
    v_cos_f32 v24, v7
    v_sin_f32 v25, v7
    s_nop 0
    v_pk_mul_f32 v[26:27], v[28:29], v[24:25] op_sel:[0,0] op_sel_hi:[1,0]
    v_pk_fma_f32 v[32:33], v[28:29], v[24:25], v[26:27] op_sel:[1,1,0] op_sel_hi:[0,1,1] neg_lo:[1,0,0]
    v_mul_f32 v7, 0xbb800000, v5
    v_cos_f32 v24, v7
    v_sin_f32 v25, v7
    s_nop 0
    v_pk_mul_f32 v[26:27], v[20:21], v[24:25] op_sel:[0,0] op_sel_hi:[1,0]
    v_pk_fma_f32 v[28:29], v[20:21], v[24:25], v[26:27] op_sel:[1,1,0] op_sel_hi:[0,1,1] neg_lo:[1,0,0]
    v_mul_f32 v7, 0xbba00000, v5
    v_cos_f32 v20, v7
    v_sin_f32 v21, v7
    s_nop 0
    v_pk_mul_f32 v[24:25], v[44:45], v[20:21] op_sel:[0,0] op_sel_hi:[1,0]
    v_pk_fma_f32 v[26:27], v[44:45], v[20:21], v[24:25] op_sel:[1,1,0] op_sel_hi:[0,1,1] neg_lo:[1,0,0]
    v_mul_f32 v7, 0xbbc00000, v5
    v_cos_f32 v20, v7
    v_sin_f32 v21, v7
    s_nop 0
    v_pk_mul_f32 v[24:25], v[38:39], v[20:21] op_sel:[0,0] op_sel_hi:[1,0]
    v_pk_fma_f32 v[44:45], v[38:39], v[20:21], v[24:25] op_sel:[1,1,0] op_sel_hi:[0,1,1] neg_lo:[1,0,0]
    v_mul_f32 v7, 0xbbe00000, v5
    v_cos_f32 v20, v7
    v_sin_f32 v21, v7
    s_nop 0
    v_pk_mul_f32 v[24:25], v[34:35], v[20:21] op_sel:[0,0] op_sel_hi:[1,0]
    v_pk_fma_f32 v[38:39], v[34:35], v[20:21], v[24:25] op_sel:[1,1,0] op_sel_hi:[0,1,1] neg_lo:[1,0,0]
    v_mul_f32 v7, 0xbc000000, v5
    v_cos_f32 v20, v7
    v_sin_f32 v21, v7
    s_nop 0
    v_pk_mul_f32 v[24:25], v[18:19], v[20:21] op_sel:[0,0] op_sel_hi:[1,0]
    v_pk_fma_f32 v[34:35], v[18:19], v[20:21], v[24:25] op_sel:[1,1,0] op_sel_hi:[0,1,1] neg_lo:[1,0,0]
    v_mul_f32 v7, 0xbc100000, v5
    v_cos_f32 v18, v7
    v_sin_f32 v19, v7
    s_nop 0
    v_pk_mul_f32 v[20:21], v[42:43], v[18:19] op_sel:[0,0] op_sel_hi:[1,0]
    v_pk_fma_f32 v[24:25], v[42:43], v[18:19], v[20:21] op_sel:[1,1,0] op_sel_hi:[0,1,1] neg_lo:[1,0,0]
    v_mul_f32 v7, 0xbc200000, v5
    v_cos_f32 v18, v7
    v_sin_f32 v19, v7
    s_nop 0
    v_pk_mul_f32 v[20:21], v[36:37], v[18:19] op_sel:[0,0] op_sel_hi:[1,0]
    v_pk_fma_f32 v[42:43], v[36:37], v[18:19], v[20:21] op_sel:[1,1,0] op_sel_hi:[0,1,1] neg_lo:[1,0,0]
    v_mul_f32 v7, 0xbc300000, v5
    v_cos_f32 v18, v7
    v_sin_f32 v19, v7
    s_nop 0
    v_pk_mul_f32 v[20:21], v[30:31], v[18:19] op_sel:[0,0] op_sel_hi:[1,0]
    v_pk_fma_f32 v[36:37], v[30:31], v[18:19], v[20:21] op_sel:[1,1,0] op_sel_hi:[0,1,1] neg_lo:[1,0,0]
    v_mul_f32 v7, 0xbc400000, v5
    v_cos_f32 v18, v7
    v_sin_f32 v19, v7
    s_nop 0
    v_pk_mul_f32 v[20:21], v[22:23], v[18:19] op_sel:[0,0] op_sel_hi:[1,0]
    v_pk_fma_f32 v[30:31], v[22:23], v[18:19], v[20:21] op_sel:[1,1,0] op_sel_hi:[0,1,1] neg_lo:[1,0,0]
    v_mul_f32 v7, 0xbc500000, v5
    v_cos_f32 v18, v7
    v_sin_f32 v19, v7
    s_nop 0
    v_pk_mul_f32 v[20:21], v[50:51], v[18:19] op_sel:[0,0] op_sel_hi:[1,0]
    v_pk_fma_f32 v[22:23], v[50:51], v[18:19], v[20:21] op_sel:[1,1,0] op_sel_hi:[0,1,1] neg_lo:[1,0,0]
    v_mul_f32 v7, 0xbc600000, v5
    v_cos_f32 v18, v7
    v_sin_f32 v19, v7
    s_nop 0
    v_pk_mul_f32 v[20:21], v[48:49], v[18:19] op_sel:[0,0] op_sel_hi:[1,0]
    v_pk_fma_f32 v[50:51], v[48:49], v[18:19], v[20:21] op_sel:[1,1,0] op_sel_hi:[0,1,1] neg_lo:[1,0,0]
    v_mul_f32 v7, 0xbc700000, v5
    v_cos_f32 v18, v7
    v_sin_f32 v19, v7
    s_nop 0
    v_pk_mul_f32 v[20:21], v[40:41], v[18:19] op_sel:[0,0] op_sel_hi:[1,0]
    v_pk_fma_f32 v[48:49], v[40:41], v[18:19], v[20:21] op_sel:[1,1,0] op_sel_hi:[0,1,1] neg_lo:[1,0,0]
    v_lshl_add_u32 v6, v1, 3, v4
    ds_write_b64 v6, v[16:17] offset:0
    ds_write_b64 v6, v[52:53] offset:544
    ds_write_b64 v6, v[46:47] offset:1088
    ds_write_b64 v6, v[32:33] offset:1632
    ds_write_b64 v6, v[28:29] offset:2176
    ds_write_b64 v6, v[26:27] offset:2720
    ds_write_b64 v6, v[44:45] offset:3264
    ds_write_b64 v6, v[38:39] offset:3808
    ds_write_b64 v6, v[34:35] offset:4352
    ds_write_b64 v6, v[24:25] offset:4896
    ds_write_b64 v6, v[42:43] offset:5440
    ds_write_b64 v6, v[36:37] offset:5984
    ds_write_b64 v6, v[30:31] offset:6528
    ds_write_b64 v6, v[22:23] offset:7072
    ds_write_b64 v6, v[50:51] offset:7616
    ds_write_b64 v6, v[48:49] offset:8160
    v_lshrrev_b32 v6, 2, v1
    v_mul_u32_u24 v6, 68, v6
    v_and_b32 v8, 3, v1
    v_add_u32 v6, v6, v8
    v_lshl_add_u32 v6, v6, 3, v4
    ds_read_b64 v[16:17], v6 offset:0
    ds_read_b64 v[18:19], v6 offset:32
    ds_read_b64 v[20:21], v6 offset:64
    ds_read_b64 v[22:23], v6 offset:96
    ds_read_b64 v[24:25], v6 offset:128
    ds_read_b64 v[26:27], v6 offset:160
    ds_read_b64 v[28:29], v6 offset:192
    ds_read_b64 v[30:31], v6 offset:224
    ds_read_b64 v[32:33], v6 offset:256
    ds_read_b64 v[34:35], v6 offset:288
    ds_read_b64 v[36:37], v6 offset:320
    ds_read_b64 v[38:39], v6 offset:352
    ds_read_b64 v[40:41], v6 offset:384
    ds_read_b64 v[42:43], v6 offset:416
    ds_read_b64 v[44:45], v6 offset:448
    ds_read_b64 v[46:47], v6 offset:480
    s_waitcnt lgkmcnt(0)
    v_pk_add_f32 v[48:49], v[16:17], v[32:33]
    v_pk_add_f32 v[50:51], v[16:17], v[32:33] neg_lo:[0,1] neg_hi:[0,1]
    v_pk_add_f32 v[52:53], v[24:25], v[40:41]
    v_pk_add_f32 v[54:55], v[24:25], v[40:41] neg_lo:[0,1] neg_hi:[0,1]
    v_pk_add_f32 v[16:17], v[48:49], v[52:53]
    v_pk_add_f32 v[24:25], v[48:49], v[52:53] neg_lo:[0,1] neg_hi:[0,1]
    v_pk_add_f32 v[32:33], v[50:51], v[54:55] op_sel:[0,1] op_sel_hi:[1,0] neg_hi:[0,1]
    v_pk_add_f32 v[40:41], v[50:51], v[54:55] op_sel:[0,1] op_sel_hi:[1,0] neg_lo:[0,1]
    v_pk_add_f32 v[48:49], v[18:19], v[34:35]
    v_pk_add_f32 v[50:51], v[18:19], v[34:35] neg_lo:[0,1] neg_hi:[0,1]
    v_pk_add_f32 v[52:53], v[26:27], v[42:43]
    v_pk_add_f32 v[54:55], v[26:27], v[42:43] neg_lo:[0,1] neg_hi:[0,1]
    v_pk_add_f32 v[18:19], v[48:49], v[52:53]
    v_pk_add_f32 v[26:27], v[48:49], v[52:53] neg_lo:[0,1] neg_hi:[0,1]
    v_pk_add_f32 v[34:35], v[50:51], v[54:55] op_sel:[0,1] op_sel_hi:[1,0] neg_hi:[0,1]
    v_pk_add_f32 v[42:43], v[50:51], v[54:55] op_sel:[0,1] op_sel_hi:[1,0] neg_lo:[0,1]
    v_pk_mul_f32 v[48:49], v[34:35], s[40:41] op_sel:[0,0] op_sel_hi:[1,0]
    v_pk_fma_f32 v[50:51], v[34:35], s[40:41], v[48:49] op_sel:[1,1,0] op_sel_hi:[0,1,1] neg_lo:[1,0,0]
    v_pk_mul_f32 v[34:35], v[26:27], s[42:43] op_sel:[0,0] op_sel_hi:[1,0]
    v_pk_fma_f32 v[48:49], v[26:27], s[42:43], v[34:35] op_sel:[1,1,0] op_sel_hi:[0,1,1] neg_lo:[1,0,0]
    v_pk_mul_f32 v[26:27], v[42:43], s[44:45] op_sel:[0,0] op_sel_hi:[1,0]
    v_pk_fma_f32 v[34:35], v[42:43], s[44:45], v[26:27] op_sel:[1,1,0] op_sel_hi:[0,1,1] neg_lo:[1,0,0]
    v_pk_add_f32 v[26:27], v[20:21], v[36:37]
    v_pk_add_f32 v[42:43], v[20:21], v[36:37] neg_lo:[0,1] neg_hi:[0,1]
    v_pk_add_f32 v[52:53], v[28:29], v[44:45]
    v_pk_add_f32 v[54:55], v[28:29], v[44:45] neg_lo:[0,1] neg_hi:[0,1]
    v_pk_add_f32 v[20:21], v[26:27], v[52:53]
    v_pk_add_f32 v[28:29], v[26:27], v[52:53] neg_lo:[0,1] neg_hi:[0,1]
    v_pk_add_f32 v[36:37], v[42:43], v[54:55] op_sel:[0,1] op_sel_hi:[1,0] neg_hi:[0,1]
    v_pk_add_f32 v[44:45], v[42:43], v[54:55] op_sel:[0,1] op_sel_hi:[1,0] neg_lo:[0,1]
    v_pk_mul_f32 v[26:27], v[36:37], s[42:43] op_sel:[0,0] op_sel_hi:[1,0]
    v_pk_fma_f32 v[42:43], v[36:37], s[42:43], v[26:27] op_sel:[1,1,0] op_sel_hi:[0,1,1] neg_lo:[1,0,0]
    v_pk_mul_f32 v[26:27], v[28:29], s[46:47] op_sel:[0,0] op_sel_hi:[1,0]
    v_pk_fma_f32 v[36:37], v[28:29], s[46:47], v[26:27] op_sel:[1,1,0] op_sel_hi:[0,1,1] neg_lo:[1,0,0]
    v_pk_mul_f32 v[26:27], v[44:45], s[48:49] op_sel:[0,0] op_sel_hi:[1,0]
    v_pk_fma_f32 v[28:29], v[44:45], s[48:49], v[26:27] op_sel:[1,1,0] op_sel_hi:[0,1,1] neg_lo:[1,0,0]
    v_pk_add_f32 v[26:27], v[22:23], v[38:39]
    v_pk_add_f32 v[44:45], v[22:23], v[38:39] neg_lo:[0,1] neg_hi:[0,1]
    v_pk_add_f32 v[52:53], v[30:31], v[46:47]
    v_pk_add_f32 v[54:55], v[30:31], v[46:47] neg_lo:[0,1] neg_hi:[0,1]
    v_pk_add_f32 v[22:23], v[26:27], v[52:53]
    v_pk_add_f32 v[30:31], v[26:27], v[52:53] neg_lo:[0,1] neg_hi:[0,1]
    v_pk_add_f32 v[38:39], v[44:45], v[54:55] op_sel:[0,1] op_sel_hi:[1,0] neg_hi:[0,1]
    v_pk_add_f32 v[46:47], v[44:45], v[54:55] op_sel:[0,1] op_sel_hi:[1,0] neg_lo:[0,1]
    v_pk_mul_f32 v[26:27], v[38:39], s[44:45] op_sel:[0,0] op_sel_hi:[1,0]
    v_pk_fma_f32 v[44:45], v[38:39], s[44:45], v[26:27] op_sel:[1,1,0] op_sel_hi:[0,1,1] neg_lo:[1,0,0]
    v_pk_mul_f32 v[26:27], v[30:31], s[48:49] op_sel:[0,0] op_sel_hi:[1,0]
    v_pk_fma_f32 v[38:39], v[30:31], s[48:49], v[26:27] op_sel:[1,1,0] op_sel_hi:[0,1,1] neg_lo:[1,0,0]
    v_pk_mul_f32 v[26:27], v[46:47], s[50:51] op_sel:[0,0] op_sel_hi:[1,0]
    v_pk_fma_f32 v[30:31], v[46:47], s[50:51], v[26:27] op_sel:[1,1,0] op_sel_hi:[0,1,1] neg_lo:[1,0,0]
    v_pk_add_f32 v[26:27], v[16:17], v[20:21]
    v_pk_add_f32 v[46:47], v[16:17], v[20:21] neg_lo:[0,1] neg_hi:[0,1]
    v_pk_add_f32 v[52:53], v[18:19], v[22:23]
    v_pk_add_f32 v[54:55], v[18:19], v[22:23] neg_lo:[0,1] neg_hi:[0,1]
    v_pk_add_f32 v[16:17], v[26:27], v[52:53]
    v_pk_add_f32 v[18:19], v[26:27], v[52:53] neg_lo:[0,1] neg_hi:[0,1]
    v_pk_add_f32 v[20:21], v[46:47], v[54:55] op_sel:[0,1] op_sel_hi:[1,0] neg_hi:[0,1]
    v_pk_add_f32 v[22:23], v[46:47], v[54:55] op_sel:[0,1] op_sel_hi:[1,0] neg_lo:[0,1]
    v_pk_add_f32 v[26:27], v[32:33], v[42:43]
    v_pk_add_f32 v[46:47], v[32:33], v[42:43] neg_lo:[0,1] neg_hi:[0,1]
    v_pk_add_f32 v[52:53], v[50:51], v[44:45]
    v_pk_add_f32 v[54:55], v[50:51], v[44:45] neg_lo:[0,1] neg_hi:[0,1]
    v_pk_add_f32 v[32:33], v[26:27], v[52:53]
    v_pk_add_f32 v[42:43], v[26:27], v[52:53] neg_lo:[0,1] neg_hi:[0,1]
    v_pk_add_f32 v[44:45], v[46:47], v[54:55] op_sel:[0,1] op_sel_hi:[1,0] neg_hi:[0,1]
    v_pk_add_f32 v[50:51], v[46:47], v[54:55] op_sel:[0,1] op_sel_hi:[1,0] neg_lo:[0,1]
    v_pk_add_f32 v[26:27], v[24:25], v[36:37]
    v_pk_add_f32 v[46:47], v[24:25], v[36:37] neg_lo:[0,1] neg_hi:[0,1]
    v_pk_add_f32 v[52:53], v[48:49], v[38:39]
    v_pk_add_f32 v[54:55], v[48:49], v[38:39] neg_lo:[0,1] neg_hi:[0,1]
    v_pk_add_f32 v[24:25], v[26:27], v[52:53]
    v_pk_add_f32 v[36:37], v[26:27], v[52:53] neg_lo:[0,1] neg_hi:[0,1]
    v_pk_add_f32 v[38:39], v[46:47], v[54:55] op_sel:[0,1] op_sel_hi:[1,0] neg_hi:[0,1]
    v_pk_add_f32 v[48:49], v[46:47], v[54:55] op_sel:[0,1] op_sel_hi:[1,0] neg_lo:[0,1]
    v_pk_add_f32 v[26:27], v[40:41], v[28:29]
    v_pk_add_f32 v[46:47], v[40:41], v[28:29] neg_lo:[0,1] neg_hi:[0,1]
    v_pk_add_f32 v[52:53], v[34:35], v[30:31]
    v_pk_add_f32 v[54:55], v[34:35], v[30:31] neg_lo:[0,1] neg_hi:[0,1]
    v_pk_add_f32 v[28:29], v[26:27], v[52:53]
    v_pk_add_f32 v[30:31], v[26:27], v[52:53] neg_lo:[0,1] neg_hi:[0,1]
    v_pk_add_f32 v[34:35], v[46:47], v[54:55] op_sel:[0,1] op_sel_hi:[1,0] neg_hi:[0,1]
    v_pk_add_f32 v[40:41], v[46:47], v[54:55] op_sel:[0,1] op_sel_hi:[1,0] neg_lo:[0,1]
    v_cvt_f32_u32 v5, v8
    v_mul_f32 v7, 0xbc800000, v5
    v_cos_f32 v26, v7
    v_sin_f32 v27, v7
    s_nop 0
    v_pk_mul_f32 v[46:47], v[32:33], v[26:27] op_sel:[0,0] op_sel_hi:[1,0]
    v_pk_fma_f32 v[52:53], v[32:33], v[26:27], v[46:47] op_sel:[1,1,0] op_sel_hi:[0,1,1] neg_lo:[1,0,0]
    v_mul_f32 v7, 0xbd000000, v5
    v_cos_f32 v26, v7
    v_sin_f32 v27, v7
    s_nop 0
    v_pk_mul_f32 v[32:33], v[24:25], v[26:27] op_sel:[0,0] op_sel_hi:[1,0]
    v_pk_fma_f32 v[46:47], v[24:25], v[26:27], v[32:33] op_sel:[1,1,0] op_sel_hi:[0,1,1] neg_lo:[1,0,0]
    v_mul_f32 v7, 0xbd400000, v5
    v_cos_f32 v24, v7
    v_sin_f32 v25, v7
    s_nop 0
    v_pk_mul_f32 v[26:27], v[28:29], v[24:25] op_sel:[0,0] op_sel_hi:[1,0]
    v_pk_fma_f32 v[32:33], v[28:29], v[24:25], v[26:27] op_sel:[1,1,0] op_sel_hi:[0,1,1] neg_lo:[1,0,0]
    v_mul_f32 v7, 0xbd800000, v5
    v_cos_f32 v24, v7
    v_sin_f32 v25, v7
    s_nop 0
    v_pk_mul_f32 v[26:27], v[20:21], v[24:25] op_sel:[0,0] op_sel_hi:[1,0]
    v_pk_fma_f32 v[28:29], v[20:21], v[24:25], v[26:27] op_sel:[1,1,0] op_sel_hi:[0,1,1] neg_lo:[1,0,0]
    v_mul_f32 v7, 0xbda00000, v5
    v_cos_f32 v20, v7
    v_sin_f32 v21, v7
    s_nop 0
    v_pk_mul_f32 v[24:25], v[44:45], v[20:21] op_sel:[0,0] op_sel_hi:[1,0]
    v_pk_fma_f32 v[26:27], v[44:45], v[20:21], v[24:25] op_sel:[1,1,0] op_sel_hi:[0,1,1] neg_lo:[1,0,0]
    v_mul_f32 v7, 0xbdc00000, v5
    v_cos_f32 v20, v7
    v_sin_f32 v21, v7
    s_nop 0
    v_pk_mul_f32 v[24:25], v[38:39], v[20:21] op_sel:[0,0] op_sel_hi:[1,0]
    v_pk_fma_f32 v[44:45], v[38:39], v[20:21], v[24:25] op_sel:[1,1,0] op_sel_hi:[0,1,1] neg_lo:[1,0,0]
    v_mul_f32 v7, 0xbde00000, v5
    v_cos_f32 v20, v7
    v_sin_f32 v21, v7
    s_nop 0
    v_pk_mul_f32 v[24:25], v[34:35], v[20:21] op_sel:[0,0] op_sel_hi:[1,0]
    v_pk_fma_f32 v[38:39], v[34:35], v[20:21], v[24:25] op_sel:[1,1,0] op_sel_hi:[0,1,1] neg_lo:[1,0,0]
    v_mul_f32 v7, 0xbe000000, v5
    v_cos_f32 v20, v7
    v_sin_f32 v21, v7
    s_nop 0
    v_pk_mul_f32 v[24:25], v[18:19], v[20:21] op_sel:[0,0] op_sel_hi:[1,0]
    v_pk_fma_f32 v[34:35], v[18:19], v[20:21], v[24:25] op_sel:[1,1,0] op_sel_hi:[0,1,1] neg_lo:[1,0,0]
    v_mul_f32 v7, 0xbe100000, v5
    v_cos_f32 v18, v7
    v_sin_f32 v19, v7
    s_nop 0
    v_pk_mul_f32 v[20:21], v[42:43], v[18:19] op_sel:[0,0] op_sel_hi:[1,0]
    v_pk_fma_f32 v[24:25], v[42:43], v[18:19], v[20:21] op_sel:[1,1,0] op_sel_hi:[0,1,1] neg_lo:[1,0,0]
    v_mul_f32 v7, 0xbe200000, v5
    v_cos_f32 v18, v7
    v_sin_f32 v19, v7
    s_nop 0
    v_pk_mul_f32 v[20:21], v[36:37], v[18:19] op_sel:[0,0] op_sel_hi:[1,0]
    v_pk_fma_f32 v[42:43], v[36:37], v[18:19], v[20:21] op_sel:[1,1,0] op_sel_hi:[0,1,1] neg_lo:[1,0,0]
    v_mul_f32 v7, 0xbe300000, v5
    v_cos_f32 v18, v7
    v_sin_f32 v19, v7
    s_nop 0
    v_pk_mul_f32 v[20:21], v[30:31], v[18:19] op_sel:[0,0] op_sel_hi:[1,0]
    v_pk_fma_f32 v[36:37], v[30:31], v[18:19], v[20:21] op_sel:[1,1,0] op_sel_hi:[0,1,1] neg_lo:[1,0,0]
    v_mul_f32 v7, 0xbe400000, v5
    v_cos_f32 v18, v7
    v_sin_f32 v19, v7
    s_nop 0
    v_pk_mul_f32 v[20:21], v[22:23], v[18:19] op_sel:[0,0] op_sel_hi:[1,0]
    v_pk_fma_f32 v[30:31], v[22:23], v[18:19], v[20:21] op_sel:[1,1,0] op_sel_hi:[0,1,1] neg_lo:[1,0,0]
    v_mul_f32 v7, 0xbe500000, v5
    v_cos_f32 v18, v7
    v_sin_f32 v19, v7
    s_nop 0
    v_pk_mul_f32 v[20:21], v[50:51], v[18:19] op_sel:[0,0] op_sel_hi:[1,0]
    v_pk_fma_f32 v[22:23], v[50:51], v[18:19], v[20:21] op_sel:[1,1,0] op_sel_hi:[0,1,1] neg_lo:[1,0,0]
    v_mul_f32 v7, 0xbe600000, v5
    v_cos_f32 v18, v7
    v_sin_f32 v19, v7
    s_nop 0
    v_pk_mul_f32 v[20:21], v[48:49], v[18:19] op_sel:[0,0] op_sel_hi:[1,0]
    v_pk_fma_f32 v[50:51], v[48:49], v[18:19], v[20:21] op_sel:[1,1,0] op_sel_hi:[0,1,1] neg_lo:[1,0,0]
    v_mul_f32 v7, 0xbe700000, v5
    v_cos_f32 v18, v7
    v_sin_f32 v19, v7
    s_nop 0
    v_pk_mul_f32 v[20:21], v[40:41], v[18:19] op_sel:[0,0] op_sel_hi:[1,0]
    v_pk_fma_f32 v[48:49], v[40:41], v[18:19], v[20:21] op_sel:[1,1,0] op_sel_hi:[0,1,1] neg_lo:[1,0,0]
    ds_write_b64 v6, v[16:17] offset:0
    ds_write_b64 v6, v[52:53] offset:32
    ds_write_b64 v6, v[46:47] offset:64
    ds_write_b64 v6, v[32:33] offset:96
    ds_write_b64 v6, v[28:29] offset:128
    ds_write_b64 v6, v[26:27] offset:160
    ds_write_b64 v6, v[44:45] offset:192
    ds_write_b64 v6, v[38:39] offset:224
    ds_write_b64 v6, v[34:35] offset:256
    ds_write_b64 v6, v[24:25] offset:288
    ds_write_b64 v6, v[42:43] offset:320
    ds_write_b64 v6, v[36:37] offset:352
    ds_write_b64 v6, v[30:31] offset:384
    ds_write_b64 v6, v[22:23] offset:416
    ds_write_b64 v6, v[50:51] offset:448
    ds_write_b64 v6, v[48:49] offset:480
    v_and_b32 v6, 15, v1
    v_mul_u32_u24 v6, 68, v6
    v_lshrrev_b32 v8, 4, v1
    v_lshl_add_u32 v6, v8, 2, v6
    v_lshl_add_u32 v6, v6, 3, v4
    ds_read_b64 v[16:17], v6 offset:0
    ds_read_b64 v[18:19], v6 offset:8
    ds_read_b64 v[20:21], v6 offset:16
    ds_read_b64 v[22:23], v6 offset:24
    ds_read_b64 v[24:25], v6 offset:128
    ds_read_b64 v[26:27], v6 offset:136
    ds_read_b64 v[28:29], v6 offset:144
    ds_read_b64 v[30:31], v6 offset:152
    ds_read_b64 v[32:33], v6 offset:256
    ds_read_b64 v[34:35], v6 offset:264
    ds_read_b64 v[36:37], v6 offset:272
    ds_read_b64 v[38:39], v6 offset:280
    ds_read_b64 v[40:41], v6 offset:384
    ds_read_b64 v[42:43], v6 offset:392
    ds_read_b64 v[44:45], v6 offset:400
    ds_read_b64 v[46:47], v6 offset:408
    s_waitcnt lgkmcnt(0)
    v_pk_add_f32 v[48:49], v[16:17], v[20:21]
    v_pk_add_f32 v[50:51], v[16:17], v[20:21] neg_lo:[0,1] neg_hi:[0,1]
    v_pk_add_f32 v[52:53], v[18:19], v[22:23]
    v_pk_add_f32 v[54:55], v[18:19], v[22:23] neg_lo:[0,1] neg_hi:[0,1]
    v_pk_add_f32 v[16:17], v[48:49], v[52:53]
    v_pk_add_f32 v[18:19], v[48:49], v[52:53] neg_lo:[0,1] neg_hi:[0,1]
    v_pk_add_f32 v[20:21], v[50:51], v[54:55] op_sel:[0,1] op_sel_hi:[1,0] neg_hi:[0,1]
    v_pk_add_f32 v[22:23], v[50:51], v[54:55] op_sel:[0,1] op_sel_hi:[1,0] neg_lo:[0,1]
    v_pk_add_f32 v[48:49], v[24:25], v[28:29]
    v_pk_add_f32 v[50:51], v[24:25], v[28:29] neg_lo:[0,1] neg_hi:[0,1]
    v_pk_add_f32 v[52:53], v[26:27], v[30:31]
    v_pk_add_f32 v[54:55], v[26:27], v[30:31] neg_lo:[0,1] neg_hi:[0,1]
    v_pk_add_f32 v[24:25], v[48:49], v[52:53]
    v_pk_add_f32 v[26:27], v[48:49], v[52:53] neg_lo:[0,1] neg_hi:[0,1]
    v_pk_add_f32 v[28:29], v[50:51], v[54:55] op_sel:[0,1] op_sel_hi:[1,0] neg_hi:[0,1]
    v_pk_add_f32 v[30:31], v[50:51], v[54:55] op_sel:[0,1] op_sel_hi:[1,0] neg_lo:[0,1]
    v_pk_add_f32 v[48:49], v[32:33], v[36:37]
    v_pk_add_f32 v[50:51], v[32:33], v[36:37] neg_lo:[0,1] neg_hi:[0,1]
    v_pk_add_f32 v[52:53], v[34:35], v[38:39]
    v_pk_add_f32 v[54:55], v[34:35], v[38:39] neg_lo:[0,1] neg_hi:[0,1]
    v_pk_add_f32 v[32:33], v[48:49], v[52:53]
    v_pk_add_f32 v[34:35], v[48:49], v[52:53] neg_lo:[0,1] neg_hi:[0,1]
    v_pk_add_f32 v[36:37], v[50:51], v[54:55] op_sel:[0,1] op_sel_hi:[1,0] neg_hi:[0,1]
    v_pk_add_f32 v[38:39], v[50:51], v[54:55] op_sel:[0,1] op_sel_hi:[1,0] neg_lo:[0,1]
    v_pk_add_f32 v[48:49], v[40:41], v[44:45]
    v_pk_add_f32 v[50:51], v[40:41], v[44:45] neg_lo:[0,1] neg_hi:[0,1]
    v_pk_add_f32 v[52:53], v[42:43], v[46:47]
    v_pk_add_f32 v[54:55], v[42:43], v[46:47] neg_lo:[0,1] neg_hi:[0,1]
    v_pk_add_f32 v[40:41], v[48:49], v[52:53]
    v_pk_add_f32 v[42:43], v[48:49], v[52:53] neg_lo:[0,1] neg_hi:[0,1]
    v_pk_add_f32 v[44:45], v[50:51], v[54:55] op_sel:[0,1] op_sel_hi:[1,0] neg_hi:[0,1]
    v_pk_add_f32 v[46:47], v[50:51], v[54:55] op_sel:[0,1] op_sel_hi:[1,0] neg_lo:[0,1]
    v_lshl_add_u32 v6, v1, 3, v4
    ds_write_b64 v6, v[16:17] offset:0
    ds_write_b64 v6, v[20:21] offset:2176
    ds_write_b64 v6, v[18:19] offset:4352
    ds_write_b64 v6, v[22:23] offset:6528
    ds_write_b64 v6, v[24:25] offset:544
    ds_write_b64 v6, v[28:29] offset:2720
    ds_write_b64 v6, v[26:27] offset:4896
    ds_write_b64 v6, v[30:31] offset:7072
    ds_write_b64 v6, v[32:33] offset:1088
    ds_write_b64 v6, v[36:37] offset:3264
    ds_write_b64 v6, v[34:35] offset:5440
    ds_write_b64 v6, v[38:39] offset:7616
    ds_write_b64 v6, v[40:41] offset:1632
    ds_write_b64 v6, v[44:45] offset:3808
    ds_write_b64 v6, v[42:43] offset:5984
    ds_write_b64 v6, v[46:47] offset:8160
    s_waitcnt lgkmcnt(0)
    s_barrier
    v_and_b32 v5, 3, v0
    v_mul_u32_u24 v6, 8768, v5
    v_lshrrev_b32 v7, 2, v0
    v_lshl_add_u32 v8, v5, 1, s16
    v_lshlrev_b32 v8, 3, v8
    v_add_u32 v9, 0, v7
    v_lshrrev_b32 v10, 6, v9
    v_lshl_add_u32 v10, v10, 2, v9
    v_lshlrev_b32 v10, 3, v10
    v_add_u32 v10, v10, v6
    ds_read_b64 v[16:17], v10
    v_sub_u32 v11, 1024, v9
    v_and_b32 v11, 1023, v11
    v_lshrrev_b32 v12, 6, v11
    v_lshl_add_u32 v12, v12, 2, v11
    v_lshlrev_b32 v12, 3, v12
    v_add_u32 v12, v12, v6
    ds_read_b64 v[18:19], v12
    v_add_u32 v9, 64, v7
    v_lshrrev_b32 v10, 6, v9
    v_lshl_add_u32 v10, v10, 2, v9
    v_lshlrev_b32 v10, 3, v10
    v_add_u32 v10, v10, v6
    ds_read_b64 v[20:21], v10
    v_sub_u32 v11, 1024, v9
    v_and_b32 v11, 1023, v11
    v_lshrrev_b32 v12, 6, v11
    v_lshl_add_u32 v12, v12, 2, v11
    v_lshlrev_b32 v12, 3, v12
    v_add_u32 v12, v12, v6
    ds_read_b64 v[22:23], v12
    v_add_u32 v9, 128, v7
    v_lshrrev_b32 v10, 6, v9
    v_lshl_add_u32 v10, v10, 2, v9
    v_lshlrev_b32 v10, 3, v10
    v_add_u32 v10, v10, v6
    ds_read_b64 v[24:25], v10
    v_sub_u32 v11, 1024, v9
    v_and_b32 v11, 1023, v11
    v_lshrrev_b32 v12, 6, v11
    v_lshl_add_u32 v12, v12, 2, v11
    v_lshlrev_b32 v12, 3, v12
    v_add_u32 v12, v12, v6
    ds_read_b64 v[26:27], v12
    v_add_u32 v9, 192, v7
    v_lshrrev_b32 v10, 6, v9
    v_lshl_add_u32 v10, v10, 2, v9
    v_lshlrev_b32 v10, 3, v10
    v_add_u32 v10, v10, v6
    ds_read_b64 v[28:29], v10
    v_sub_u32 v11, 1024, v9
    v_and_b32 v11, 1023, v11
    v_lshrrev_b32 v12, 6, v11
    v_lshl_add_u32 v12, v12, 2, v11
    v_lshlrev_b32 v12, 3, v12
    v_add_u32 v12, v12, v6
    ds_read_b64 v[30:31], v12
    v_add_u32 v9, 256, v7
    v_lshrrev_b32 v10, 6, v9
    v_lshl_add_u32 v10, v10, 2, v9
    v_lshlrev_b32 v10, 3, v10
    v_add_u32 v10, v10, v6
    ds_read_b64 v[32:33], v10
    v_sub_u32 v11, 1024, v9
    v_and_b32 v11, 1023, v11
    v_lshrrev_b32 v12, 6, v11
    v_lshl_add_u32 v12, v12, 2, v11
    v_lshlrev_b32 v12, 3, v12
    v_add_u32 v12, v12, v6
    ds_read_b64 v[34:35], v12
    v_add_u32 v9, 320, v7
    v_lshrrev_b32 v10, 6, v9
    v_lshl_add_u32 v10, v10, 2, v9
    v_lshlrev_b32 v10, 3, v10
    v_add_u32 v10, v10, v6
    ds_read_b64 v[36:37], v10
    v_sub_u32 v11, 1024, v9
    v_and_b32 v11, 1023, v11
    v_lshrrev_b32 v12, 6, v11
    v_lshl_add_u32 v12, v12, 2, v11
    v_lshlrev_b32 v12, 3, v12
    v_add_u32 v12, v12, v6
    ds_read_b64 v[38:39], v12
    v_add_u32 v9, 384, v7
    v_lshrrev_b32 v10, 6, v9
    v_lshl_add_u32 v10, v10, 2, v9
    v_lshlrev_b32 v10, 3, v10
    v_add_u32 v10, v10, v6
    ds_read_b64 v[40:41], v10
    v_sub_u32 v11, 1024, v9
    v_and_b32 v11, 1023, v11
    v_lshrrev_b32 v12, 6, v11
    v_lshl_add_u32 v12, v12, 2, v11
    v_lshlrev_b32 v12, 3, v12
    v_add_u32 v12, v12, v6
    ds_read_b64 v[42:43], v12
    v_add_u32 v9, 448, v7
    v_lshrrev_b32 v10, 6, v9
    v_lshl_add_u32 v10, v10, 2, v9
    v_lshlrev_b32 v10, 3, v10
    v_add_u32 v10, v10, v6
    ds_read_b64 v[44:45], v10
    v_sub_u32 v11, 1024, v9
    v_and_b32 v11, 1023, v11
    v_lshrrev_b32 v12, 6, v11
    v_lshl_add_u32 v12, v12, 2, v11
    v_lshlrev_b32 v12, 3, v12
    v_add_u32 v12, v12, v6
    ds_read_b64 v[46:47], v12
    v_add_u32 v9, 512, v7
    v_lshrrev_b32 v10, 6, v9
    v_lshl_add_u32 v10, v10, 2, v9
    v_lshlrev_b32 v10, 3, v10
    v_add_u32 v10, v10, v6
    ds_read_b64 v[48:49], v10
    v_sub_u32 v11, 1024, v9
    v_and_b32 v11, 1023, v11
    v_lshrrev_b32 v12, 6, v11
    v_lshl_add_u32 v12, v12, 2, v11
    v_lshlrev_b32 v12, 3, v12
    v_add_u32 v12, v12, v6
    ds_read_b64 v[50:51], v12
    s_waitcnt lgkmcnt(0)
    v_add_f32 v112, v16, v18
    v_sub_f32 v113, v17, v19
    v_add_f32 v114, v17, v19
    v_sub_f32 v115, v18, v16
    v_add_u32 v9, 0, v7
    v_lshl_add_u32 v9, v9, 14, v8
    buffer_store_dwordx4 v[112:115], v9, s[12:15], 0 offen
    v_add_f32 v116, v20, v22
    v_sub_f32 v117, v21, v23
    v_add_f32 v118, v21, v23
    v_sub_f32 v119, v22, v20
    v_add_u32 v9, 64, v7
    v_lshl_add_u32 v9, v9, 14, v8
    buffer_store_dwordx4 v[116:119], v9, s[12:15], 0 offen
    v_add_f32 v112, v24, v26
    v_sub_f32 v113, v25, v27
    v_add_f32 v114, v25, v27
    v_sub_f32 v115, v26, v24
    v_add_u32 v9, 128, v7
    v_lshl_add_u32 v9, v9, 14, v8
    buffer_store_dwordx4 v[112:115], v9, s[12:15], 0 offen
    v_add_f32 v116, v28, v30
    v_sub_f32 v117, v29, v31
    v_add_f32 v118, v29, v31
    v_sub_f32 v119, v30, v28
    v_add_u32 v9, 192, v7
    v_lshl_add_u32 v9, v9, 14, v8
    buffer_store_dwordx4 v[116:119], v9, s[12:15], 0 offen
    v_add_f32 v112, v32, v34
    v_sub_f32 v113, v33, v35
    v_add_f32 v114, v33, v35
    v_sub_f32 v115, v34, v32
    v_add_u32 v9, 256, v7
    v_lshl_add_u32 v9, v9, 14, v8
    buffer_store_dwordx4 v[112:115], v9, s[12:15], 0 offen
    v_add_f32 v116, v36, v38
    v_sub_f32 v117, v37, v39
    v_add_f32 v118, v37, v39
    v_sub_f32 v119, v38, v36
    v_add_u32 v9, 320, v7
    v_lshl_add_u32 v9, v9, 14, v8
    buffer_store_dwordx4 v[116:119], v9, s[12:15], 0 offen
    v_add_f32 v112, v40, v42
    v_sub_f32 v113, v41, v43
    v_add_f32 v114, v41, v43
    v_sub_f32 v115, v42, v40
    v_add_u32 v9, 384, v7
    v_lshl_add_u32 v9, v9, 14, v8
    buffer_store_dwordx4 v[112:115], v9, s[12:15], 0 offen
    v_add_f32 v116, v44, v46
    v_sub_f32 v117, v45, v47
    v_add_f32 v118, v45, v47
    v_sub_f32 v119, v46, v44
    v_add_u32 v9, 448, v7
    v_lshl_add_u32 v9, v9, 14, v8
    buffer_store_dwordx4 v[116:119], v9, s[12:15], 0 offen
    v_add_f32 v112, v48, v50
    v_sub_f32 v113, v49, v51
    v_add_f32 v114, v49, v51
    v_sub_f32 v115, v50, v48
    v_add_u32 v9, 512, v7
    v_lshl_add_u32 v9, v9, 14, v8
    buffer_store_dwordx4 v[112:115], v9, s[12:15], 0 offen
    s_branch fa_end
fa_aux:
    s_sub_u32 s2, s2, 256
    s_lshl_b32 s16, s2, 3
    v_and_b32 v5, 3, v0
    v_lshrrev_b32 v7, 2, v0
    v_lshl_add_u32 v8, v5, 1, s16
    v_mul_u32_u24 v9, 1026, v8
    v_lshl_add_u32 v9, v7, 1, v9
    v_lshlrev_b32 v8, 3, v8
    buffer_load_ushort v52, v9, s[24:27], 0 offen offset:0
    buffer_load_ushort v53, v9, s[28:31], 0 offen offset:0
    buffer_load_ushort v54, v9, s[24:27], 0 offen offset:1026
    buffer_load_ushort v55, v9, s[28:31], 0 offen offset:1026
    buffer_load_ushort v56, v9, s[24:27], 0 offen offset:128
    buffer_load_ushort v57, v9, s[28:31], 0 offen offset:128
    buffer_load_ushort v58, v9, s[24:27], 0 offen offset:1154
    buffer_load_ushort v59, v9, s[28:31], 0 offen offset:1154
    buffer_load_ushort v60, v9, s[24:27], 0 offen offset:256
    buffer_load_ushort v61, v9, s[28:31], 0 offen offset:256
    buffer_load_ushort v62, v9, s[24:27], 0 offen offset:1282
    buffer_load_ushort v63, v9, s[28:31], 0 offen offset:1282
    buffer_load_ushort v64, v9, s[24:27], 0 offen offset:384
    buffer_load_ushort v65, v9, s[28:31], 0 offen offset:384
    buffer_load_ushort v66, v9, s[24:27], 0 offen offset:1410
    buffer_load_ushort v67, v9, s[28:31], 0 offen offset:1410
    buffer_load_ushort v68, v9, s[24:27], 0 offen offset:512
    buffer_load_ushort v69, v9, s[28:31], 0 offen offset:512
    buffer_load_ushort v70, v9, s[24:27], 0 offen offset:1538
    buffer_load_ushort v71, v9, s[28:31], 0 offen offset:1538
    buffer_load_ushort v72, v9, s[24:27], 0 offen offset:640
    buffer_load_ushort v73, v9, s[28:31], 0 offen offset:640
    buffer_load_ushort v74, v9, s[24:27], 0 offen offset:1666
    buffer_load_ushort v75, v9, s[28:31], 0 offen offset:1666
    buffer_load_ushort v76, v9, s[24:27], 0 offen offset:768
    buffer_load_ushort v77, v9, s[28:31], 0 offen offset:768
    buffer_load_ushort v78, v9, s[24:27], 0 offen offset:1794
    buffer_load_ushort v79, v9, s[28:31], 0 offen offset:1794
    buffer_load_ushort v80, v9, s[24:27], 0 offen offset:896
    buffer_load_ushort v81, v9, s[28:31], 0 offen offset:896
    buffer_load_ushort v82, v9, s[24:27], 0 offen offset:1922
    buffer_load_ushort v83, v9, s[28:31], 0 offen offset:1922
    buffer_load_ushort v84, v9, s[24:27], 0 offen offset:1024
    buffer_load_ushort v85, v9, s[28:31], 0 offen offset:1024
    buffer_load_ushort v86, v9, s[24:27], 0 offen offset:2050
    buffer_load_ushort v87, v9, s[28:31], 0 offen offset:2050
    s_lshl_b32 s17, s2, 8
    v_add_u32 v10, s17, v0
    v_lshlrev_b32 v112, 16, v10
    s_mov_b32 s52, 0xbfb8aa3b
    s_mov_b32 s53, 0x3f317218
    s_mov_b32 s54, 0x3a800000
    s_mov_b32 s55, 0xc038aa3b
    s_mov_b32 s56, 0x3e000000
    s_mov_b32 s57, 0x3e088889
    s_mov_b32 s58, 0xbeaaaaab
    v_mul_f32 v114, s52, abs(v112)
    v_exp_f32 v114, v114
    s_nop 0
    v_cvt_pk_bf16_f32 v114, v114, v114
    v_lshlrev_b32 v114, 16, v114
    v_add_f32 v115, 1.0, v114
    v_log_f32 v115, v115
    v_fma_f32 v116, v114, -0.5, 1.0
    v_mul_f32 v115, s53, v115
    v_mul_f32 v116, v116, v114
    v_cmp_gt_f32 vcc, s54, v114
    s_nop 1
    v_cndmask_b32 v115, v115, v116, vcc
    v_cvt_pk_bf16_f32 v115, v115, v115
    v_lshlrev_b32 v115, 16, v115
    v_max_f32 v116, 0, v112
    v_cmp_u_f32 vcc, v112, v112
    s_nop 1
    v_cndmask_b32 v116, v116, v112, vcc
    v_add_f32 v115, v115, v116
    v_cvt_pk_bf16_f32 v115, v115, v115
    v_lshlrev_b32 v115, 16, v115
    v_mul_f32 v114, s55, v115
    v_exp_f32 v114, v114
    v_mul_f32 v117, v115, v115
    v_add_f32 v116, 1.0, v114
    v_rcp_f32 v116, v116
    v_sub_f32 v114, 1.0, v114
    v_mul_f32 v114, v114, v116
    v_mov_b32 v113, s58
    v_fma_f32 v116, v117, s57, v113
    v_fma_f32 v116, v116, v117, 1.0
    v_mul_f32 v116, v116, v115
    v_cmp_gt_f32 vcc, s56, v115
    s_nop 1
    v_cndmask_b32 v114, v114, v116, vcc
    v_cvt_pk_bf16_f32 v114, v114, v114
    v_lshlrev_b32 v114, 16, v114
    v_mul_f32 v112, v112, v114
    v_cvt_pk_bf16_f32 v112, v112, v112
    v_lshlrev_b32 v112, 16, v112
    v_lshlrev_b32 v10, 1, v10
    buffer_store_short_d16_hi v112, v10, s[36:39], 0 offen
    s_waitcnt vmcnt(1)
    v_lshlrev_b32 v52, 16, v52
    v_lshlrev_b32 v53, 16, v53
    v_lshlrev_b32 v54, 16, v54
    v_lshlrev_b32 v55, 16, v55
    v_add_u32 v10, 0, v7
    v_lshl_add_u32 v10, v10, 14, v8
    buffer_store_dwordx4 v[52:55], v10, s[32:35], 0 offen
    v_lshlrev_b32 v56, 16, v56
    v_lshlrev_b32 v57, 16, v57
    v_lshlrev_b32 v58, 16, v58
    v_lshlrev_b32 v59, 16, v59
    v_add_u32 v10, 64, v7
    v_lshl_add_u32 v10, v10, 14, v8
    buffer_store_dwordx4 v[56:59], v10, s[32:35], 0 offen
    v_lshlrev_b32 v60, 16, v60
    v_lshlrev_b32 v61, 16, v61
    v_lshlrev_b32 v62, 16, v62
    v_lshlrev_b32 v63, 16, v63
    v_add_u32 v10, 128, v7
    v_lshl_add_u32 v10, v10, 14, v8
    buffer_store_dwordx4 v[60:63], v10, s[32:35], 0 offen
    v_lshlrev_b32 v64, 16, v64
    v_lshlrev_b32 v65, 16, v65
    v_lshlrev_b32 v66, 16, v66
    v_lshlrev_b32 v67, 16, v67
    v_add_u32 v10, 192, v7
    v_lshl_add_u32 v10, v10, 14, v8
    buffer_store_dwordx4 v[64:67], v10, s[32:35], 0 offen
    v_lshlrev_b32 v68, 16, v68
    v_lshlrev_b32 v69, 16, v69
    v_lshlrev_b32 v70, 16, v70
    v_lshlrev_b32 v71, 16, v71
    v_add_u32 v10, 256, v7
    v_lshl_add_u32 v10, v10, 14, v8
    buffer_store_dwordx4 v[68:71], v10, s[32:35], 0 offen
    v_lshlrev_b32 v72, 16, v72
    v_lshlrev_b32 v73, 16, v73
    v_lshlrev_b32 v74, 16, v74
    v_lshlrev_b32 v75, 16, v75
    v_add_u32 v10, 320, v7
    v_lshl_add_u32 v10, v10, 14, v8
    buffer_store_dwordx4 v[72:75], v10, s[32:35], 0 offen
    v_lshlrev_b32 v76, 16, v76
    v_lshlrev_b32 v77, 16, v77
    v_lshlrev_b32 v78, 16, v78
    v_lshlrev_b32 v79, 16, v79
    v_add_u32 v10, 384, v7
    v_lshl_add_u32 v10, v10, 14, v8
    buffer_store_dwordx4 v[76:79], v10, s[32:35], 0 offen
    v_lshlrev_b32 v80, 16, v80
    v_lshlrev_b32 v81, 16, v81
    v_lshlrev_b32 v82, 16, v82
    v_lshlrev_b32 v83, 16, v83
    v_add_u32 v10, 448, v7
    v_lshl_add_u32 v10, v10, 14, v8
    buffer_store_dwordx4 v[80:83], v10, s[32:35], 0 offen
    v_lshlrev_b32 v84, 16, v84
    v_lshlrev_b32 v85, 16, v85
    v_lshlrev_b32 v86, 16, v86
    v_lshlrev_b32 v87, 16, v87
    v_add_u32 v10, 512, v7
    v_lshl_add_u32 v10, v10, 14, v8
    buffer_store_dwordx4 v[84:87], v10, s[32:35], 0 offen
fa_end:
    s_endpgm
.globl fft_b_kernel
.p2align 8
.type fft_b_kernel,@function
fft_b_kernel:
    s_load_dwordx2 s[64:65], s[0:1], 32
    s_load_dwordx2 s[66:67], s[0:1], 48
    s_load_dwordx2 s[16:17], s[0:1], 72
    s_cmp_ge_u32 s2, 513
    s_cbranch_scc1 fb_end
    s_waitcnt lgkmcnt(0)
    s_add_u32 s8, s16, 50331648
    s_addc_u32 s9, s17, 0
    s_and_b32 s9, s9, 0xffff
    s_mov_b32 s10, 8404992
    s_mov_b32 s11, 0x00020000
    s_mov_b32 s20, s16
    s_and_b32 s21, s17, 0xffff
    s_mov_b32 s22, 8404992
    s_mov_b32 s23, 0x00020000
    s_add_u32 s12, s16, 67108864
    s_addc_u32 s13, s17, 0
    s_and_b32 s13, s13, 0xffff
    s_mov_b32 s14, 8404992
    s_mov_b32 s15, 0x00020000
    s_mov_b32 s32, s66
    s_and_b32 s33, s67, 0xffff
    s_mov_b32 s34, 7340032
    s_mov_b32 s35, 0x00020000
    s_mov_b32 s28, s64
    s_and_b32 s29, s65, 0xffff
    s_mov_b32 s30, 7340032
    s_mov_b32 s31, 0x00020000
    s_mov_b32 s40, 0x3f3504f3
    s_mov_b32 s41, 0xbf3504f3
    s_mov_b32 s42, 0x00000000
    s_mov_b32 s43, 0xbf800000
    s_mov_b32 s44, 0xbf3504f3
    s_mov_b32 s45, 0xbf3504f3
    s_mov_b32 s46, 0x3f3504f3
    s_mov_b32 s47, 0x3f3504f3
    s_mov_b32 s48, 0x00000000
    s_mov_b32 s49, 0x3f800000
    s_mov_b32 s50, 0xbf3504f3
    s_mov_b32 s51, 0x3f3504f3
    s_lshl_b32 s24, s2, 14
    v_lshlrev_b32 v1, 3, v0
    s_add_u32 s25, s24, 0
    buffer_load_dwordx2 v[24:25], v1, s[20:23], s25 offen
    s_add_u32 s25, s24, 2048
    buffer_load_dwordx2 v[26:27], v1, s[20:23], s25 offen
    s_add_u32 s25, s24, 4096
    buffer_load_dwordx2 v[28:29], v1, s[20:23], s25 offen
    s_add_u32 s25, s24, 6144
    buffer_load_dwordx2 v[30:31], v1, s[20:23], s25 offen
    s_add_u32 s25, s24, 8192
    buffer_load_dwordx2 v[32:33], v1, s[20:23], s25 offen
    s_add_u32 s25, s24, 10240
    buffer_load_dwordx2 v[34:35], v1, s[20:23], s25 offen
    s_add_u32 s25, s24, 12288
    buffer_load_dwordx2 v[36:37], v1, s[20:23], s25 offen
    s_add_u32 s25, s24, 14336
    buffer_load_dwordx2 v[38:39], v1, s[20:23], s25 offen
    v_lshrrev_b32 v2, 6, v0
    v_bfe_u32 v3, v0, 3, 3
    v_lshl_add_u32 v2, v3, 3, v2
    v_and_b32 v3, 7, v0
    v_lshl_add_u32 v2, v3, 6, v2
    v_lshlrev_b32 v2, 3, v2
    s_add_u32 s25, s24, 0
    buffer_load_dwordx2 v[40:41], v2, s[8:11], s25 offen
    s_add_u32 s25, s24, 4096
    buffer_load_dwordx2 v[42:43], v2, s[8:11], s25 offen
    s_add_u32 s25, s24, 8192
    buffer_load_dwordx2 v[44:45], v2, s[8:11], s25 offen
    s_add_u32 s25, s24, 12288
    buffer_load_dwordx2 v[46:47], v2, s[8:11], s25 offen
    s_add_u32 s25, s24, 32
    buffer_load_dwordx2 v[48:49], v2, s[8:11], s25 offen
    s_add_u32 s25, s24, 4128
    buffer_load_dwordx2 v[50:51], v2, s[8:11], s25 offen
    s_add_u32 s25, s24, 8224
    buffer_load_dwordx2 v[52:53], v2, s[8:11], s25 offen
    s_add_u32 s25, s24, 12320
    buffer_load_dwordx2 v[54:55], v2, s[8:11], s25 offen
    s_lshl_b32 s36, s2, 8
    v_add_u32 v3, s36, v0
    v_lshlrev_b32 v3, 7, v3
    buffer_load_dword v8, v3, s[28:31], 0 offen
    v_subrev_u32 v3, 7340032, v3
    buffer_load_dword v9, v3, s[32:35], 0 offen
    v_lshrrev_b32 v5, 5, v0
    v_lshl_add_u32 v5, v5, 2, v0
    v_lshlrev_b32 v5, 3, v5
    v_cvt_f32_u32 v4, v0
    s_waitcnt vmcnt(10)
    v_pk_add_f32 v[56:57], v[24:25], v[32:33]
    v_pk_add_f32 v[58:59], v[24:25], v[32:33] neg_lo:[0,1] neg_hi:[0,1]
    v_pk_add_f32 v[60:61], v[28:29], v[36:37]
    v_pk_add_f32 v[62:63], v[28:29], v[36:37] neg_lo:[0,1] neg_hi:[0,1]
    v_pk_add_f32 v[24:25], v[56:57], v[60:61]
    v_pk_add_f32 v[28:29], v[56:57], v[60:61] neg_lo:[0,1] neg_hi:[0,1]
    v_pk_add_f32 v[32:33], v[58:59], v[62:63] op_sel:[0,1] op_sel_hi:[1,0] neg_hi:[0,1]
    v_pk_add_f32 v[36:37], v[58:59], v[62:63] op_sel:[0,1] op_sel_hi:[1,0] neg_lo:[0,1]
    v_pk_add_f32 v[56:57], v[26:27], v[34:35]
    v_pk_add_f32 v[58:59], v[26:27], v[34:35] neg_lo:[0,1] neg_hi:[0,1]
    v_pk_add_f32 v[60:61], v[30:31], v[38:39]
    v_pk_add_f32 v[62:63], v[30:31], v[38:39] neg_lo:[0,1] neg_hi:[0,1]
    v_pk_add_f32 v[26:27], v[56:57], v[60:61]
    v_pk_add_f32 v[30:31], v[56:57], v[60:61] neg_lo:[0,1] neg_hi:[0,1]
    v_pk_add_f32 v[34:35], v[58:59], v[62:63] op_sel:[0,1] op_sel_hi:[1,0] neg_hi:[0,1]
    v_pk_add_f32 v[38:39], v[58:59], v[62:63] op_sel:[0,1] op_sel_hi:[1,0] neg_lo:[0,1]
    v_pk_mul_f32 v[56:57], v[34:35], s[40:41] op_sel:[0,0] op_sel_hi:[1,0]
    v_pk_fma_f32 v[58:59], v[34:35], s[40:41], v[56:57] op_sel:[1,1,0] op_sel_hi:[0,1,1] neg_lo:[1,0,0]
    v_pk_mul_f32 v[34:35], v[30:31], s[42:43] op_sel:[0,0] op_sel_hi:[1,0]
    v_pk_fma_f32 v[56:57], v[30:31], s[42:43], v[34:35] op_sel:[1,1,0] op_sel_hi:[0,1,1] neg_lo:[1,0,0]
    v_pk_mul_f32 v[30:31], v[38:39], s[44:45] op_sel:[0,0] op_sel_hi:[1,0]
    v_pk_fma_f32 v[34:35], v[38:39], s[44:45], v[30:31] op_sel:[1,1,0] op_sel_hi:[0,1,1] neg_lo:[1,0,0]
    v_pk_add_f32 v[30:31], v[24:25], v[26:27]
    v_pk_add_f32 v[38:39], v[24:25], v[26:27] neg_lo:[0,1] neg_hi:[0,1]
    v_pk_add_f32 v[24:25], v[32:33], v[58:59]
    v_pk_add_f32 v[26:27], v[32:33], v[58:59] neg_lo:[0,1] neg_hi:[0,1]
    v_pk_add_f32 v[32:33], v[28:29], v[56:57]
    v_pk_add_f32 v[58:59], v[28:29], v[56:57] neg_lo:[0,1] neg_hi:[0,1]
    v_pk_add_f32 v[28:29], v[36:37], v[34:35]
    v_pk_add_f32 v[56:57], v[36:37], v[34:35] neg_lo:[0,1] neg_hi:[0,1]
    v_mul_f32 v6, 0xba000000, v4
    v_cos_f32 v34, v6
    v_sin_f32 v35, v6
    s_nop 0
    v_pk_mul_f32 v[36:37], v[24:25], v[34:35] op_sel:[0,0] op_sel_hi:[1,0]
    v_pk_fma_f32 v[60:61], v[24:25], v[34:35], v[36:37] op_sel:[1,1,0] op_sel_hi:[0,1,1] neg_lo:[1,0,0]
    v_mul_f32 v6, 0xba800000, v4
    v_cos_f32 v24, v6
    v_sin_f32 v25, v6
    s_nop 0
    v_pk_mul_f32 v[34:35], v[32:33], v[24:25] op_sel:[0,0] op_sel_hi:[1,0]
    v_pk_fma_f32 v[36:37], v[32:33], v[24:25], v[34:35] op_sel:[1,1,0] op_sel_hi:[0,1,1] neg_lo:[1,0,0]
    v_mul_f32 v6, 0xbac00000, v4
    v_cos_f32 v24, v6
    v_sin_f32 v25, v6
    s_nop 0
    v_pk_mul_f32 v[32:33], v[28:29], v[24:25] op_sel:[0,0] op_sel_hi:[1,0]
    v_pk_fma_f32 v[34:35], v[28:29], v[24:25], v[32:33] op_sel:[1,1,0] op_sel_hi:[0,1,1] neg_lo:[1,0,0]
    v_mul_f32 v6, 0xbb000000, v4
    v_cos_f32 v24, v6
    v_sin_f32 v25, v6
    s_nop 0
    v_pk_mul_f32 v[28:29], v[38:39], v[24:25] op_sel:[0,0] op_sel_hi:[1,0]
    v_pk_fma_f32 v[32:33], v[38:39], v[24:25], v[28:29] op_sel:[1,1,0] op_sel_hi:[0,1,1] neg_lo:[1,0,0]
    v_mul_f32 v6, 0xbb200000, v4
    v_cos_f32 v24, v6
    v_sin_f32 v25, v6
    s_nop 0
    v_pk_mul_f32 v[28:29], v[26:27], v[24:25] op_sel:[0,0] op_sel_hi:[1,0]
    v_pk_fma_f32 v[38:39], v[26:27], v[24:25], v[28:29] op_sel:[1,1,0] op_sel_hi:[0,1,1] neg_lo:[1,0,0]
    v_mul_f32 v6, 0xbb400000, v4
    v_cos_f32 v24, v6
    v_sin_f32 v25, v6
    s_nop 0
    v_pk_mul_f32 v[26:27], v[58:59], v[24:25] op_sel:[0,0] op_sel_hi:[1,0]
    v_pk_fma_f32 v[28:29], v[58:59], v[24:25], v[26:27] op_sel:[1,1,0] op_sel_hi:[0,1,1] neg_lo:[1,0,0]
    v_mul_f32 v6, 0xbb600000, v4
    v_cos_f32 v24, v6
    v_sin_f32 v25, v6
    s_nop 0
    v_pk_mul_f32 v[26:27], v[56:57], v[24:25] op_sel:[0,0] op_sel_hi:[1,0]
    v_pk_fma_f32 v[58:59], v[56:57], v[24:25], v[26:27] op_sel:[1,1,0] op_sel_hi:[0,1,1] neg_lo:[1,0,0]
    ds_write_b64 v5, v[30:31] offset:0
    ds_write_b64 v5, v[60:61] offset:2304
    ds_write_b64 v5, v[36:37] offset:4608
    ds_write_b64 v5, v[34:35] offset:6912
    ds_write_b64 v5, v[32:33] offset:9216
    ds_write_b64 v5, v[38:39] offset:11520
    ds_write_b64 v5, v[28:29] offset:13824
    ds_write_b64 v5, v[58:59] offset:16128
    s_waitcnt lgkmcnt(0)
    s_barrier
    v_lshrrev_b32 v5, 5, v0
    v_mul_u32_u24 v5, 288, v5
    v_and_b32 v7, 31, v0
    v_add_u32 v5, v5, v7
    v_lshlrev_b32 v5, 3, v5
    v_cvt_f32_u32 v4, v7
    ds_read_b64 v[24:25], v5 offset:0
    ds_read_b64 v[26:27], v5 offset:288
    ds_read_b64 v[28:29], v5 offset:576
    ds_read_b64 v[30:31], v5 offset:864
    ds_read_b64 v[32:33], v5 offset:1152
    ds_read_b64 v[34:35], v5 offset:1440
    ds_read_b64 v[36:37], v5 offset:1728
    ds_read_b64 v[38:39], v5 offset:2016
    s_waitcnt lgkmcnt(0)
    v_pk_add_f32 v[56:57], v[24:25], v[32:33]
    v_pk_add_f32 v[58:59], v[24:25], v[32:33] neg_lo:[0,1] neg_hi:[0,1]
    v_pk_add_f32 v[60:61], v[28:29], v[36:37]
    v_pk_add_f32 v[62:63], v[28:29], v[36:37] neg_lo:[0,1] neg_hi:[0,1]
    v_pk_add_f32 v[24:25], v[56:57], v[60:61]
    v_pk_add_f32 v[28:29], v[56:57], v[60:61] neg_lo:[0,1] neg_hi:[0,1]
    v_pk_add_f32 v[32:33], v[58:59], v[62:63] op_sel:[0,1] op_sel_hi:[1,0] neg_hi:[0,1]
    v_pk_add_f32 v[36:37], v[58:59], v[62:63] op_sel:[0,1] op_sel_hi:[1,0] neg_lo:[0,1]
    v_pk_add_f32 v[56:57], v[26:27], v[34:35]
    v_pk_add_f32 v[58:59], v[26:27], v[34:35] neg_lo:[0,1] neg_hi:[0,1]
    v_pk_add_f32 v[60:61], v[30:31], v[38:39]
    v_pk_add_f32 v[62:63], v[30:31], v[38:39] neg_lo:[0,1] neg_hi:[0,1]
    v_pk_add_f32 v[26:27], v[56:57], v[60:61]
    v_pk_add_f32 v[30:31], v[56:57], v[60:61] neg_lo:[0,1] neg_hi:[0,1]
    v_pk_add_f32 v[34:35], v[58:59], v[62:63] op_sel:[0,1] op_sel_hi:[1,0] neg_hi:[0,1]
    v_pk_add_f32 v[38:39], v[58:59], v[62:63] op_sel:[0,1] op_sel_hi:[1,0] neg_lo:[0,1]
    v_pk_mul_f32 v[56:57], v[34:35], s[40:41] op_sel:[0,0] op_sel_hi:[1,0]
    v_pk_fma_f32 v[58:59], v[34:35], s[40:41], v[56:57] op_sel:[1,1,0] op_sel_hi:[0,1,1] neg_lo:[1,0,0]
    v_pk_mul_f32 v[34:35], v[30:31], s[42:43] op_sel:[0,0] op_sel_hi:[1,0]
    v_pk_fma_f32 v[56:57], v[30:31], s[42:43], v[34:35] op_sel:[1,1,0] op_sel_hi:[0,1,1] neg_lo:[1,0,0]
    v_pk_mul_f32 v[30:31], v[38:39], s[44:45] op_sel:[0,0] op_sel_hi:[1,0]
    v_pk_fma_f32 v[34:35], v[38:39], s[44:45], v[30:31] op_sel:[1,1,0] op_sel_hi:[0,1,1] neg_lo:[1,0,0]
    v_pk_add_f32 v[30:31], v[24:25], v[26:27]
    v_pk_add_f32 v[38:39], v[24:25], v[26:27] neg_lo:[0,1] neg_hi:[0,1]
    v_pk_add_f32 v[24:25], v[32:33], v[58:59]
    v_pk_add_f32 v[26:27], v[32:33], v[58:59] neg_lo:[0,1] neg_hi:[0,1]
    v_pk_add_f32 v[32:33], v[28:29], v[56:57]
    v_pk_add_f32 v[58:59], v[28:29], v[56:57] neg_lo:[0,1] neg_hi:[0,1]
    v_pk_add_f32 v[28:29], v[36:37], v[34:35]
    v_pk_add_f32 v[56:57], v[36:37], v[34:35] neg_lo:[0,1] neg_hi:[0,1]
    v_mul_f32 v6, 0xbb800000, v4
    v_cos_f32 v34, v6
    v_sin_f32 v35, v6
    s_nop 0
    v_pk_mul_f32 v[36:37], v[24:25], v[34:35] op_sel:[0,0] op_sel_hi:[1,0]
    v_pk_fma_f32 v[60:61], v[24:25], v[34:35], v[36:37] op_sel:[1,1,0] op_sel_hi:[0,1,1] neg_lo:[1,0,0]
    v_mul_f32 v6, 0xbc000000, v4
    v_cos_f32 v24, v6
    v_sin_f32 v25, v6
    s_nop 0
    v_pk_mul_f32 v[34:35], v[32:33], v[24:25] op_sel:[0,0] op_sel_hi:[1,0]
    v_pk_fma_f32 v[36:37], v[32:33], v[24:25], v[34:35] op_sel:[1,1,0] op_sel_hi:[0,1,1] neg_lo:[1,0,0]
    v_mul_f32 v6, 0xbc400000, v4
    v_cos_f32 v24, v6
    v_sin_f32 v25, v6
    s_nop 0
    v_pk_mul_f32 v[32:33], v[28:29], v[24:25] op_sel:[0,0] op_sel_hi:[1,0]
    v_pk_fma_f32 v[34:35], v[28:29], v[24:25], v[32:33] op_sel:[1,1,0] op_sel_hi:[0,1,1] neg_lo:[1,0,0]
    v_mul_f32 v6, 0xbc800000, v4
    v_cos_f32 v24, v6
    v_sin_f32 v25, v6
    s_nop 0
    v_pk_mul_f32 v[28:29], v[38:39], v[24:25] op_sel:[0,0] op_sel_hi:[1,0]
    v_pk_fma_f32 v[32:33], v[38:39], v[24:25], v[28:29] op_sel:[1,1,0] op_sel_hi:[0,1,1] neg_lo:[1,0,0]
    v_mul_f32 v6, 0xbca00000, v4
    v_cos_f32 v24, v6
    v_sin_f32 v25, v6
    s_nop 0
    v_pk_mul_f32 v[28:29], v[26:27], v[24:25] op_sel:[0,0] op_sel_hi:[1,0]
    v_pk_fma_f32 v[38:39], v[26:27], v[24:25], v[28:29] op_sel:[1,1,0] op_sel_hi:[0,1,1] neg_lo:[1,0,0]
    v_mul_f32 v6, 0xbcc00000, v4
    v_cos_f32 v24, v6
    v_sin_f32 v25, v6
    s_nop 0
    v_pk_mul_f32 v[26:27], v[58:59], v[24:25] op_sel:[0,0] op_sel_hi:[1,0]
    v_pk_fma_f32 v[28:29], v[58:59], v[24:25], v[26:27] op_sel:[1,1,0] op_sel_hi:[0,1,1] neg_lo:[1,0,0]
    v_mul_f32 v6, 0xbce00000, v4
    v_cos_f32 v24, v6
    v_sin_f32 v25, v6
    s_nop 0
    v_pk_mul_f32 v[26:27], v[56:57], v[24:25] op_sel:[0,0] op_sel_hi:[1,0]
    v_pk_fma_f32 v[58:59], v[56:57], v[24:25], v[26:27] op_sel:[1,1,0] op_sel_hi:[0,1,1] neg_lo:[1,0,0]
    ds_write_b64 v5, v[30:31] offset:0
    ds_write_b64 v5, v[60:61] offset:288
    ds_write_b64 v5, v[36:37] offset:576
    ds_write_b64 v5, v[34:35] offset:864
    ds_write_b64 v5, v[32:33] offset:1152
    ds_write_b64 v5, v[38:39] offset:1440
    ds_write_b64 v5, v[28:29] offset:1728
    ds_write_b64 v5, v[58:59] offset:2016
    s_waitcnt lgkmcnt(0)
    s_barrier
    v_lshrrev_b32 v5, 2, v0
    v_mul_u32_u24 v5, 36, v5
    v_and_b32 v7, 3, v0
    v_add_u32 v5, v5, v7
    v_lshlrev_b32 v5, 3, v5
    v_cvt_f32_u32 v4, v7
    ds_read_b64 v[24:25], v5 offset:0
    ds_read_b64 v[26:27], v5 offset:32
    ds_read_b64 v[28:29], v5 offset:64
    ds_read_b64 v[30:31], v5 offset:96
    ds_read_b64 v[32:33], v5 offset:128
    ds_read_b64 v[34:35], v5 offset:160
    ds_read_b64 v[36:37], v5 offset:192
    ds_read_b64 v[38:39], v5 offset:224
    s_waitcnt lgkmcnt(0)
    v_pk_add_f32 v[56:57], v[24:25], v[32:33]
    v_pk_add_f32 v[58:59], v[24:25], v[32:33] neg_lo:[0,1] neg_hi:[0,1]
    v_pk_add_f32 v[60:61], v[28:29], v[36:37]
    v_pk_add_f32 v[62:63], v[28:29], v[36:37] neg_lo:[0,1] neg_hi:[0,1]
    v_pk_add_f32 v[24:25], v[56:57], v[60:61]
    v_pk_add_f32 v[28:29], v[56:57], v[60:61] neg_lo:[0,1] neg_hi:[0,1]
    v_pk_add_f32 v[32:33], v[58:59], v[62:63] op_sel:[0,1] op_sel_hi:[1,0] neg_hi:[0,1]
    v_pk_add_f32 v[36:37], v[58:59], v[62:63] op_sel:[0,1] op_sel_hi:[1,0] neg_lo:[0,1]
    v_pk_add_f32 v[56:57], v[26:27], v[34:35]
    v_pk_add_f32 v[58:59], v[26:27], v[34:35] neg_lo:[0,1] neg_hi:[0,1]
    v_pk_add_f32 v[60:61], v[30:31], v[38:39]
    v_pk_add_f32 v[62:63], v[30:31], v[38:39] neg_lo:[0,1] neg_hi:[0,1]
    v_pk_add_f32 v[26:27], v[56:57], v[60:61]
    v_pk_add_f32 v[30:31], v[56:57], v[60:61] neg_lo:[0,1] neg_hi:[0,1]
    v_pk_add_f32 v[34:35], v[58:59], v[62:63] op_sel:[0,1] op_sel_hi:[1,0] neg_hi:[0,1]
    v_pk_add_f32 v[38:39], v[58:59], v[62:63] op_sel:[0,1] op_sel_hi:[1,0] neg_lo:[0,1]
    v_pk_mul_f32 v[56:57], v[34:35], s[40:41] op_sel:[0,0] op_sel_hi:[1,0]
    v_pk_fma_f32 v[58:59], v[34:35], s[40:41], v[56:57] op_sel:[1,1,0] op_sel_hi:[0,1,1] neg_lo:[1,0,0]
    v_pk_mul_f32 v[34:35], v[30:31], s[42:43] op_sel:[0,0] op_sel_hi:[1,0]
    v_pk_fma_f32 v[56:57], v[30:31], s[42:43], v[34:35] op_sel:[1,1,0] op_sel_hi:[0,1,1] neg_lo:[1,0,0]
    v_pk_mul_f32 v[30:31], v[38:39], s[44:45] op_sel:[0,0] op_sel_hi:[1,0]
    v_pk_fma_f32 v[34:35], v[38:39], s[44:45], v[30:31] op_sel:[1,1,0] op_sel_hi:[0,1,1] neg_lo:[1,0,0]
    v_pk_add_f32 v[30:31], v[24:25], v[26:27]
    v_pk_add_f32 v[38:39], v[24:25], v[26:27] neg_lo:[0,1] neg_hi:[0,1]
    v_pk_add_f32 v[24:25], v[32:33], v[58:59]
    v_pk_add_f32 v[26:27], v[32:33], v[58:59] neg_lo:[0,1] neg_hi:[0,1]
    v_pk_add_f32 v[32:33], v[28:29], v[56:57]
    v_pk_add_f32 v[58:59], v[28:29], v[56:57] neg_lo:[0,1] neg_hi:[0,1]
    v_pk_add_f32 v[28:29], v[36:37], v[34:35]
    v_pk_add_f32 v[56:57], v[36:37], v[34:35] neg_lo:[0,1] neg_hi:[0,1]
    v_mul_f32 v6, 0xbd000000, v4
    v_cos_f32 v34, v6
    v_sin_f32 v35, v6
    s_nop 0
    v_pk_mul_f32 v[36:37], v[24:25], v[34:35] op_sel:[0,0] op_sel_hi:[1,0]
    v_pk_fma_f32 v[60:61], v[24:25], v[34:35], v[36:37] op_sel:[1,1,0] op_sel_hi:[0,1,1] neg_lo:[1,0,0]
    v_mul_f32 v6, 0xbd800000, v4
    v_cos_f32 v24, v6
    v_sin_f32 v25, v6
    s_nop 0
    v_pk_mul_f32 v[34:35], v[32:33], v[24:25] op_sel:[0,0] op_sel_hi:[1,0]
    v_pk_fma_f32 v[36:37], v[32:33], v[24:25], v[34:35] op_sel:[1,1,0] op_sel_hi:[0,1,1] neg_lo:[1,0,0]
    v_mul_f32 v6, 0xbdc00000, v4
    v_cos_f32 v24, v6
    v_sin_f32 v25, v6
    s_nop 0
    v_pk_mul_f32 v[32:33], v[28:29], v[24:25] op_sel:[0,0] op_sel_hi:[1,0]
    v_pk_fma_f32 v[34:35], v[28:29], v[24:25], v[32:33] op_sel:[1,1,0] op_sel_hi:[0,1,1] neg_lo:[1,0,0]
    v_mul_f32 v6, 0xbe000000, v4
    v_cos_f32 v24, v6
    v_sin_f32 v25, v6
    s_nop 0
    v_pk_mul_f32 v[28:29], v[38:39], v[24:25] op_sel:[0,0] op_sel_hi:[1,0]
    v_pk_fma_f32 v[32:33], v[38:39], v[24:25], v[28:29] op_sel:[1,1,0] op_sel_hi:[0,1,1] neg_lo:[1,0,0]
    v_mul_f32 v6, 0xbe200000, v4
    v_cos_f32 v24, v6
    v_sin_f32 v25, v6
    s_nop 0
    v_pk_mul_f32 v[28:29], v[26:27], v[24:25] op_sel:[0,0] op_sel_hi:[1,0]
    v_pk_fma_f32 v[38:39], v[26:27], v[24:25], v[28:29] op_sel:[1,1,0] op_sel_hi:[0,1,1] neg_lo:[1,0,0]
    v_mul_f32 v6, 0xbe400000, v4
    v_cos_f32 v24, v6
    v_sin_f32 v25, v6
    s_nop 0
    v_pk_mul_f32 v[26:27], v[58:59], v[24:25] op_sel:[0,0] op_sel_hi:[1,0]
    v_pk_fma_f32 v[28:29], v[58:59], v[24:25], v[26:27] op_sel:[1,1,0] op_sel_hi:[0,1,1] neg_lo:[1,0,0]
    v_mul_f32 v6, 0xbe600000, v4
    v_cos_f32 v24, v6
    v_sin_f32 v25, v6
    s_nop 0
    v_pk_mul_f32 v[26:27], v[56:57], v[24:25] op_sel:[0,0] op_sel_hi:[1,0]
    v_pk_fma_f32 v[58:59], v[56:57], v[24:25], v[26:27] op_sel:[1,1,0] op_sel_hi:[0,1,1] neg_lo:[1,0,0]
    ds_write_b64 v5, v[30:31] offset:0
    ds_write_b64 v5, v[60:61] offset:32
    ds_write_b64 v5, v[36:37] offset:64
    ds_write_b64 v5, v[34:35] offset:96
    ds_write_b64 v5, v[32:33] offset:128
    ds_write_b64 v5, v[38:39] offset:160
    ds_write_b64 v5, v[28:29] offset:192
    ds_write_b64 v5, v[58:59] offset:224
    s_waitcnt lgkmcnt(0)
    s_barrier
    v_lshrrev_b32 v5, 3, v0
    v_add_u32 v5, v5, v0
    v_lshlrev_b32 v5, 5, v5
    ds_read_b64 v[24:25], v5 offset:0
    ds_read_b64 v[26:27], v5 offset:8
    ds_read_b64 v[28:29], v5 offset:16
    ds_read_b64 v[30:31], v5 offset:24
    ds_read_b64 v[32:33], v5 offset:9216
    ds_read_b64 v[34:35], v5 offset:9224
    ds_read_b64 v[36:37], v5 offset:9232
    ds_read_b64 v[38:39], v5 offset:9240
    s_waitcnt lgkmcnt(0)
    s_waitcnt vmcnt(0)
    v_pk_add_f32 v[56:57], v[24:25], v[28:29]
    v_pk_add_f32 v[58:59], v[24:25], v[28:29] neg_lo:[0,1] neg_hi:[0,1]
    v_pk_add_f32 v[60:61], v[26:27], v[30:31]
    v_pk_add_f32 v[62:63], v[26:27], v[30:31] neg_lo:[0,1] neg_hi:[0,1]
    v_pk_add_f32 v[24:25], v[56:57], v[60:61]
    v_pk_add_f32 v[26:27], v[56:57], v[60:61] neg_lo:[0,1] neg_hi:[0,1]
    v_pk_add_f32 v[28:29], v[58:59], v[62:63] op_sel:[0,1] op_sel_hi:[1,0] neg_hi:[0,1]
    v_pk_add_f32 v[30:31], v[58:59], v[62:63] op_sel:[0,1] op_sel_hi:[1,0] neg_lo:[0,1]
    v_pk_mul_f32 v[56:57], v[24:25], v[40:41] op_sel:[0,0] op_sel_hi:[1,0]
    v_pk_fma_f32 v[58:59], v[24:25], v[40:41], v[56:57] op_sel:[1,1,0] op_sel_hi:[0,1,1] neg_lo:[1,0,0]
    v_pk_mul_f32 v[24:25], v[28:29], v[42:43] op_sel:[0,0] op_sel_hi:[1,0]
    v_pk_fma_f32 v[40:41], v[28:29], v[42:43], v[24:25] op_sel:[1,1,0] op_sel_hi:[0,1,1] neg_lo:[1,0,0]
    v_pk_mul_f32 v[24:25], v[26:27], v[44:45] op_sel:[0,0] op_sel_hi:[1,0]
    v_pk_fma_f32 v[28:29], v[26:27], v[44:45], v[24:25] op_sel:[1,1,0] op_sel_hi:[0,1,1] neg_lo:[1,0,0]
    v_pk_mul_f32 v[24:25], v[30:31], v[46:47] op_sel:[0,0] op_sel_hi:[1,0]
    v_pk_fma_f32 v[26:27], v[30:31], v[46:47], v[24:25] op_sel:[1,1,0] op_sel_hi:[0,1,1] neg_lo:[1,0,0]
    v_pk_add_f32 v[24:25], v[58:59], v[28:29]
    v_pk_add_f32 v[30:31], v[58:59], v[28:29] neg_lo:[0,1] neg_hi:[0,1]
    v_pk_add_f32 v[42:43], v[40:41], v[26:27]
    v_pk_add_f32 v[44:45], v[40:41], v[26:27] neg_lo:[0,1] neg_hi:[0,1]
    v_pk_add_f32 v[26:27], v[24:25], v[42:43]
    v_pk_add_f32 v[28:29], v[24:25], v[42:43] neg_lo:[0,1] neg_hi:[0,1]
    v_pk_add_f32 v[40:41], v[30:31], v[44:45] op_sel:[0,1] op_sel_hi:[1,0] neg_lo:[0,1]
    v_pk_add_f32 v[46:47], v[30:31], v[44:45] op_sel:[0,1] op_sel_hi:[1,0] neg_hi:[0,1]
    v_pk_add_f32 v[24:25], v[32:33], v[36:37]
    v_pk_add_f32 v[30:31], v[32:33], v[36:37] neg_lo:[0,1] neg_hi:[0,1]
    v_pk_add_f32 v[42:43], v[34:35], v[38:39]
    v_pk_add_f32 v[44:45], v[34:35], v[38:39] neg_lo:[0,1] neg_hi:[0,1]
    v_pk_add_f32 v[32:33], v[24:25], v[42:43]
    v_pk_add_f32 v[34:35], v[24:25], v[42:43] neg_lo:[0,1] neg_hi:[0,1]
    v_pk_add_f32 v[36:37], v[30:31], v[44:45] op_sel:[0,1] op_sel_hi:[1,0] neg_hi:[0,1]
    v_pk_add_f32 v[38:39], v[30:31], v[44:45] op_sel:[0,1] op_sel_hi:[1,0] neg_lo:[0,1]
    v_pk_mul_f32 v[24:25], v[32:33], v[48:49] op_sel:[0,0] op_sel_hi:[1,0]
    v_pk_fma_f32 v[30:31], v[32:33], v[48:49], v[24:25] op_sel:[1,1,0] op_sel_hi:[0,1,1] neg_lo:[1,0,0]
    v_pk_mul_f32 v[24:25], v[36:37], v[50:51] op_sel:[0,0] op_sel_hi:[1,0]
    v_pk_fma_f32 v[32:33], v[36:37], v[50:51], v[24:25] op_sel:[1,1,0] op_sel_hi:[0,1,1] neg_lo:[1,0,0]
    v_pk_mul_f32 v[24:25], v[34:35], v[52:53] op_sel:[0,0] op_sel_hi:[1,0]
    v_pk_fma_f32 v[36:37], v[34:35], v[52:53], v[24:25] op_sel:[1,1,0] op_sel_hi:[0,1,1] neg_lo:[1,0,0]
    v_pk_mul_f32 v[24:25], v[38:39], v[54:55] op_sel:[0,0] op_sel_hi:[1,0]
    v_pk_fma_f32 v[34:35], v[38:39], v[54:55], v[24:25] op_sel:[1,1,0] op_sel_hi:[0,1,1] neg_lo:[1,0,0]
    v_pk_add_f32 v[24:25], v[30:31], v[36:37]
    v_pk_add_f32 v[38:39], v[30:31], v[36:37] neg_lo:[0,1] neg_hi:[0,1]
    v_pk_add_f32 v[42:43], v[32:33], v[34:35]
    v_pk_add_f32 v[44:45], v[32:33], v[34:35] neg_lo:[0,1] neg_hi:[0,1]
    v_pk_add_f32 v[30:31], v[24:25], v[42:43]
    v_pk_add_f32 v[32:33], v[24:25], v[42:43] neg_lo:[0,1] neg_hi:[0,1]
    v_pk_add_f32 v[34:35], v[38:39], v[44:45] op_sel:[0,1] op_sel_hi:[1,0] neg_lo:[0,1]
    v_pk_add_f32 v[36:37], v[38:39], v[44:45] op_sel:[0,1] op_sel_hi:[1,0] neg_hi:[0,1]
    ds_write_b64 v5, v[26:27] offset:0
    ds_write_b64 v5, v[40:41] offset:8
    ds_write_b64 v5, v[28:29] offset:16
    ds_write_b64 v5, v[46:47] offset:24
    ds_write_b64 v5, v[30:31] offset:9216
    ds_write_b64 v5, v[34:35] offset:9224
    ds_write_b64 v5, v[32:33] offset:9232
    ds_write_b64 v5, v[36:37] offset:9240
    s_waitcnt lgkmcnt(0)
    s_barrier
    v_lshrrev_b32 v5, 2, v0
    v_mul_u32_u24 v5, 36, v5
    v_and_b32 v7, 3, v0
    v_add_u32 v5, v5, v7
    v_lshlrev_b32 v5, 3, v5
    v_cvt_f32_u32 v4, v7
    ds_read_b64 v[24:25], v5 offset:0
    ds_read_b64 v[26:27], v5 offset:32
    ds_read_b64 v[28:29], v5 offset:64
    ds_read_b64 v[30:31], v5 offset:96
    ds_read_b64 v[32:33], v5 offset:128
    ds_read_b64 v[34:35], v5 offset:160
    ds_read_b64 v[36:37], v5 offset:192
    ds_read_b64 v[38:39], v5 offset:224
    s_waitcnt lgkmcnt(0)
    v_mul_f32 v6, 0x3d000000, v4
    v_cos_f32 v40, v6
    v_sin_f32 v41, v6
    s_nop 0
    v_pk_mul_f32 v[42:43], v[26:27], v[40:41] op_sel:[0,0] op_sel_hi:[1,0]
    v_pk_fma_f32 v[44:45], v[26:27], v[40:41], v[42:43] op_sel:[1,1,0] op_sel_hi:[0,1,1] neg_lo:[1,0,0]
    v_mul_f32 v6, 0x3d800000, v4
    v_cos_f32 v26, v6
    v_sin_f32 v27, v6
    s_nop 0
    v_pk_mul_f32 v[40:41], v[28:29], v[26:27] op_sel:[0,0] op_sel_hi:[1,0]
    v_pk_fma_f32 v[42:43], v[28:29], v[26:27], v[40:41] op_sel:[1,1,0] op_sel_hi:[0,1,1] neg_lo:[1,0,0]
    v_mul_f32 v6, 0x3dc00000, v4
    v_cos_f32 v26, v6
    v_sin_f32 v27, v6
    s_nop 0
    v_pk_mul_f32 v[28:29], v[30:31], v[26:27] op_sel:[0,0] op_sel_hi:[1,0]
    v_pk_fma_f32 v[40:41], v[30:31], v[26:27], v[28:29] op_sel:[1,1,0] op_sel_hi:[0,1,1] neg_lo:[1,0,0]
    v_mul_f32 v6, 0x3e000000, v4
    v_cos_f32 v26, v6
    v_sin_f32 v27, v6
    s_nop 0
    v_pk_mul_f32 v[28:29], v[32:33], v[26:27] op_sel:[0,0] op_sel_hi:[1,0]
    v_pk_fma_f32 v[30:31], v[32:33], v[26:27], v[28:29] op_sel:[1,1,0] op_sel_hi:[0,1,1] neg_lo:[1,0,0]
    v_mul_f32 v6, 0x3e200000, v4
    v_cos_f32 v26, v6
    v_sin_f32 v27, v6
    s_nop 0
    v_pk_mul_f32 v[28:29], v[34:35], v[26:27] op_sel:[0,0] op_sel_hi:[1,0]
    v_pk_fma_f32 v[32:33], v[34:35], v[26:27], v[28:29] op_sel:[1,1,0] op_sel_hi:[0,1,1] neg_lo:[1,0,0]
    v_mul_f32 v6, 0x3e400000, v4
    v_cos_f32 v26, v6
    v_sin_f32 v27, v6
    s_nop 0
    v_pk_mul_f32 v[28:29], v[36:37], v[26:27] op_sel:[0,0] op_sel_hi:[1,0]
    v_pk_fma_f32 v[34:35], v[36:37], v[26:27], v[28:29] op_sel:[1,1,0] op_sel_hi:[0,1,1] neg_lo:[1,0,0]
    v_mul_f32 v6, 0x3e600000, v4
    v_cos_f32 v26, v6
    v_sin_f32 v27, v6
    s_nop 0
    v_pk_mul_f32 v[28:29], v[38:39], v[26:27] op_sel:[0,0] op_sel_hi:[1,0]
    v_pk_fma_f32 v[36:37], v[38:39], v[26:27], v[28:29] op_sel:[1,1,0] op_sel_hi:[0,1,1] neg_lo:[1,0,0]
    v_pk_add_f32 v[26:27], v[24:25], v[30:31]
    v_pk_add_f32 v[28:29], v[24:25], v[30:31] neg_lo:[0,1] neg_hi:[0,1]
    v_pk_add_f32 v[38:39], v[42:43], v[34:35]
    v_pk_add_f32 v[46:47], v[42:43], v[34:35] neg_lo:[0,1] neg_hi:[0,1]
    v_pk_add_f32 v[24:25], v[26:27], v[38:39]
    v_pk_add_f32 v[30:31], v[26:27], v[38:39] neg_lo:[0,1] neg_hi:[0,1]
    v_pk_add_f32 v[34:35], v[28:29], v[46:47] op_sel:[0,1] op_sel_hi:[1,0] neg_lo:[0,1]
    v_pk_add_f32 v[42:43], v[28:29], v[46:47] op_sel:[0,1] op_sel_hi:[1,0] neg_hi:[0,1]
    v_pk_add_f32 v[26:27], v[44:45], v[32:33]
    v_pk_add_f32 v[28:29], v[44:45], v[32:33] neg_lo:[0,1] neg_hi:[0,1]
    v_pk_add_f32 v[38:39], v[40:41], v[36:37]
    v_pk_add_f32 v[46:47], v[40:41], v[36:37] neg_lo:[0,1] neg_hi:[0,1]
    v_pk_add_f32 v[32:33], v[26:27], v[38:39]
    v_pk_add_f32 v[36:37], v[26:27], v[38:39] neg_lo:[0,1] neg_hi:[0,1]
    v_pk_add_f32 v[40:41], v[28:29], v[46:47] op_sel:[0,1] op_sel_hi:[1,0] neg_lo:[0,1]
    v_pk_add_f32 v[44:45], v[28:29], v[46:47] op_sel:[0,1] op_sel_hi:[1,0] neg_hi:[0,1]
    v_pk_mul_f32 v[26:27], v[40:41], s[46:47] op_sel:[0,0] op_sel_hi:[1,0]
    v_pk_fma_f32 v[28:29], v[40:41], s[46:47], v[26:27] op_sel:[1,1,0] op_sel_hi:[0,1,1] neg_lo:[1,0,0]
    v_pk_mul_f32 v[26:27], v[36:37], s[48:49] op_sel:[0,0] op_sel_hi:[1,0]
    v_pk_fma_f32 v[38:39], v[36:37], s[48:49], v[26:27] op_sel:[1,1,0] op_sel_hi:[0,1,1] neg_lo:[1,0,0]
    v_pk_mul_f32 v[26:27], v[44:45], s[50:51] op_sel:[0,0] op_sel_hi:[1,0]
    v_pk_fma_f32 v[36:37], v[44:45], s[50:51], v[26:27] op_sel:[1,1,0] op_sel_hi:[0,1,1] neg_lo:[1,0,0]
    v_pk_add_f32 v[26:27], v[24:25], v[32:33]
    v_pk_add_f32 v[40:41], v[24:25], v[32:33] neg_lo:[0,1] neg_hi:[0,1]
    v_pk_add_f32 v[24:25], v[34:35], v[28:29]
    v_pk_add_f32 v[32:33], v[34:35], v[28:29] neg_lo:[0,1] neg_hi:[0,1]
    v_pk_add_f32 v[28:29], v[30:31], v[38:39]
    v_pk_add_f32 v[34:35], v[30:31], v[38:39] neg_lo:[0,1] neg_hi:[0,1]
    v_pk_add_f32 v[30:31], v[42:43], v[36:37]
    v_pk_add_f32 v[38:39], v[42:43], v[36:37] neg_lo:[0,1] neg_hi:[0,1]
    ds_write_b64 v5, v[26:27] offset:0
    ds_write_b64 v5, v[24:25] offset:32
    ds_write_b64 v5, v[28:29] offset:64
    ds_write_b64 v5, v[30:31] offset:96
    ds_write_b64 v5, v[40:41] offset:128
    ds_write_b64 v5, v[32:33] offset:160
    ds_write_b64 v5, v[34:35] offset:192
    ds_write_b64 v5, v[38:39] offset:224
    s_waitcnt lgkmcnt(0)
    s_barrier
    v_lshrrev_b32 v5, 5, v0
    v_mul_u32_u24 v5, 288, v5
    v_and_b32 v7, 31, v0
    v_add_u32 v5, v5, v7
    v_lshlrev_b32 v5, 3, v5
    v_cvt_f32_u32 v4, v7
    ds_read_b64 v[24:25], v5 offset:0
    ds_read_b64 v[26:27], v5 offset:288
    ds_read_b64 v[28:29], v5 offset:576
    ds_read_b64 v[30:31], v5 offset:864
    ds_read_b64 v[32:33], v5 offset:1152
    ds_read_b64 v[34:35], v5 offset:1440
    ds_read_b64 v[36:37], v5 offset:1728
    ds_read_b64 v[38:39], v5 offset:2016
    s_waitcnt lgkmcnt(0)
    v_mul_f32 v6, 0x3b800000, v4
    v_cos_f32 v40, v6
    v_sin_f32 v41, v6
    s_nop 0
    v_pk_mul_f32 v[42:43], v[26:27], v[40:41] op_sel:[0,0] op_sel_hi:[1,0]
    v_pk_fma_f32 v[44:45], v[26:27], v[40:41], v[42:43] op_sel:[1,1,0] op_sel_hi:[0,1,1] neg_lo:[1,0,0]
    v_mul_f32 v6, 0x3c000000, v4
    v_cos_f32 v26, v6
    v_sin_f32 v27, v6
    s_nop 0
    v_pk_mul_f32 v[40:41], v[28:29], v[26:27] op_sel:[0,0] op_sel_hi:[1,0]
    v_pk_fma_f32 v[42:43], v[28:29], v[26:27], v[40:41] op_sel:[1,1,0] op_sel_hi:[0,1,1] neg_lo:[1,0,0]
    v_mul_f32 v6, 0x3c400000, v4
    v_cos_f32 v26, v6
    v_sin_f32 v27, v6
    s_nop 0
    v_pk_mul_f32 v[28:29], v[30:31], v[26:27] op_sel:[0,0] op_sel_hi:[1,0]
    v_pk_fma_f32 v[40:41], v[30:31], v[26:27], v[28:29] op_sel:[1,1,0] op_sel_hi:[0,1,1] neg_lo:[1,0,0]
    v_mul_f32 v6, 0x3c800000, v4
    v_cos_f32 v26, v6
    v_sin_f32 v27, v6
    s_nop 0
    v_pk_mul_f32 v[28:29], v[32:33], v[26:27] op_sel:[0,0] op_sel_hi:[1,0]
    v_pk_fma_f32 v[30:31], v[32:33], v[26:27], v[28:29] op_sel:[1,1,0] op_sel_hi:[0,1,1] neg_lo:[1,0,0]
    v_mul_f32 v6, 0x3ca00000, v4
    v_cos_f32 v26, v6
    v_sin_f32 v27, v6
    s_nop 0
    v_pk_mul_f32 v[28:29], v[34:35], v[26:27] op_sel:[0,0] op_sel_hi:[1,0]
    v_pk_fma_f32 v[32:33], v[34:35], v[26:27], v[28:29] op_sel:[1,1,0] op_sel_hi:[0,1,1] neg_lo:[1,0,0]
    v_mul_f32 v6, 0x3cc00000, v4
    v_cos_f32 v26, v6
    v_sin_f32 v27, v6
    s_nop 0
    v_pk_mul_f32 v[28:29], v[36:37], v[26:27] op_sel:[0,0] op_sel_hi:[1,0]
    v_pk_fma_f32 v[34:35], v[36:37], v[26:27], v[28:29] op_sel:[1,1,0] op_sel_hi:[0,1,1] neg_lo:[1,0,0]
    v_mul_f32 v6, 0x3ce00000, v4
    v_cos_f32 v26, v6
    v_sin_f32 v27, v6
    s_nop 0
    v_pk_mul_f32 v[28:29], v[38:39], v[26:27] op_sel:[0,0] op_sel_hi:[1,0]
    v_pk_fma_f32 v[36:37], v[38:39], v[26:27], v[28:29] op_sel:[1,1,0] op_sel_hi:[0,1,1] neg_lo:[1,0,0]
    v_pk_add_f32 v[26:27], v[24:25], v[30:31]
    v_pk_add_f32 v[28:29], v[24:25], v[30:31] neg_lo:[0,1] neg_hi:[0,1]
    v_pk_add_f32 v[38:39], v[42:43], v[34:35]
    v_pk_add_f32 v[46:47], v[42:43], v[34:35] neg_lo:[0,1] neg_hi:[0,1]
    v_pk_add_f32 v[24:25], v[26:27], v[38:39]
    v_pk_add_f32 v[30:31], v[26:27], v[38:39] neg_lo:[0,1] neg_hi:[0,1]
    v_pk_add_f32 v[34:35], v[28:29], v[46:47] op_sel:[0,1] op_sel_hi:[1,0] neg_lo:[0,1]
    v_pk_add_f32 v[42:43], v[28:29], v[46:47] op_sel:[0,1] op_sel_hi:[1,0] neg_hi:[0,1]
    v_pk_add_f32 v[26:27], v[44:45], v[32:33]
    v_pk_add_f32 v[28:29], v[44:45], v[32:33] neg_lo:[0,1] neg_hi:[0,1]
    v_pk_add_f32 v[38:39], v[40:41], v[36:37]
    v_pk_add_f32 v[46:47], v[40:41], v[36:37] neg_lo:[0,1] neg_hi:[0,1]
    v_pk_add_f32 v[32:33], v[26:27], v[38:39]
    v_pk_add_f32 v[36:37], v[26:27], v[38:39] neg_lo:[0,1] neg_hi:[0,1]
    v_pk_add_f32 v[40:41], v[28:29], v[46:47] op_sel:[0,1] op_sel_hi:[1,0] neg_lo:[0,1]
    v_pk_add_f32 v[44:45], v[28:29], v[46:47] op_sel:[0,1] op_sel_hi:[1,0] neg_hi:[0,1]
    v_pk_mul_f32 v[26:27], v[40:41], s[46:47] op_sel:[0,0] op_sel_hi:[1,0]
    v_pk_fma_f32 v[28:29], v[40:41], s[46:47], v[26:27] op_sel:[1,1,0] op_sel_hi:[0,1,1] neg_lo:[1,0,0]
    v_pk_mul_f32 v[26:27], v[36:37], s[48:49] op_sel:[0,0] op_sel_hi:[1,0]
    v_pk_fma_f32 v[38:39], v[36:37], s[48:49], v[26:27] op_sel:[1,1,0] op_sel_hi:[0,1,1] neg_lo:[1,0,0]
    v_pk_mul_f32 v[26:27], v[44:45], s[50:51] op_sel:[0,0] op_sel_hi:[1,0]
    v_pk_fma_f32 v[36:37], v[44:45], s[50:51], v[26:27] op_sel:[1,1,0] op_sel_hi:[0,1,1] neg_lo:[1,0,0]
    v_pk_add_f32 v[26:27], v[24:25], v[32:33]
    v_pk_add_f32 v[40:41], v[24:25], v[32:33] neg_lo:[0,1] neg_hi:[0,1]
    v_pk_add_f32 v[24:25], v[34:35], v[28:29]
    v_pk_add_f32 v[32:33], v[34:35], v[28:29] neg_lo:[0,1] neg_hi:[0,1]
    v_pk_add_f32 v[28:29], v[30:31], v[38:39]
    v_pk_add_f32 v[34:35], v[30:31], v[38:39] neg_lo:[0,1] neg_hi:[0,1]
    v_pk_add_f32 v[30:31], v[42:43], v[36:37]
    v_pk_add_f32 v[38:39], v[42:43], v[36:37] neg_lo:[0,1] neg_hi:[0,1]
    ds_write_b64 v5, v[26:27] offset:0
    ds_write_b64 v5, v[24:25] offset:288
    ds_write_b64 v5, v[28:29] offset:576
    ds_write_b64 v5, v[30:31] offset:864
    ds_write_b64 v5, v[40:41] offset:1152
    ds_write_b64 v5, v[32:33] offset:1440
    ds_write_b64 v5, v[34:35] offset:1728
    ds_write_b64 v5, v[38:39] offset:2016
    s_waitcnt lgkmcnt(0)
    s_barrier
    v_lshrrev_b32 v5, 5, v0
    v_lshl_add_u32 v5, v5, 2, v0
    v_lshlrev_b32 v5, 3, v5
    v_cvt_f32_u32 v4, v0
    ds_read_b64 v[24:25], v5 offset:0
    ds_read_b64 v[26:27], v5 offset:2304
    ds_read_b64 v[28:29], v5 offset:4608
    ds_read_b64 v[30:31], v5 offset:6912
    ds_read_b64 v[32:33], v5 offset:9216
    ds_read_b64 v[34:35], v5 offset:11520
    ds_read_b64 v[36:37], v5 offset:13824
    ds_read_b64 v[38:39], v5 offset:16128
    s_waitcnt lgkmcnt(0)
    v_mul_f32 v6, 0x3a000000, v4
    v_cos_f32 v40, v6
    v_sin_f32 v41, v6
    s_nop 0
    v_pk_mul_f32 v[42:43], v[26:27], v[40:41] op_sel:[0,0] op_sel_hi:[1,0]
    v_pk_fma_f32 v[44:45], v[26:27], v[40:41], v[42:43] op_sel:[1,1,0] op_sel_hi:[0,1,1] neg_lo:[1,0,0]
    v_mul_f32 v6, 0x3a800000, v4
    v_cos_f32 v26, v6
    v_sin_f32 v27, v6
    s_nop 0
    v_pk_mul_f32 v[40:41], v[28:29], v[26:27] op_sel:[0,0] op_sel_hi:[1,0]
    v_pk_fma_f32 v[42:43], v[28:29], v[26:27], v[40:41] op_sel:[1,1,0] op_sel_hi:[0,1,1] neg_lo:[1,0,0]
    v_mul_f32 v6, 0x3ac00000, v4
    v_cos_f32 v26, v6
    v_sin_f32 v27, v6
    s_nop 0
    v_pk_mul_f32 v[28:29], v[30:31], v[26:27] op_sel:[0,0] op_sel_hi:[1,0]
    v_pk_fma_f32 v[40:41], v[30:31], v[26:27], v[28:29] op_sel:[1,1,0] op_sel_hi:[0,1,1] neg_lo:[1,0,0]
    v_mul_f32 v6, 0x3b000000, v4
    v_cos_f32 v26, v6
    v_sin_f32 v27, v6
    s_nop 0
    v_pk_mul_f32 v[28:29], v[32:33], v[26:27] op_sel:[0,0] op_sel_hi:[1,0]
    v_pk_fma_f32 v[30:31], v[32:33], v[26:27], v[28:29] op_sel:[1,1,0] op_sel_hi:[0,1,1] neg_lo:[1,0,0]
    v_mul_f32 v6, 0x3b200000, v4
    v_cos_f32 v26, v6
    v_sin_f32 v27, v6
    s_nop 0
    v_pk_mul_f32 v[28:29], v[34:35], v[26:27] op_sel:[0,0] op_sel_hi:[1,0]
    v_pk_fma_f32 v[32:33], v[34:35], v[26:27], v[28:29] op_sel:[1,1,0] op_sel_hi:[0,1,1] neg_lo:[1,0,0]
    v_mul_f32 v6, 0x3b400000, v4
    v_cos_f32 v26, v6
    v_sin_f32 v27, v6
    s_nop 0
    v_pk_mul_f32 v[28:29], v[36:37], v[26:27] op_sel:[0,0] op_sel_hi:[1,0]
    v_pk_fma_f32 v[34:35], v[36:37], v[26:27], v[28:29] op_sel:[1,1,0] op_sel_hi:[0,1,1] neg_lo:[1,0,0]
    v_mul_f32 v6, 0x3b600000, v4
    v_cos_f32 v26, v6
    v_sin_f32 v27, v6
    s_nop 0
    v_pk_mul_f32 v[28:29], v[38:39], v[26:27] op_sel:[0,0] op_sel_hi:[1,0]
    v_pk_fma_f32 v[36:37], v[38:39], v[26:27], v[28:29] op_sel:[1,1,0] op_sel_hi:[0,1,1] neg_lo:[1,0,0]
    v_pk_add_f32 v[26:27], v[24:25], v[30:31]
    v_pk_add_f32 v[28:29], v[24:25], v[30:31] neg_lo:[0,1] neg_hi:[0,1]
    v_pk_add_f32 v[38:39], v[42:43], v[34:35]
    v_pk_add_f32 v[46:47], v[42:43], v[34:35] neg_lo:[0,1] neg_hi:[0,1]
    v_pk_add_f32 v[24:25], v[26:27], v[38:39]
    v_pk_add_f32 v[30:31], v[26:27], v[38:39] neg_lo:[0,1] neg_hi:[0,1]
    v_pk_add_f32 v[34:35], v[28:29], v[46:47] op_sel:[0,1] op_sel_hi:[1,0] neg_lo:[0,1]
    v_pk_add_f32 v[42:43], v[28:29], v[46:47] op_sel:[0,1] op_sel_hi:[1,0] neg_hi:[0,1]
    v_pk_add_f32 v[26:27], v[44:45], v[32:33]
    v_pk_add_f32 v[28:29], v[44:45], v[32:33] neg_lo:[0,1] neg_hi:[0,1]
    v_pk_add_f32 v[38:39], v[40:41], v[36:37]
    v_pk_add_f32 v[46:47], v[40:41], v[36:37] neg_lo:[0,1] neg_hi:[0,1]
    v_pk_add_f32 v[32:33], v[26:27], v[38:39]
    v_pk_add_f32 v[36:37], v[26:27], v[38:39] neg_lo:[0,1] neg_hi:[0,1]
    v_pk_add_f32 v[40:41], v[28:29], v[46:47] op_sel:[0,1] op_sel_hi:[1,0] neg_lo:[0,1]
    v_pk_add_f32 v[44:45], v[28:29], v[46:47] op_sel:[0,1] op_sel_hi:[1,0] neg_hi:[0,1]
    v_pk_mul_f32 v[26:27], v[40:41], s[46:47] op_sel:[0,0] op_sel_hi:[1,0]
    v_pk_fma_f32 v[28:29], v[40:41], s[46:47], v[26:27] op_sel:[1,1,0] op_sel_hi:[0,1,1] neg_lo:[1,0,0]
    v_pk_mul_f32 v[26:27], v[36:37], s[48:49] op_sel:[0,0] op_sel_hi:[1,0]
    v_pk_fma_f32 v[38:39], v[36:37], s[48:49], v[26:27] op_sel:[1,1,0] op_sel_hi:[0,1,1] neg_lo:[1,0,0]
    v_pk_mul_f32 v[26:27], v[44:45], s[50:51] op_sel:[0,0] op_sel_hi:[1,0]
    v_pk_fma_f32 v[36:37], v[44:45], s[50:51], v[26:27] op_sel:[1,1,0] op_sel_hi:[0,1,1] neg_lo:[1,0,0]
    v_pk_add_f32 v[26:27], v[24:25], v[32:33]
    v_pk_add_f32 v[40:41], v[24:25], v[32:33] neg_lo:[0,1] neg_hi:[0,1]
    v_pk_add_f32 v[24:25], v[34:35], v[28:29]
    v_pk_add_f32 v[32:33], v[34:35], v[28:29] neg_lo:[0,1] neg_hi:[0,1]
    v_pk_add_f32 v[28:29], v[30:31], v[38:39]
    v_pk_add_f32 v[34:35], v[30:31], v[38:39] neg_lo:[0,1] neg_hi:[0,1]
    v_pk_add_f32 v[30:31], v[42:43], v[36:37]
    v_pk_add_f32 v[38:39], v[42:43], v[36:37] neg_lo:[0,1] neg_hi:[0,1]
    v_lshrrev_b32 v2, 3, v0
    s_mov_b32 s26, 32832
    v_mul_lo_u32 v2, v2, s26
    v_and_b32 v3, 7, v0
    v_lshl_add_u32 v2, v3, 3, v2
    s_lshl_b32 s27, s2, 6
    s_add_u32 s25, s27, 0
    buffer_store_dwordx2 v[26:27], v2, s[12:15], s25 offen
    s_add_u32 s25, s27, 1050624
    buffer_store_dwordx2 v[24:25], v2, s[12:15], s25 offen
    s_add_u32 s25, s27, 2101248
    buffer_store_dwordx2 v[28:29], v2, s[12:15], s25 offen
    s_add_u32 s25, s27, 3151872
    buffer_store_dwordx2 v[30:31], v2, s[12:15], s25 offen
    s_add_u32 s25, s27, 4202496
    buffer_store_dwordx2 v[40:41], v2, s[12:15], s25 offen
    s_add_u32 s25, s27, 5253120
    buffer_store_dwordx2 v[32:33], v2, s[12:15], s25 offen
    s_add_u32 s25, s27, 6303744
    buffer_store_dwordx2 v[34:35], v2, s[12:15], s25 offen
    s_add_u32 s25, s27, 7354368
    buffer_store_dwordx2 v[38:39], v2, s[12:15], s25 offen
fb_end:
    s_endpgm
.globl fft_c_kernel
.p2align 8
.type fft_c_kernel,@function
fft_c_kernel:
    s_load_dwordx2 s[4:5], s[0:1], 0
    s_load_dwordx2 s[6:7], s[0:1], 72
    s_cmp_ge_u32 s2, 256
    s_cbranch_scc1 fc_end
    s_waitcnt lgkmcnt(0)
    s_mov_b32 s8, s4
    s_and_b32 s9, s5, 0xffff
    s_mov_b32 s10, 4194304
    s_mov_b32 s11, 0x00020000
    s_add_u32 s12, s6, 67108864
    s_addc_u32 s13, s7, 0
    s_and_b32 s13, s13, 0xffff
    s_mov_b32 s14, 8404992
    s_mov_b32 s15, 0x00020000
    s_add_u32 s24, s6, 16777216
    s_addc_u32 s25, s7, 0
    s_and_b32 s25, s25, 0xffff
    s_mov_b32 s26, 4194304
    s_mov_b32 s27, 0x00020000
    s_add_u32 s28, s6, 25165824
    s_addc_u32 s29, s7, 0
    s_and_b32 s29, s29, 0xffff
    s_mov_b32 s30, 4194304
    s_mov_b32 s31, 0x00020000
    s_mov_b32 s40, 0x3f6c835e
    s_mov_b32 s41, 0x3ec3ef15
    s_mov_b32 s42, 0x3f3504f3
    s_mov_b32 s43, 0x3f3504f3
    s_mov_b32 s44, 0x3ec3ef15
    s_mov_b32 s45, 0x3f6c835e
    s_mov_b32 s46, 0x00000000
    s_mov_b32 s47, 0x3f800000
    s_mov_b32 s48, 0xbf3504f3
    s_mov_b32 s49, 0x3f3504f3
    s_mov_b32 s50, 0xbf6c835e
    s_mov_b32 s51, 0xbec3ef15
    s_lshl_b32 s16, s2, 3
    v_and_b32 v1, 63, v0
    v_lshrrev_b32 v2, 6, v0
    v_and_b32 v5, 3, v0
    v_mul_u32_u24 v6, 8768, v5
    v_lshrrev_b32 v7, 2, v0
    v_lshlrev_b32 v13, 4, v0
    s_mul_i32 s17, s2, 32832
    s_add_u32 s53, s17, 4096
    s_add_u32 s54, s17, 8192
    s_add_u32 s55, s17, 12288
    s_add_u32 s56, s17, 16384
    s_add_u32 s57, s17, 20480
    s_add_u32 s58, s17, 24576
    s_add_u32 s59, s17, 28672
    s_add_u32 s60, s17, 32768
    buffer_load_dwordx4 v[16:19], v13, s[12:15], s17 offen offset:0
    buffer_load_dwordx4 v[20:23], v13, s[12:15], s53 offen
    buffer_load_dwordx4 v[24:27], v13, s[12:15], s54 offen
    buffer_load_dwordx4 v[28:31], v13, s[12:15], s55 offen
    buffer_load_dwordx4 v[32:35], v13, s[12:15], s56 offen
    buffer_load_dwordx4 v[36:39], v13, s[12:15], s57 offen
    buffer_load_dwordx4 v[40:43], v13, s[12:15], s58 offen
    buffer_load_dwordx4 v[44:47], v13, s[12:15], s59 offen
    buffer_load_dwordx4 v[48:51], v13, s[12:15], s60 offen
    v_lshl_add_u32 v3, v2, 1, s16
    v_lshlrev_b32 v3, 11, v3
    v_lshl_add_u32 v3, v1, 1, v3
    v_mul_u32_u24 v4, 8768, v2
    buffer_load_ushort v120, v3, s[8:11], 0 offen offset:0
    buffer_load_ushort v121, v3, s[8:11], 0 offen offset:2048
    buffer_load_ushort v122, v3, s[8:11], 0 offen offset:128
    buffer_load_ushort v123, v3, s[8:11], 0 offen offset:2176
    buffer_load_ushort v124, v3, s[8:11], 0 offen offset:256
    buffer_load_ushort v125, v3, s[8:11], 0 offen offset:2304
    buffer_load_ushort v126, v3, s[8:11], 0 offen offset:384
    buffer_load_ushort v127, v3, s[8:11], 0 offen offset:2432
    buffer_load_ushort v128, v3, s[8:11], 0 offen offset:512
    buffer_load_ushort v129, v3, s[8:11], 0 offen offset:2560
    buffer_load_ushort v130, v3, s[8:11], 0 offen offset:640
    buffer_load_ushort v131, v3, s[8:11], 0 offen offset:2688
    buffer_load_ushort v132, v3, s[8:11], 0 offen offset:768
    buffer_load_ushort v133, v3, s[8:11], 0 offen offset:2816
    buffer_load_ushort v134, v3, s[8:11], 0 offen offset:896
    buffer_load_ushort v135, v3, s[8:11], 0 offen offset:2944
    buffer_load_ushort v136, v3, s[8:11], 0 offen offset:1024
    buffer_load_ushort v137, v3, s[8:11], 0 offen offset:3072
    buffer_load_ushort v138, v3, s[8:11], 0 offen offset:1152
    buffer_load_ushort v139, v3, s[8:11], 0 offen offset:3200
    buffer_load_ushort v140, v3, s[8:11], 0 offen offset:1280
    buffer_load_ushort v141, v3, s[8:11], 0 offen offset:3328
    buffer_load_ushort v142, v3, s[8:11], 0 offen offset:1408
    buffer_load_ushort v143, v3, s[8:11], 0 offen offset:3456
    buffer_load_ushort v144, v3, s[8:11], 0 offen offset:1536
    buffer_load_ushort v145, v3, s[8:11], 0 offen offset:3584
    buffer_load_ushort v146, v3, s[8:11], 0 offen offset:1664
    buffer_load_ushort v147, v3, s[8:11], 0 offen offset:3712
    buffer_load_ushort v148, v3, s[8:11], 0 offen offset:1792
    buffer_load_ushort v149, v3, s[8:11], 0 offen offset:3840
    buffer_load_ushort v150, v3, s[8:11], 0 offen offset:1920
    buffer_load_ushort v151, v3, s[8:11], 0 offen offset:3968
    s_waitcnt vmcnt(32)
    v_add_u32 v9, 0, v7
    v_and_b32 v10, 511, v9
    v_cmp_eq_u32 vcc, 0, v10
    s_nop 1
    v_cndmask_b32 v17, v17, 0, vcc
    v_cndmask_b32 v19, v19, 0, vcc
    v_sub_f32 v112, v16, v19
    v_add_f32 v113, v17, v18
    v_add_f32 v114, v16, v19
    v_sub_f32 v115, v18, v17
    v_lshrrev_b32 v10, 6, v9
    v_lshl_add_u32 v10, v10, 2, v9
    v_lshlrev_b32 v10, 3, v10
    v_add_u32 v10, v10, v6
    v_sub_u32 v11, 1024, v9
    v_and_b32 v11, 1023, v11
    v_lshrrev_b32 v12, 6, v11
    v_lshl_add_u32 v12, v12, 2, v11
    v_lshlrev_b32 v12, 3, v12
    v_add_u32 v12, v12, v6
    ds_write_b64 v10, v[112:113]
    ds_write_b64 v12, v[114:115]
    v_add_u32 v9, 64, v7
    v_sub_f32 v112, v20, v23
    v_add_f32 v113, v21, v22
    v_add_f32 v114, v20, v23
    v_sub_f32 v115, v22, v21
    v_lshrrev_b32 v10, 6, v9
    v_lshl_add_u32 v10, v10, 2, v9
    v_lshlrev_b32 v10, 3, v10
    v_add_u32 v10, v10, v6
    v_sub_u32 v11, 1024, v9
    v_and_b32 v11, 1023, v11
    v_lshrrev_b32 v12, 6, v11
    v_lshl_add_u32 v12, v12, 2, v11
    v_lshlrev_b32 v12, 3, v12
    v_add_u32 v12, v12, v6
    ds_write_b64 v10, v[112:113]
    ds_write_b64 v12, v[114:115]
    v_add_u32 v9, 128, v7
    v_sub_f32 v112, v24, v27
    v_add_f32 v113, v25, v26
    v_add_f32 v114, v24, v27
    v_sub_f32 v115, v26, v25
    v_lshrrev_b32 v10, 6, v9
    v_lshl_add_u32 v10, v10, 2, v9
    v_lshlrev_b32 v10, 3, v10
    v_add_u32 v10, v10, v6
    v_sub_u32 v11, 1024, v9
    v_and_b32 v11, 1023, v11
    v_lshrrev_b32 v12, 6, v11
    v_lshl_add_u32 v12, v12, 2, v11
    v_lshlrev_b32 v12, 3, v12
    v_add_u32 v12, v12, v6
    ds_write_b64 v10, v[112:113]
    ds_write_b64 v12, v[114:115]
    v_add_u32 v9, 192, v7
    v_sub_f32 v112, v28, v31
    v_add_f32 v113, v29, v30
    v_add_f32 v114, v28, v31
    v_sub_f32 v115, v30, v29
    v_lshrrev_b32 v10, 6, v9
    v_lshl_add_u32 v10, v10, 2, v9
    v_lshlrev_b32 v10, 3, v10
    v_add_u32 v10, v10, v6
    v_sub_u32 v11, 1024, v9
    v_and_b32 v11, 1023, v11
    v_lshrrev_b32 v12, 6, v11
    v_lshl_add_u32 v12, v12, 2, v11
    v_lshlrev_b32 v12, 3, v12
    v_add_u32 v12, v12, v6
    ds_write_b64 v10, v[112:113]
    ds_write_b64 v12, v[114:115]
    v_add_u32 v9, 256, v7
    v_sub_f32 v112, v32, v35
    v_add_f32 v113, v33, v34
    v_add_f32 v114, v32, v35
    v_sub_f32 v115, v34, v33
    v_lshrrev_b32 v10, 6, v9
    v_lshl_add_u32 v10, v10, 2, v9
    v_lshlrev_b32 v10, 3, v10
    v_add_u32 v10, v10, v6
    v_sub_u32 v11, 1024, v9
    v_and_b32 v11, 1023, v11
    v_lshrrev_b32 v12, 6, v11
    v_lshl_add_u32 v12, v12, 2, v11
    v_lshlrev_b32 v12, 3, v12
    v_add_u32 v12, v12, v6
    ds_write_b64 v10, v[112:113]
    ds_write_b64 v12, v[114:115]
    v_add_u32 v9, 320, v7
    v_sub_f32 v112, v36, v39
    v_add_f32 v113, v37, v38
    v_add_f32 v114, v36, v39
    v_sub_f32 v115, v38, v37
    v_lshrrev_b32 v10, 6, v9
    v_lshl_add_u32 v10, v10, 2, v9
    v_lshlrev_b32 v10, 3, v10
    v_add_u32 v10, v10, v6
    v_sub_u32 v11, 1024, v9
    v_and_b32 v11, 1023, v11
    v_lshrrev_b32 v12, 6, v11
    v_lshl_add_u32 v12, v12, 2, v11
    v_lshlrev_b32 v12, 3, v12
    v_add_u32 v12, v12, v6
    ds_write_b64 v10, v[112:113]
    ds_write_b64 v12, v[114:115]
    v_add_u32 v9, 384, v7
    v_sub_f32 v112, v40, v43
    v_add_f32 v113, v41, v42
    v_add_f32 v114, v40, v43
    v_sub_f32 v115, v42, v41
    v_lshrrev_b32 v10, 6, v9
    v_lshl_add_u32 v10, v10, 2, v9
    v_lshlrev_b32 v10, 3, v10
    v_add_u32 v10, v10, v6
    v_sub_u32 v11, 1024, v9
    v_and_b32 v11, 1023, v11
    v_lshrrev_b32 v12, 6, v11
    v_lshl_add_u32 v12, v12, 2, v11
    v_lshlrev_b32 v12, 3, v12
    v_add_u32 v12, v12, v6
    ds_write_b64 v10, v[112:113]
    ds_write_b64 v12, v[114:115]
    v_add_u32 v9, 448, v7
    v_sub_f32 v112, v44, v47
    v_add_f32 v113, v45, v46
    v_add_f32 v114, v44, v47
    v_sub_f32 v115, v46, v45
    v_lshrrev_b32 v10, 6, v9
    v_lshl_add_u32 v10, v10, 2, v9
    v_lshlrev_b32 v10, 3, v10
    v_add_u32 v10, v10, v6
    v_sub_u32 v11, 1024, v9
    v_and_b32 v11, 1023, v11
    v_lshrrev_b32 v12, 6, v11
    v_lshl_add_u32 v12, v12, 2, v11
    v_lshlrev_b32 v12, 3, v12
    v_add_u32 v12, v12, v6
    ds_write_b64 v10, v[112:113]
    ds_write_b64 v12, v[114:115]
    v_add_u32 v9, 512, v7
    v_and_b32 v10, 511, v9
    v_cmp_eq_u32 vcc, 0, v10
    s_nop 1
    v_cndmask_b32 v49, v49, 0, vcc
    v_cndmask_b32 v51, v51, 0, vcc
    v_sub_f32 v112, v48, v51
    v_add_f32 v113, v49, v50
    v_add_f32 v114, v48, v51
    v_sub_f32 v115, v50, v49
    v_lshrrev_b32 v10, 6, v9
    v_lshl_add_u32 v10, v10, 2, v9
    v_lshlrev_b32 v10, 3, v10
    v_add_u32 v10, v10, v6
    v_sub_u32 v11, 1024, v9
    v_and_b32 v11, 1023, v11
    v_lshrrev_b32 v12, 6, v11
    v_lshl_add_u32 v12, v12, 2, v11
    v_lshlrev_b32 v12, 3, v12
    v_add_u32 v12, v12, v6
    v_cmp_ge_u32 vcc, 512, v9
    s_nop 3
    s_and_saveexec_b64 s[32:33], vcc
    ds_write_b64 v10, v[112:113]
    ds_write_b64 v12, v[114:115]
    s_mov_b64 exec, s[32:33]
    s_waitcnt lgkmcnt(0)
    s_barrier
    v_lshl_add_u32 v6, v1, 3, v4
    ds_read_b64 v[16:17], v6 offset:0
    ds_read_b64 v[18:19], v6 offset:544
    ds_read_b64 v[20:21], v6 offset:1088
    ds_read_b64 v[22:23], v6 offset:1632
    ds_read_b64 v[24:25], v6 offset:2176
    ds_read_b64 v[26:27], v6 offset:2720
    ds_read_b64 v[28:29], v6 offset:3264
    ds_read_b64 v[30:31], v6 offset:3808
    ds_read_b64 v[32:33], v6 offset:4352
    ds_read_b64 v[34:35], v6 offset:4896
    ds_read_b64 v[36:37], v6 offset:5440
    ds_read_b64 v[38:39], v6 offset:5984
    ds_read_b64 v[40:41], v6 offset:6528
    ds_read_b64 v[42:43], v6 offset:7072
    ds_read_b64 v[44:45], v6 offset:7616
    ds_read_b64 v[46:47], v6 offset:8160
    s_waitcnt lgkmcnt(0)
    v_pk_add_f32 v[48:49], v[16:17], v[32:33]
    v_pk_add_f32 v[50:51], v[16:17], v[32:33] neg_lo:[0,1] neg_hi:[0,1]
    v_pk_add_f32 v[52:53], v[24:25], v[40:41]
    v_pk_add_f32 v[54:55], v[24:25], v[40:41] neg_lo:[0,1] neg_hi:[0,1]
    v_pk_add_f32 v[16:17], v[48:49], v[52:53]
    v_pk_add_f32 v[24:25], v[48:49], v[52:53] neg_lo:[0,1] neg_hi:[0,1]
    v_pk_add_f32 v[32:33], v[50:51], v[54:55] op_sel:[0,1] op_sel_hi:[1,0] neg_lo:[0,1]
    v_pk_add_f32 v[40:41], v[50:51], v[54:55] op_sel:[0,1] op_sel_hi:[1,0] neg_hi:[0,1]
    v_pk_add_f32 v[48:49], v[18:19], v[34:35]
    v_pk_add_f32 v[50:51], v[18:19], v[34:35] neg_lo:[0,1] neg_hi:[0,1]
    v_pk_add_f32 v[52:53], v[26:27], v[42:43]
    v_pk_add_f32 v[54:55], v[26:27], v[42:43] neg_lo:[0,1] neg_hi:[0,1]
    v_pk_add_f32 v[18:19], v[48:49], v[52:53]
    v_pk_add_f32 v[26:27], v[48:49], v[52:53] neg_lo:[0,1] neg_hi:[0,1]
    v_pk_add_f32 v[34:35], v[50:51], v[54:55] op_sel:[0,1] op_sel_hi:[1,0] neg_lo:[0,1]
    v_pk_add_f32 v[42:43], v[50:51], v[54:55] op_sel:[0,1] op_sel_hi:[1,0] neg_hi:[0,1]
    v_pk_mul_f32 v[48:49], v[34:35], s[40:41] op_sel:[0,0] op_sel_hi:[1,0]
    v_pk_fma_f32 v[50:51], v[34:35], s[40:41], v[48:49] op_sel:[1,1,0] op_sel_hi:[0,1,1] neg_lo:[1,0,0]
    v_pk_mul_f32 v[34:35], v[26:27], s[42:43] op_sel:[0,0] op_sel_hi:[1,0]
    v_pk_fma_f32 v[48:49], v[26:27], s[42:43], v[34:35] op_sel:[1,1,0] op_sel_hi:[0,1,1] neg_lo:[1,0,0]
    v_pk_mul_f32 v[26:27], v[42:43], s[44:45] op_sel:[0,0] op_sel_hi:[1,0]
    v_pk_fma_f32 v[34:35], v[42:43], s[44:45], v[26:27] op_sel:[1,1,0] op_sel_hi:[0,1,1] neg_lo:[1,0,0]
    v_pk_add_f32 v[26:27], v[20:21], v[36:37]
    v_pk_add_f32 v[42:43], v[20:21], v[36:37] neg_lo:[0,1] neg_hi:[0,1]
    v_pk_add_f32 v[52:53], v[28:29], v[44:45]
    v_pk_add_f32 v[54:55], v[28:29], v[44:45] neg_lo:[0,1] neg_hi:[0,1]
    v_pk_add_f32 v[20:21], v[26:27], v[52:53]
    v_pk_add_f32 v[28:29], v[26:27], v[52:53] neg_lo:[0,1] neg_hi:[0,1]
    v_pk_add_f32 v[36:37], v[42:43], v[54:55] op_sel:[0,1] op_sel_hi:[1,0] neg_lo:[0,1]
    v_pk_add_f32 v[44:45], v[42:43], v[54:55] op_sel:[0,1] op_sel_hi:[1,0] neg_hi:[0,1]
    v_pk_mul_f32 v[26:27], v[36:37], s[42:43] op_sel:[0,0] op_sel_hi:[1,0]
    v_pk_fma_f32 v[42:43], v[36:37], s[42:43], v[26:27] op_sel:[1,1,0] op_sel_hi:[0,1,1] neg_lo:[1,0,0]
    v_pk_mul_f32 v[26:27], v[28:29], s[46:47] op_sel:[0,0] op_sel_hi:[1,0]
    v_pk_fma_f32 v[36:37], v[28:29], s[46:47], v[26:27] op_sel:[1,1,0] op_sel_hi:[0,1,1] neg_lo:[1,0,0]
    v_pk_mul_f32 v[26:27], v[44:45], s[48:49] op_sel:[0,0] op_sel_hi:[1,0]
    v_pk_fma_f32 v[28:29], v[44:45], s[48:49], v[26:27] op_sel:[1,1,0] op_sel_hi:[0,1,1] neg_lo:[1,0,0]
    v_pk_add_f32 v[26:27], v[22:23], v[38:39]
    v_pk_add_f32 v[44:45], v[22:23], v[38:39] neg_lo:[0,1] neg_hi:[0,1]
    v_pk_add_f32 v[52:53], v[30:31], v[46:47]
    v_pk_add_f32 v[54:55], v[30:31], v[46:47] neg_lo:[0,1] neg_hi:[0,1]
    v_pk_add_f32 v[22:23], v[26:27], v[52:53]
    v_pk_add_f32 v[30:31], v[26:27], v[52:53] neg_lo:[0,1] neg_hi:[0,1]
    v_pk_add_f32 v[38:39], v[44:45], v[54:55] op_sel:[0,1] op_sel_hi:[1,0] neg_lo:[0,1]
    v_pk_add_f32 v[46:47], v[44:45], v[54:55] op_sel:[0,1] op_sel_hi:[1,0] neg_hi:[0,1]
    v_pk_mul_f32 v[26:27], v[38:39], s[44:45] op_sel:[0,0] op_sel_hi:[1,0]
    v_pk_fma_f32 v[44:45], v[38:39], s[44:45], v[26:27] op_sel:[1,1,0] op_sel_hi:[0,1,1] neg_lo:[1,0,0]
    v_pk_mul_f32 v[26:27], v[30:31], s[48:49] op_sel:[0,0] op_sel_hi:[1,0]
    v_pk_fma_f32 v[38:39], v[30:31], s[48:49], v[26:27] op_sel:[1,1,0] op_sel_hi:[0,1,1] neg_lo:[1,0,0]
    v_pk_mul_f32 v[26:27], v[46:47], s[50:51] op_sel:[0,0] op_sel_hi:[1,0]
    v_pk_fma_f32 v[30:31], v[46:47], s[50:51], v[26:27] op_sel:[1,1,0] op_sel_hi:[0,1,1] neg_lo:[1,0,0]
    v_pk_add_f32 v[26:27], v[16:17], v[20:21]
    v_pk_add_f32 v[46:47], v[16:17], v[20:21] neg_lo:[0,1] neg_hi:[0,1]
    v_pk_add_f32 v[52:53], v[18:19], v[22:23]
    v_pk_add_f32 v[54:55], v[18:19], v[22:23] neg_lo:[0,1] neg_hi:[0,1]
    v_pk_add_f32 v[16:17], v[26:27], v[52:53]
    v_pk_add_f32 v[18:19], v[26:27], v[52:53] neg_lo:[0,1] neg_hi:[0,1]
    v_pk_add_f32 v[20:21], v[46:47], v[54:55] op_sel:[0,1] op_sel_hi:[1,0] neg_lo:[0,1]
    v_pk_add_f32 v[22:23], v[46:47], v[54:55] op_sel:[0,1] op_sel_hi:[1,0] neg_hi:[0,1]
    v_pk_add_f32 v[26:27], v[32:33], v[42:43]
    v_pk_add_f32 v[46:47], v[32:33], v[42:43] neg_lo:[0,1] neg_hi:[0,1]
    v_pk_add_f32 v[52:53], v[50:51], v[44:45]
    v_pk_add_f32 v[54:55], v[50:51], v[44:45] neg_lo:[0,1] neg_hi:[0,1]
    v_pk_add_f32 v[32:33], v[26:27], v[52:53]
    v_pk_add_f32 v[42:43], v[26:27], v[52:53] neg_lo:[0,1] neg_hi:[0,1]
    v_pk_add_f32 v[44:45], v[46:47], v[54:55] op_sel:[0,1] op_sel_hi:[1,0] neg_lo:[0,1]
    v_pk_add_f32 v[50:51], v[46:47], v[54:55] op_sel:[0,1] op_sel_hi:[1,0] neg_hi:[0,1]
    v_pk_add_f32 v[26:27], v[24:25], v[36:37]
    v_pk_add_f32 v[46:47], v[24:25], v[36:37] neg_lo:[0,1] neg_hi:[0,1]
    v_pk_add_f32 v[52:53], v[48:49], v[38:39]
    v_pk_add_f32 v[54:55], v[48:49], v[38:39] neg_lo:[0,1] neg_hi:[0,1]
    v_pk_add_f32 v[24:25], v[26:27], v[52:53]
    v_pk_add_f32 v[36:37], v[26:27], v[52:53] neg_lo:[0,1] neg_hi:[0,1]
    v_pk_add_f32 v[38:39], v[46:47], v[54:55] op_sel:[0,1] op_sel_hi:[1,0] neg_lo:[0,1]
    v_pk_add_f32 v[48:49], v[46:47], v[54:55] op_sel:[0,1] op_sel_hi:[1,0] neg_hi:[0,1]
    v_pk_add_f32 v[26:27], v[40:41], v[28:29]
    v_pk_add_f32 v[46:47], v[40:41], v[28:29] neg_lo:[0,1] neg_hi:[0,1]
    v_pk_add_f32 v[52:53], v[34:35], v[30:31]
    v_pk_add_f32 v[54:55], v[34:35], v[30:31] neg_lo:[0,1] neg_hi:[0,1]
    v_pk_add_f32 v[28:29], v[26:27], v[52:53]
    v_pk_add_f32 v[30:31], v[26:27], v[52:53] neg_lo:[0,1] neg_hi:[0,1]
    v_pk_add_f32 v[34:35], v[46:47], v[54:55] op_sel:[0,1] op_sel_hi:[1,0] neg_lo:[0,1]
    v_pk_add_f32 v[40:41], v[46:47], v[54:55] op_sel:[0,1] op_sel_hi:[1,0] neg_hi:[0,1]
    v_cvt_f32_u32 v5, v1
    v_mul_f32 v7, 0x3a800000, v5
    v_cos_f32 v26, v7
    v_sin_f32 v27, v7
    s_nop 0
    v_pk_mul_f32 v[46:47], v[32:33], v[26:27] op_sel:[0,0] op_sel_hi:[1,0]
    v_pk_fma_f32 v[52:53], v[32:33], v[26:27], v[46:47] op_sel:[1,1,0] op_sel_hi:[0,1,1] neg_lo:[1,0,0]
    v_mul_f32 v7, 0x3b000000, v5
    v_cos_f32 v26, v7
    v_sin_f32 v27, v7
    s_nop 0
    v_pk_mul_f32 v[32:33], v[24:25], v[26:27] op_sel:[0,0] op_sel_hi:[1,0]
    v_pk_fma_f32 v[46:47], v[24:25], v[26:27], v[32:33] op_sel:[1,1,0] op_sel_hi:[0,1,1] neg_lo:[1,0,0]
    v_mul_f32 v7, 0x3b400000, v5
    v_cos_f32 v24, v7
    v_sin_f32 v25, v7
    s_nop 0
    v_pk_mul_f32 v[26:27], v[28:29], v[24:25] op_sel:[0,0] op_sel_hi:[1,0]
    v_pk_fma_f32 v[32:33], v[28:29], v[24:25], v[26:27] op_sel:[1,1,0] op_sel_hi:[0,1,1] neg_lo:[1,0,0]
    v_mul_f32 v7, 0x3b800000, v5
    v_cos_f32 v24, v7
    v_sin_f32 v25, v7
    s_nop 0
    v_pk_mul_f32 v[26:27], v[20:21], v[24:25] op_sel:[0,0] op_sel_hi:[1,0]
    v_pk_fma_f32 v[28:29], v[20:21], v[24:25], v[26:27] op_sel:[1,1,0] op_sel_hi:[0,1,1] neg_lo:[1,0,0]
    v_mul_f32 v7, 0x3ba00000, v5
    v_cos_f32 v20, v7
    v_sin_f32 v21, v7
    s_nop 0
    v_pk_mul_f32 v[24:25], v[44:45], v[20:21] op_sel:[0,0] op_sel_hi:[1,0]
    v_pk_fma_f32 v[26:27], v[44:45], v[20:21], v[24:25] op_sel:[1,1,0] op_sel_hi:[0,1,1] neg_lo:[1,0,0]
    v_mul_f32 v7, 0x3bc00000, v5
    v_cos_f32 v20, v7
    v_sin_f32 v21, v7
    s_nop 0
    v_pk_mul_f32 v[24:25], v[38:39], v[20:21] op_sel:[0,0] op_sel_hi:[1,0]
    v_pk_fma_f32 v[44:45], v[38:39], v[20:21], v[24:25] op_sel:[1,1,0] op_sel_hi:[0,1,1] neg_lo:[1,0,0]
    v_mul_f32 v7, 0x3be00000, v5
    v_cos_f32 v20, v7
    v_sin_f32 v21, v7
    s_nop 0
    v_pk_mul_f32 v[24:25], v[34:35], v[20:21] op_sel:[0,0] op_sel_hi:[1,0]
    v_pk_fma_f32 v[38:39], v[34:35], v[20:21], v[24:25] op_sel:[1,1,0] op_sel_hi:[0,1,1] neg_lo:[1,0,0]
    v_mul_f32 v7, 0x3c000000, v5
    v_cos_f32 v20, v7
    v_sin_f32 v21, v7
    s_nop 0
    v_pk_mul_f32 v[24:25], v[18:19], v[20:21] op_sel:[0,0] op_sel_hi:[1,0]
    v_pk_fma_f32 v[34:35], v[18:19], v[20:21], v[24:25] op_sel:[1,1,0] op_sel_hi:[0,1,1] neg_lo:[1,0,0]
    v_mul_f32 v7, 0x3c100000, v5
    v_cos_f32 v18, v7
    v_sin_f32 v19, v7
    s_nop 0
    v_pk_mul_f32 v[20:21], v[42:43], v[18:19] op_sel:[0,0] op_sel_hi:[1,0]
    v_pk_fma_f32 v[24:25], v[42:43], v[18:19], v[20:21] op_sel:[1,1,0] op_sel_hi:[0,1,1] neg_lo:[1,0,0]
    v_mul_f32 v7, 0x3c200000, v5
    v_cos_f32 v18, v7
    v_sin_f32 v19, v7
    s_nop 0
    v_pk_mul_f32 v[20:21], v[36:37], v[18:19] op_sel:[0,0] op_sel_hi:[1,0]
    v_pk_fma_f32 v[42:43], v[36:37], v[18:19], v[20:21] op_sel:[1,1,0] op_sel_hi:[0,1,1] neg_lo:[1,0,0]
    v_mul_f32 v7, 0x3c300000, v5
    v_cos_f32 v18, v7
    v_sin_f32 v19, v7
    s_nop 0
    v_pk_mul_f32 v[20:21], v[30:31], v[18:19] op_sel:[0,0] op_sel_hi:[1,0]
    v_pk_fma_f32 v[36:37], v[30:31], v[18:19], v[20:21] op_sel:[1,1,0] op_sel_hi:[0,1,1] neg_lo:[1,0,0]
    v_mul_f32 v7, 0x3c400000, v5
    v_cos_f32 v18, v7
    v_sin_f32 v19, v7
    s_nop 0
    v_pk_mul_f32 v[20:21], v[22:23], v[18:19] op_sel:[0,0] op_sel_hi:[1,0]
    v_pk_fma_f32 v[30:31], v[22:23], v[18:19], v[20:21] op_sel:[1,1,0] op_sel_hi:[0,1,1] neg_lo:[1,0,0]
    v_mul_f32 v7, 0x3c500000, v5
    v_cos_f32 v18, v7
    v_sin_f32 v19, v7
    s_nop 0
    v_pk_mul_f32 v[20:21], v[50:51], v[18:19] op_sel:[0,0] op_sel_hi:[1,0]
    v_pk_fma_f32 v[22:23], v[50:51], v[18:19], v[20:21] op_sel:[1,1,0] op_sel_hi:[0,1,1] neg_lo:[1,0,0]
    v_mul_f32 v7, 0x3c600000, v5
    v_cos_f32 v18, v7
    v_sin_f32 v19, v7
    s_nop 0
    v_pk_mul_f32 v[20:21], v[48:49], v[18:19] op_sel:[0,0] op_sel_hi:[1,0]
    v_pk_fma_f32 v[50:51], v[48:49], v[18:19], v[20:21] op_sel:[1,1,0] op_sel_hi:[0,1,1] neg_lo:[1,0,0]
    v_mul_f32 v7, 0x3c700000, v5
    v_cos_f32 v18, v7
    v_sin_f32 v19, v7
    s_nop 0
    v_pk_mul_f32 v[20:21], v[40:41], v[18:19] op_sel:[0,0] op_sel_hi:[1,0]
    v_pk_fma_f32 v[48:49], v[40:41], v[18:19], v[20:21] op_sel:[1,1,0] op_sel_hi:[0,1,1] neg_lo:[1,0,0]
    v_lshl_add_u32 v6, v1, 3, v4
    ds_write_b64 v6, v[16:17] offset:0
    ds_write_b64 v6, v[52:53] offset:544
    ds_write_b64 v6, v[46:47] offset:1088
    ds_write_b64 v6, v[32:33] offset:1632
    ds_write_b64 v6, v[28:29] offset:2176
    ds_write_b64 v6, v[26:27] offset:2720
    ds_write_b64 v6, v[44:45] offset:3264
    ds_write_b64 v6, v[38:39] offset:3808
    ds_write_b64 v6, v[34:35] offset:4352
    ds_write_b64 v6, v[24:25] offset:4896
    ds_write_b64 v6, v[42:43] offset:5440
    ds_write_b64 v6, v[36:37] offset:5984
    ds_write_b64 v6, v[30:31] offset:6528
    ds_write_b64 v6, v[22:23] offset:7072
    ds_write_b64 v6, v[50:51] offset:7616
    ds_write_b64 v6, v[48:49] offset:8160
    v_lshrrev_b32 v6, 2, v1
    v_mul_u32_u24 v6, 68, v6
    v_and_b32 v8, 3, v1
    v_add_u32 v6, v6, v8
    v_lshl_add_u32 v6, v6, 3, v4
    ds_read_b64 v[16:17], v6 offset:0
    ds_read_b64 v[18:19], v6 offset:32
    ds_read_b64 v[20:21], v6 offset:64
    ds_read_b64 v[22:23], v6 offset:96
    ds_read_b64 v[24:25], v6 offset:128
    ds_read_b64 v[26:27], v6 offset:160
    ds_read_b64 v[28:29], v6 offset:192
    ds_read_b64 v[30:31], v6 offset:224
    ds_read_b64 v[32:33], v6 offset:256
    ds_read_b64 v[34:35], v6 offset:288
    ds_read_b64 v[36:37], v6 offset:320
    ds_read_b64 v[38:39], v6 offset:352
    ds_read_b64 v[40:41], v6 offset:384
    ds_read_b64 v[42:43], v6 offset:416
    ds_read_b64 v[44:45], v6 offset:448
    ds_read_b64 v[46:47], v6 offset:480
    s_waitcnt lgkmcnt(0)
    v_pk_add_f32 v[48:49], v[16:17], v[32:33]
    v_pk_add_f32 v[50:51], v[16:17], v[32:33] neg_lo:[0,1] neg_hi:[0,1]
    v_pk_add_f32 v[52:53], v[24:25], v[40:41]
    v_pk_add_f32 v[54:55], v[24:25], v[40:41] neg_lo:[0,1] neg_hi:[0,1]
    v_pk_add_f32 v[16:17], v[48:49], v[52:53]
    v_pk_add_f32 v[24:25], v[48:49], v[52:53] neg_lo:[0,1] neg_hi:[0,1]
    v_pk_add_f32 v[32:33], v[50:51], v[54:55] op_sel:[0,1] op_sel_hi:[1,0] neg_lo:[0,1]
    v_pk_add_f32 v[40:41], v[50:51], v[54:55] op_sel:[0,1] op_sel_hi:[1,0] neg_hi:[0,1]
    v_pk_add_f32 v[48:49], v[18:19], v[34:35]
    v_pk_add_f32 v[50:51], v[18:19], v[34:35] neg_lo:[0,1] neg_hi:[0,1]
    v_pk_add_f32 v[52:53], v[26:27], v[42:43]
    v_pk_add_f32 v[54:55], v[26:27], v[42:43] neg_lo:[0,1] neg_hi:[0,1]
    v_pk_add_f32 v[18:19], v[48:49], v[52:53]
    v_pk_add_f32 v[26:27], v[48:49], v[52:53] neg_lo:[0,1] neg_hi:[0,1]
    v_pk_add_f32 v[34:35], v[50:51], v[54:55] op_sel:[0,1] op_sel_hi:[1,0] neg_lo:[0,1]
    v_pk_add_f32 v[42:43], v[50:51], v[54:55] op_sel:[0,1] op_sel_hi:[1,0] neg_hi:[0,1]
    v_pk_mul_f32 v[48:49], v[34:35], s[40:41] op_sel:[0,0] op_sel_hi:[1,0]
    v_pk_fma_f32 v[50:51], v[34:35], s[40:41], v[48:49] op_sel:[1,1,0] op_sel_hi:[0,1,1] neg_lo:[1,0,0]
    v_pk_mul_f32 v[34:35], v[26:27], s[42:43] op_sel:[0,0] op_sel_hi:[1,0]
    v_pk_fma_f32 v[48:49], v[26:27], s[42:43], v[34:35] op_sel:[1,1,0] op_sel_hi:[0,1,1] neg_lo:[1,0,0]
    v_pk_mul_f32 v[26:27], v[42:43], s[44:45] op_sel:[0,0] op_sel_hi:[1,0]
    v_pk_fma_f32 v[34:35], v[42:43], s[44:45], v[26:27] op_sel:[1,1,0] op_sel_hi:[0,1,1] neg_lo:[1,0,0]
    v_pk_add_f32 v[26:27], v[20:21], v[36:37]
    v_pk_add_f32 v[42:43], v[20:21], v[36:37] neg_lo:[0,1] neg_hi:[0,1]
    v_pk_add_f32 v[52:53], v[28:29], v[44:45]
    v_pk_add_f32 v[54:55], v[28:29], v[44:45] neg_lo:[0,1] neg_hi:[0,1]
    v_pk_add_f32 v[20:21], v[26:27], v[52:53]
    v_pk_add_f32 v[28:29], v[26:27], v[52:53] neg_lo:[0,1] neg_hi:[0,1]
    v_pk_add_f32 v[36:37], v[42:43], v[54:55] op_sel:[0,1] op_sel_hi:[1,0] neg_lo:[0,1]
    v_pk_add_f32 v[44:45], v[42:43], v[54:55] op_sel:[0,1] op_sel_hi:[1,0] neg_hi:[0,1]
    v_pk_mul_f32 v[26:27], v[36:37], s[42:43] op_sel:[0,0] op_sel_hi:[1,0]
    v_pk_fma_f32 v[42:43], v[36:37], s[42:43], v[26:27] op_sel:[1,1,0] op_sel_hi:[0,1,1] neg_lo:[1,0,0]
    v_pk_mul_f32 v[26:27], v[28:29], s[46:47] op_sel:[0,0] op_sel_hi:[1,0]
    v_pk_fma_f32 v[36:37], v[28:29], s[46:47], v[26:27] op_sel:[1,1,0] op_sel_hi:[0,1,1] neg_lo:[1,0,0]
    v_pk_mul_f32 v[26:27], v[44:45], s[48:49] op_sel:[0,0] op_sel_hi:[1,0]
    v_pk_fma_f32 v[28:29], v[44:45], s[48:49], v[26:27] op_sel:[1,1,0] op_sel_hi:[0,1,1] neg_lo:[1,0,0]
    v_pk_add_f32 v[26:27], v[22:23], v[38:39]
    v_pk_add_f32 v[44:45], v[22:23], v[38:39] neg_lo:[0,1] neg_hi:[0,1]
    v_pk_add_f32 v[52:53], v[30:31], v[46:47]
    v_pk_add_f32 v[54:55], v[30:31], v[46:47] neg_lo:[0,1] neg_hi:[0,1]
    v_pk_add_f32 v[22:23], v[26:27], v[52:53]
    v_pk_add_f32 v[30:31], v[26:27], v[52:53] neg_lo:[0,1] neg_hi:[0,1]
    v_pk_add_f32 v[38:39], v[44:45], v[54:55] op_sel:[0,1] op_sel_hi:[1,0] neg_lo:[0,1]
    v_pk_add_f32 v[46:47], v[44:45], v[54:55] op_sel:[0,1] op_sel_hi:[1,0] neg_hi:[0,1]
    v_pk_mul_f32 v[26:27], v[38:39], s[44:45] op_sel:[0,0] op_sel_hi:[1,0]
    v_pk_fma_f32 v[44:45], v[38:39], s[44:45], v[26:27] op_sel:[1,1,0] op_sel_hi:[0,1,1] neg_lo:[1,0,0]
    v_pk_mul_f32 v[26:27], v[30:31], s[48:49] op_sel:[0,0] op_sel_hi:[1,0]
    v_pk_fma_f32 v[38:39], v[30:31], s[48:49], v[26:27] op_sel:[1,1,0] op_sel_hi:[0,1,1] neg_lo:[1,0,0]
    v_pk_mul_f32 v[26:27], v[46:47], s[50:51] op_sel:[0,0] op_sel_hi:[1,0]
    v_pk_fma_f32 v[30:31], v[46:47], s[50:51], v[26:27] op_sel:[1,1,0] op_sel_hi:[0,1,1] neg_lo:[1,0,0]
    v_pk_add_f32 v[26:27], v[16:17], v[20:21]
    v_pk_add_f32 v[46:47], v[16:17], v[20:21] neg_lo:[0,1] neg_hi:[0,1]
    v_pk_add_f32 v[52:53], v[18:19], v[22:23]
    v_pk_add_f32 v[54:55], v[18:19], v[22:23] neg_lo:[0,1] neg_hi:[0,1]
    v_pk_add_f32 v[16:17], v[26:27], v[52:53]
    v_pk_add_f32 v[18:19], v[26:27], v[52:53] neg_lo:[0,1] neg_hi:[0,1]
    v_pk_add_f32 v[20:21], v[46:47], v[54:55] op_sel:[0,1] op_sel_hi:[1,0] neg_lo:[0,1]
    v_pk_add_f32 v[22:23], v[46:47], v[54:55] op_sel:[0,1] op_sel_hi:[1,0] neg_hi:[0,1]
    v_pk_add_f32 v[26:27], v[32:33], v[42:43]
    v_pk_add_f32 v[46:47], v[32:33], v[42:43] neg_lo:[0,1] neg_hi:[0,1]
    v_pk_add_f32 v[52:53], v[50:51], v[44:45]
    v_pk_add_f32 v[54:55], v[50:51], v[44:45] neg_lo:[0,1] neg_hi:[0,1]
    v_pk_add_f32 v[32:33], v[26:27], v[52:53]
    v_pk_add_f32 v[42:43], v[26:27], v[52:53] neg_lo:[0,1] neg_hi:[0,1]
    v_pk_add_f32 v[44:45], v[46:47], v[54:55] op_sel:[0,1] op_sel_hi:[1,0] neg_lo:[0,1]
    v_pk_add_f32 v[50:51], v[46:47], v[54:55] op_sel:[0,1] op_sel_hi:[1,0] neg_hi:[0,1]
    v_pk_add_f32 v[26:27], v[24:25], v[36:37]
    v_pk_add_f32 v[46:47], v[24:25], v[36:37] neg_lo:[0,1] neg_hi:[0,1]
    v_pk_add_f32 v[52:53], v[48:49], v[38:39]
    v_pk_add_f32 v[54:55], v[48:49], v[38:39] neg_lo:[0,1] neg_hi:[0,1]
    v_pk_add_f32 v[24:25], v[26:27], v[52:53]
    v_pk_add_f32 v[36:37], v[26:27], v[52:53] neg_lo:[0,1] neg_hi:[0,1]
    v_pk_add_f32 v[38:39], v[46:47], v[54:55] op_sel:[0,1] op_sel_hi:[1,0] neg_lo:[0,1]
    v_pk_add_f32 v[48:49], v[46:47], v[54:55] op_sel:[0,1] op_sel_hi:[1,0] neg_hi:[0,1]
    v_pk_add_f32 v[26:27], v[40:41], v[28:29]
    v_pk_add_f32 v[46:47], v[40:41], v[28:29] neg_lo:[0,1] neg_hi:[0,1]
    v_pk_add_f32 v[52:53], v[34:35], v[30:31]
    v_pk_add_f32 v[54:55], v[34:35], v[30:31] neg_lo:[0,1] neg_hi:[0,1]
    v_pk_add_f32 v[28:29], v[26:27], v[52:53]
    v_pk_add_f32 v[30:31], v[26:27], v[52:53] neg_lo:[0,1] neg_hi:[0,1]
    v_pk_add_f32 v[34:35], v[46:47], v[54:55] op_sel:[0,1] op_sel_hi:[1,0] neg_lo:[0,1]
    v_pk_add_f32 v[40:41], v[46:47], v[54:55] op_sel:[0,1] op_sel_hi:[1,0] neg_hi:[0,1]
    v_cvt_f32_u32 v5, v8
    v_mul_f32 v7, 0x3c800000, v5
    v_cos_f32 v26, v7
    v_sin_f32 v27, v7
    s_nop 0
    v_pk_mul_f32 v[46:47], v[32:33], v[26:27] op_sel:[0,0] op_sel_hi:[1,0]
    v_pk_fma_f32 v[52:53], v[32:33], v[26:27], v[46:47] op_sel:[1,1,0] op_sel_hi:[0,1,1] neg_lo:[1,0,0]
    v_mul_f32 v7, 0x3d000000, v5
    v_cos_f32 v26, v7
    v_sin_f32 v27, v7
    s_nop 0
    v_pk_mul_f32 v[32:33], v[24:25], v[26:27] op_sel:[0,0] op_sel_hi:[1,0]
    v_pk_fma_f32 v[46:47], v[24:25], v[26:27], v[32:33] op_sel:[1,1,0] op_sel_hi:[0,1,1] neg_lo:[1,0,0]
    v_mul_f32 v7, 0x3d400000, v5
    v_cos_f32 v24, v7
    v_sin_f32 v25, v7
    s_nop 0
    v_pk_mul_f32 v[26:27], v[28:29], v[24:25] op_sel:[0,0] op_sel_hi:[1,0]
    v_pk_fma_f32 v[32:33], v[28:29], v[24:25], v[26:27] op_sel:[1,1,0] op_sel_hi:[0,1,1] neg_lo:[1,0,0]
    v_mul_f32 v7, 0x3d800000, v5
    v_cos_f32 v24, v7
    v_sin_f32 v25, v7
    s_nop 0
    v_pk_mul_f32 v[26:27], v[20:21], v[24:25] op_sel:[0,0] op_sel_hi:[1,0]
    v_pk_fma_f32 v[28:29], v[20:21], v[24:25], v[26:27] op_sel:[1,1,0] op_sel_hi:[0,1,1] neg_lo:[1,0,0]
    v_mul_f32 v7, 0x3da00000, v5
    v_cos_f32 v20, v7
    v_sin_f32 v21, v7
    s_nop 0
    v_pk_mul_f32 v[24:25], v[44:45], v[20:21] op_sel:[0,0] op_sel_hi:[1,0]
    v_pk_fma_f32 v[26:27], v[44:45], v[20:21], v[24:25] op_sel:[1,1,0] op_sel_hi:[0,1,1] neg_lo:[1,0,0]
    v_mul_f32 v7, 0x3dc00000, v5
    v_cos_f32 v20, v7
    v_sin_f32 v21, v7
    s_nop 0
    v_pk_mul_f32 v[24:25], v[38:39], v[20:21] op_sel:[0,0] op_sel_hi:[1,0]
    v_pk_fma_f32 v[44:45], v[38:39], v[20:21], v[24:25] op_sel:[1,1,0] op_sel_hi:[0,1,1] neg_lo:[1,0,0]
    v_mul_f32 v7, 0x3de00000, v5
    v_cos_f32 v20, v7
    v_sin_f32 v21, v7
    s_nop 0
    v_pk_mul_f32 v[24:25], v[34:35], v[20:21] op_sel:[0,0] op_sel_hi:[1,0]
    v_pk_fma_f32 v[38:39], v[34:35], v[20:21], v[24:25] op_sel:[1,1,0] op_sel_hi:[0,1,1] neg_lo:[1,0,0]
    v_mul_f32 v7, 0x3e000000, v5
    v_cos_f32 v20, v7
    v_sin_f32 v21, v7
    s_nop 0
    v_pk_mul_f32 v[24:25], v[18:19], v[20:21] op_sel:[0,0] op_sel_hi:[1,0]
    v_pk_fma_f32 v[34:35], v[18:19], v[20:21], v[24:25] op_sel:[1,1,0] op_sel_hi:[0,1,1] neg_lo:[1,0,0]
    v_mul_f32 v7, 0x3e100000, v5
    v_cos_f32 v18, v7
    v_sin_f32 v19, v7
    s_nop 0
    v_pk_mul_f32 v[20:21], v[42:43], v[18:19] op_sel:[0,0] op_sel_hi:[1,0]
    v_pk_fma_f32 v[24:25], v[42:43], v[18:19], v[20:21] op_sel:[1,1,0] op_sel_hi:[0,1,1] neg_lo:[1,0,0]
    v_mul_f32 v7, 0x3e200000, v5
    v_cos_f32 v18, v7
    v_sin_f32 v19, v7
    s_nop 0
    v_pk_mul_f32 v[20:21], v[36:37], v[18:19] op_sel:[0,0] op_sel_hi:[1,0]
    v_pk_fma_f32 v[42:43], v[36:37], v[18:19], v[20:21] op_sel:[1,1,0] op_sel_hi:[0,1,1] neg_lo:[1,0,0]
    v_mul_f32 v7, 0x3e300000, v5
    v_cos_f32 v18, v7
    v_sin_f32 v19, v7
    s_nop 0
    v_pk_mul_f32 v[20:21], v[30:31], v[18:19] op_sel:[0,0] op_sel_hi:[1,0]
    v_pk_fma_f32 v[36:37], v[30:31], v[18:19], v[20:21] op_sel:[1,1,0] op_sel_hi:[0,1,1] neg_lo:[1,0,0]
    v_mul_f32 v7, 0x3e400000, v5
    v_cos_f32 v18, v7
    v_sin_f32 v19, v7
    s_nop 0
    v_pk_mul_f32 v[20:21], v[22:23], v[18:19] op_sel:[0,0] op_sel_hi:[1,0]
    v_pk_fma_f32 v[30:31], v[22:23], v[18:19], v[20:21] op_sel:[1,1,0] op_sel_hi:[0,1,1] neg_lo:[1,0,0]
    v_mul_f32 v7, 0x3e500000, v5
    v_cos_f32 v18, v7
    v_sin_f32 v19, v7
    s_nop 0
    v_pk_mul_f32 v[20:21], v[50:51], v[18:19] op_sel:[0,0] op_sel_hi:[1,0]
    v_pk_fma_f32 v[22:23], v[50:51], v[18:19], v[20:21] op_sel:[1,1,0] op_sel_hi:[0,1,1] neg_lo:[1,0,0]
    v_mul_f32 v7, 0x3e600000, v5
    v_cos_f32 v18, v7
    v_sin_f32 v19, v7
    s_nop 0
    v_pk_mul_f32 v[20:21], v[48:49], v[18:19] op_sel:[0,0] op_sel_hi:[1,0]
    v_pk_fma_f32 v[50:51], v[48:49], v[18:19], v[20:21] op_sel:[1,1,0] op_sel_hi:[0,1,1] neg_lo:[1,0,0]
    v_mul_f32 v7, 0x3e700000, v5
    v_cos_f32 v18, v7
    v_sin_f32 v19, v7
    s_nop 0
    v_pk_mul_f32 v[20:21], v[40:41], v[18:19] op_sel:[0,0] op_sel_hi:[1,0]
    v_pk_fma_f32 v[48:49], v[40:41], v[18:19], v[20:21] op_sel:[1,1,0] op_sel_hi:[0,1,1] neg_lo:[1,0,0]
    ds_write_b64 v6, v[16:17] offset:0
    ds_write_b64 v6, v[52:53] offset:32
    ds_write_b64 v6, v[46:47] offset:64
    ds_write_b64 v6, v[32:33] offset:96
    ds_write_b64 v6, v[28:29] offset:128
    ds_write_b64 v6, v[26:27] offset:160
    ds_write_b64 v6, v[44:45] offset:192
    ds_write_b64 v6, v[38:39] offset:224
    ds_write_b64 v6, v[34:35] offset:256
    ds_write_b64 v6, v[24:25] offset:288
    ds_write_b64 v6, v[42:43] offset:320
    ds_write_b64 v6, v[36:37] offset:352
    ds_write_b64 v6, v[30:31] offset:384
    ds_write_b64 v6, v[22:23] offset:416
    ds_write_b64 v6, v[50:51] offset:448
    ds_write_b64 v6, v[48:49] offset:480
    v_and_b32 v6, 15, v1
    v_mul_u32_u24 v6, 68, v6
    v_lshrrev_b32 v8, 4, v1
    v_lshl_add_u32 v6, v8, 2, v6
    v_lshl_add_u32 v6, v6, 3, v4
    ds_read_b64 v[16:17], v6 offset:0
    ds_read_b64 v[18:19], v6 offset:8
    ds_read_b64 v[20:21], v6 offset:16
    ds_read_b64 v[22:23], v6 offset:24
    ds_read_b64 v[24:25], v6 offset:128
    ds_read_b64 v[26:27], v6 offset:136
    ds_read_b64 v[28:29], v6 offset:144
    ds_read_b64 v[30:31], v6 offset:152
    ds_read_b64 v[32:33], v6 offset:256
    ds_read_b64 v[34:35], v6 offset:264
    ds_read_b64 v[36:37], v6 offset:272
    ds_read_b64 v[38:39], v6 offset:280
    ds_read_b64 v[40:41], v6 offset:384
    ds_read_b64 v[42:43], v6 offset:392
    ds_read_b64 v[44:45], v6 offset:400
    ds_read_b64 v[46:47], v6 offset:408
    s_waitcnt lgkmcnt(0)
    v_pk_add_f32 v[48:49], v[16:17], v[20:21]
    v_pk_add_f32 v[50:51], v[16:17], v[20:21] neg_lo:[0,1] neg_hi:[0,1]
    v_pk_add_f32 v[52:53], v[18:19], v[22:23]
    v_pk_add_f32 v[54:55], v[18:19], v[22:23] neg_lo:[0,1] neg_hi:[0,1]
    v_pk_add_f32 v[16:17], v[48:49], v[52:53]
    v_pk_add_f32 v[18:19], v[48:49], v[52:53] neg_lo:[0,1] neg_hi:[0,1]
    v_pk_add_f32 v[20:21], v[50:51], v[54:55] op_sel:[0,1] op_sel_hi:[1,0] neg_lo:[0,1]
    v_pk_add_f32 v[22:23], v[50:51], v[54:55] op_sel:[0,1] op_sel_hi:[1,0] neg_hi:[0,1]
    v_pk_add_f32 v[48:49], v[24:25], v[28:29]
    v_pk_add_f32 v[50:51], v[24:25], v[28:29] neg_lo:[0,1] neg_hi:[0,1]
    v_pk_add_f32 v[52:53], v[26:27], v[30:31]
    v_pk_add_f32 v[54:55], v[26:27], v[30:31] neg_lo:[0,1] neg_hi:[0,1]
    v_pk_add_f32 v[24:25], v[48:49], v[52:53]
    v_pk_add_f32 v[26:27], v[48:49], v[52:53] neg_lo:[0,1] neg_hi:[0,1]
    v_pk_add_f32 v[28:29], v[50:51], v[54:55] op_sel:[0,1] op_sel_hi:[1,0] neg_lo:[0,1]
    v_pk_add_f32 v[30:31], v[50:51], v[54:55] op_sel:[0,1] op_sel_hi:[1,0] neg_hi:[0,1]
    v_pk_add_f32 v[48:49], v[32:33], v[36:37]
    v_pk_add_f32 v[50:51], v[32:33], v[36:37] neg_lo:[0,1] neg_hi:[0,1]
    v_pk_add_f32 v[52:53], v[34:35], v[38:39]
    v_pk_add_f32 v[54:55], v[34:35], v[38:39] neg_lo:[0,1] neg_hi:[0,1]
    v_pk_add_f32 v[32:33], v[48:49], v[52:53]
    v_pk_add_f32 v[34:35], v[48:49], v[52:53] neg_lo:[0,1] neg_hi:[0,1]
    v_pk_add_f32 v[36:37], v[50:51], v[54:55] op_sel:[0,1] op_sel_hi:[1,0] neg_lo:[0,1]
    v_pk_add_f32 v[38:39], v[50:51], v[54:55] op_sel:[0,1] op_sel_hi:[1,0] neg_hi:[0,1]
    v_pk_add_f32 v[48:49], v[40:41], v[44:45]
    v_pk_add_f32 v[50:51], v[40:41], v[44:45] neg_lo:[0,1] neg_hi:[0,1]
    v_pk_add_f32 v[52:53], v[42:43], v[46:47]
    v_pk_add_f32 v[54:55], v[42:43], v[46:47] neg_lo:[0,1] neg_hi:[0,1]
    v_pk_add_f32 v[40:41], v[48:49], v[52:53]
    v_pk_add_f32 v[42:43], v[48:49], v[52:53] neg_lo:[0,1] neg_hi:[0,1]
    v_pk_add_f32 v[44:45], v[50:51], v[54:55] op_sel:[0,1] op_sel_hi:[1,0] neg_lo:[0,1]
    v_pk_add_f32 v[46:47], v[50:51], v[54:55] op_sel:[0,1] op_sel_hi:[1,0] neg_hi:[0,1]
    s_waitcnt vmcnt(0)
    s_mov_b32 s34, 0x34800000
    v_mul_f32 v16, s34, v16
    v_mul_f32 v17, s34, v17
    v_cvt_pk_bf16_f32 v9, v16, v17
    v_lshlrev_b32 v16, 16, v9
    v_and_b32 v17, 0xffff0000, v9
    v_lshlrev_b32 v120, 16, v120
    v_lshlrev_b32 v121, 16, v121
    v_add_f32 v16, v16, v120
    v_add_f32 v17, v17, v121
    v_cvt_pk_bf16_f32 v120, v16, v17
    v_lshlrev_b32 v16, 16, v120
    v_and_b32 v17, 0xffff0000, v120
    buffer_store_short v120, v3, s[24:27], 0 offen offset:0
    buffer_store_short_d16_hi v120, v3, s[24:27], 0 offen offset:2048
    v_mul_f32 v24, s34, v24
    v_mul_f32 v25, s34, v25
    v_cvt_pk_bf16_f32 v9, v24, v25
    v_lshlrev_b32 v24, 16, v9
    v_and_b32 v25, 0xffff0000, v9
    v_lshlrev_b32 v122, 16, v122
    v_lshlrev_b32 v123, 16, v123
    v_add_f32 v24, v24, v122
    v_add_f32 v25, v25, v123
    v_cvt_pk_bf16_f32 v122, v24, v25
    v_lshlrev_b32 v24, 16, v122
    v_and_b32 v25, 0xffff0000, v122
    buffer_store_short v122, v3, s[24:27], 0 offen offset:128
    buffer_store_short_d16_hi v122, v3, s[24:27], 0 offen offset:2176
    v_mul_f32 v32, s34, v32
    v_mul_f32 v33, s34, v33
    v_cvt_pk_bf16_f32 v9, v32, v33
    v_lshlrev_b32 v32, 16, v9
    v_and_b32 v33, 0xffff0000, v9
    v_lshlrev_b32 v124, 16, v124
    v_lshlrev_b32 v125, 16, v125
    v_add_f32 v32, v32, v124
    v_add_f32 v33, v33, v125
    v_cvt_pk_bf16_f32 v124, v32, v33
    v_lshlrev_b32 v32, 16, v124
    v_and_b32 v33, 0xffff0000, v124
    buffer_store_short v124, v3, s[24:27], 0 offen offset:256
    buffer_store_short_d16_hi v124, v3, s[24:27], 0 offen offset:2304
    v_mul_f32 v40, s34, v40
    v_mul_f32 v41, s34, v41
    v_cvt_pk_bf16_f32 v9, v40, v41
    v_lshlrev_b32 v40, 16, v9
    v_and_b32 v41, 0xffff0000, v9
    v_lshlrev_b32 v126, 16, v126
    v_lshlrev_b32 v127, 16, v127
    v_add_f32 v40, v40, v126
    v_add_f32 v41, v41, v127
    v_cvt_pk_bf16_f32 v126, v40, v41
    v_lshlrev_b32 v40, 16, v126
    v_and_b32 v41, 0xffff0000, v126
    buffer_store_short v126, v3, s[24:27], 0 offen offset:384
    buffer_store_short_d16_hi v126, v3, s[24:27], 0 offen offset:2432
    v_mul_f32 v20, s34, v20
    v_mul_f32 v21, s34, v21
    v_cvt_pk_bf16_f32 v9, v20, v21
    v_lshlrev_b32 v20, 16, v9
    v_and_b32 v21, 0xffff0000, v9
    v_lshlrev_b32 v128, 16, v128
    v_lshlrev_b32 v129, 16, v129
    v_add_f32 v20, v20, v128
    v_add_f32 v21, v21, v129
    v_cvt_pk_bf16_f32 v128, v20, v21
    v_lshlrev_b32 v20, 16, v128
    v_and_b32 v21, 0xffff0000, v128
    buffer_store_short v128, v3, s[24:27], 0 offen offset:512
    buffer_store_short_d16_hi v128, v3, s[24:27], 0 offen offset:2560
    v_mul_f32 v28, s34, v28
    v_mul_f32 v29, s34, v29
    v_cvt_pk_bf16_f32 v9, v28, v29
    v_lshlrev_b32 v28, 16, v9
    v_and_b32 v29, 0xffff0000, v9
    v_lshlrev_b32 v130, 16, v130
    v_lshlrev_b32 v131, 16, v131
    v_add_f32 v28, v28, v130
    v_add_f32 v29, v29, v131
    v_cvt_pk_bf16_f32 v130, v28, v29
    v_lshlrev_b32 v28, 16, v130
    v_and_b32 v29, 0xffff0000, v130
    buffer_store_short v130, v3, s[24:27], 0 offen offset:640
    buffer_store_short_d16_hi v130, v3, s[24:27], 0 offen offset:2688
    v_mul_f32 v36, s34, v36
    v_mul_f32 v37, s34, v37
    v_cvt_pk_bf16_f32 v9, v36, v37
    v_lshlrev_b32 v36, 16, v9
    v_and_b32 v37, 0xffff0000, v9
    v_lshlrev_b32 v132, 16, v132
    v_lshlrev_b32 v133, 16, v133
    v_add_f32 v36, v36, v132
    v_add_f32 v37, v37, v133
    v_cvt_pk_bf16_f32 v132, v36, v37
    v_lshlrev_b32 v36, 16, v132
    v_and_b32 v37, 0xffff0000, v132
    buffer_store_short v132, v3, s[24:27], 0 offen offset:768
    buffer_store_short_d16_hi v132, v3, s[24:27], 0 offen offset:2816
    v_mul_f32 v44, s34, v44
    v_mul_f32 v45, s34, v45
    v_cvt_pk_bf16_f32 v9, v44, v45
    v_lshlrev_b32 v44, 16, v9
    v_and_b32 v45, 0xffff0000, v9
    v_lshlrev_b32 v134, 16, v134
    v_lshlrev_b32 v135, 16, v135
    v_add_f32 v44, v44, v134
    v_add_f32 v45, v45, v135
    v_cvt_pk_bf16_f32 v134, v44, v45
    v_lshlrev_b32 v44, 16, v134
    v_and_b32 v45, 0xffff0000, v134
    buffer_store_short v134, v3, s[24:27], 0 offen offset:896
    buffer_store_short_d16_hi v134, v3, s[24:27], 0 offen offset:2944
    v_mul_f32 v18, s34, v18
    v_mul_f32 v19, s34, v19
    v_cvt_pk_bf16_f32 v9, v18, v19
    v_lshlrev_b32 v18, 16, v9
    v_and_b32 v19, 0xffff0000, v9
    v_lshlrev_b32 v136, 16, v136
    v_lshlrev_b32 v137, 16, v137
    v_add_f32 v18, v18, v136
    v_add_f32 v19, v19, v137
    v_cvt_pk_bf16_f32 v136, v18, v19
    v_lshlrev_b32 v18, 16, v136
    v_and_b32 v19, 0xffff0000, v136
    buffer_store_short v136, v3, s[24:27], 0 offen offset:1024
    buffer_store_short_d16_hi v136, v3, s[24:27], 0 offen offset:3072
    v_mul_f32 v26, s34, v26
    v_mul_f32 v27, s34, v27
    v_cvt_pk_bf16_f32 v9, v26, v27
    v_lshlrev_b32 v26, 16, v9
    v_and_b32 v27, 0xffff0000, v9
    v_lshlrev_b32 v138, 16, v138
    v_lshlrev_b32 v139, 16, v139
    v_add_f32 v26, v26, v138
    v_add_f32 v27, v27, v139
    v_cvt_pk_bf16_f32 v138, v26, v27
    v_lshlrev_b32 v26, 16, v138
    v_and_b32 v27, 0xffff0000, v138
    buffer_store_short v138, v3, s[24:27], 0 offen offset:1152
    buffer_store_short_d16_hi v138, v3, s[24:27], 0 offen offset:3200
    v_mul_f32 v34, s34, v34
    v_mul_f32 v35, s34, v35
    v_cvt_pk_bf16_f32 v9, v34, v35
    v_lshlrev_b32 v34, 16, v9
    v_and_b32 v35, 0xffff0000, v9
    v_lshlrev_b32 v140, 16, v140
    v_lshlrev_b32 v141, 16, v141
    v_add_f32 v34, v34, v140
    v_add_f32 v35, v35, v141
    v_cvt_pk_bf16_f32 v140, v34, v35
    v_lshlrev_b32 v34, 16, v140
    v_and_b32 v35, 0xffff0000, v140
    buffer_store_short v140, v3, s[24:27], 0 offen offset:1280
    buffer_store_short_d16_hi v140, v3, s[24:27], 0 offen offset:3328
    v_mul_f32 v42, s34, v42
    v_mul_f32 v43, s34, v43
    v_cvt_pk_bf16_f32 v9, v42, v43
    v_lshlrev_b32 v42, 16, v9
    v_and_b32 v43, 0xffff0000, v9
    v_lshlrev_b32 v142, 16, v142
    v_lshlrev_b32 v143, 16, v143
    v_add_f32 v42, v42, v142
    v_add_f32 v43, v43, v143
    v_cvt_pk_bf16_f32 v142, v42, v43
    v_lshlrev_b32 v42, 16, v142
    v_and_b32 v43, 0xffff0000, v142
    buffer_store_short v142, v3, s[24:27], 0 offen offset:1408
    buffer_store_short_d16_hi v142, v3, s[24:27], 0 offen offset:3456
    v_mul_f32 v22, s34, v22
    v_mul_f32 v23, s34, v23
    v_cvt_pk_bf16_f32 v9, v22, v23
    v_lshlrev_b32 v22, 16, v9
    v_and_b32 v23, 0xffff0000, v9
    v_lshlrev_b32 v144, 16, v144
    v_lshlrev_b32 v145, 16, v145
    v_add_f32 v22, v22, v144
    v_add_f32 v23, v23, v145
    v_cvt_pk_bf16_f32 v144, v22, v23
    v_lshlrev_b32 v22, 16, v144
    v_and_b32 v23, 0xffff0000, v144
    buffer_store_short v144, v3, s[24:27], 0 offen offset:1536
    buffer_store_short_d16_hi v144, v3, s[24:27], 0 offen offset:3584
    v_mul_f32 v30, s34, v30
    v_mul_f32 v31, s34, v31
    v_cvt_pk_bf16_f32 v9, v30, v31
    v_lshlrev_b32 v30, 16, v9
    v_and_b32 v31, 0xffff0000, v9
    v_lshlrev_b32 v146, 16, v146
    v_lshlrev_b32 v147, 16, v147
    v_add_f32 v30, v30, v146
    v_add_f32 v31, v31, v147
    v_cvt_pk_bf16_f32 v146, v30, v31
    v_lshlrev_b32 v30, 16, v146
    v_and_b32 v31, 0xffff0000, v146
    buffer_store_short v146, v3, s[24:27], 0 offen offset:1664
    buffer_store_short_d16_hi v146, v3, s[24:27], 0 offen offset:3712
    v_mul_f32 v38, s34, v38
    v_mul_f32 v39, s34, v39
    v_cvt_pk_bf16_f32 v9, v38, v39
    v_lshlrev_b32 v38, 16, v9
    v_and_b32 v39, 0xffff0000, v9
    v_lshlrev_b32 v148, 16, v148
    v_lshlrev_b32 v149, 16, v149
    v_add_f32 v38, v38, v148
    v_add_f32 v39, v39, v149
    v_cvt_pk_bf16_f32 v148, v38, v39
    v_lshlrev_b32 v38, 16, v148
    v_and_b32 v39, 0xffff0000, v148
    buffer_store_short v148, v3, s[24:27], 0 offen offset:1792
    buffer_store_short_d16_hi v148, v3, s[24:27], 0 offen offset:3840
    v_mul_f32 v46, s34, v46
    v_mul_f32 v47, s34, v47
    v_cvt_pk_bf16_f32 v9, v46, v47
    v_lshlrev_b32 v46, 16, v9
    v_and_b32 v47, 0xffff0000, v9
    v_lshlrev_b32 v150, 16, v150
    v_lshlrev_b32 v151, 16, v151
    v_add_f32 v46, v46, v150
    v_add_f32 v47, v47, v151
    v_cvt_pk_bf16_f32 v150, v46, v47
    v_lshlrev_b32 v46, 16, v150
    v_and_b32 v47, 0xffff0000, v150
    buffer_store_short v150, v3, s[24:27], 0 offen offset:1920
    buffer_store_short_d16_hi v150, v3, s[24:27], 0 offen offset:3968
    v_add_f32 v5, v16, v24
    v_add_f32 v5, v5, v32
    v_add_f32 v5, v5, v40
    v_add_f32 v5, v5, v20
    v_add_f32 v5, v5, v28
    v_add_f32 v5, v5, v36
    v_add_f32 v5, v5, v44
    v_add_f32 v5, v5, v18
    v_add_f32 v5, v5, v26
    v_add_f32 v5, v5, v34
    v_add_f32 v5, v5, v42
    v_add_f32 v5, v5, v22
    v_add_f32 v5, v5, v30
    v_add_f32 v5, v5, v38
    v_add_f32 v5, v5, v46
    s_nop 1
    v_add_f32_dpp v5, v5, v5 quad_perm:[1,0,3,2] row_mask:0xf bank_mask:0xf
    s_nop 1
    v_add_f32_dpp v5, v5, v5 quad_perm:[2,3,0,1] row_mask:0xf bank_mask:0xf
    s_nop 1
    v_add_f32_dpp v5, v5, v5 row_half_mirror row_mask:0xf bank_mask:0xf
    s_nop 1
    v_add_f32_dpp v5, v5, v5 row_mirror row_mask:0xf bank_mask:0xf
    s_nop 1
    v_add_f32_dpp v5, v5, v5 row_bcast:15 row_mask:0xa bank_mask:0xf
    s_nop 1
    v_add_f32_dpp v5, v5, v5 row_bcast:31 row_mask:0xc bank_mask:0xf
    s_nop 0
    v_readlane_b32 s20, v5, 63
    v_mov_b32 v6, 0x3a800000
    s_nop 0
    v_mul_f32 v6, s20, v6
    v_sub_f32 v5, v16, v6
    v_mul_f32 v5, v5, v5
    v_add_f32 v7, v17, v25
    v_add_f32 v7, v7, v33
    v_add_f32 v7, v7, v41
    v_add_f32 v7, v7, v21
    v_add_f32 v7, v7, v29
    v_add_f32 v7, v7, v37
    v_add_f32 v7, v7, v45
    v_add_f32 v7, v7, v19
    v_add_f32 v7, v7, v27
    v_add_f32 v7, v7, v35
    v_add_f32 v7, v7, v43
    v_add_f32 v7, v7, v23
    v_add_f32 v7, v7, v31
    v_add_f32 v7, v7, v39
    v_add_f32 v7, v7, v47
    s_nop 1
    v_add_f32_dpp v7, v7, v7 quad_perm:[1,0,3,2] row_mask:0xf bank_mask:0xf
    s_nop 1
    v_add_f32_dpp v7, v7, v7 quad_perm:[2,3,0,1] row_mask:0xf bank_mask:0xf
    s_nop 1
    v_add_f32_dpp v7, v7, v7 row_half_mirror row_mask:0xf bank_mask:0xf
    s_nop 1
    v_add_f32_dpp v7, v7, v7 row_mirror row_mask:0xf bank_mask:0xf
    s_nop 1
    v_add_f32_dpp v7, v7, v7 row_bcast:15 row_mask:0xa bank_mask:0xf
    s_nop 1
    v_add_f32_dpp v7, v7, v7 row_bcast:31 row_mask:0xc bank_mask:0xf
    s_nop 0
    v_readlane_b32 s22, v7, 63
    v_mov_b32 v8, 0x3a800000
    s_nop 0
    v_mul_f32 v8, s22, v8
    v_sub_f32 v7, v17, v8
    v_mul_f32 v7, v7, v7
    v_sub_f32 v9, v24, v6
    v_fmac_f32 v5, v9, v9
    v_sub_f32 v9, v32, v6
    v_fmac_f32 v5, v9, v9
    v_sub_f32 v9, v40, v6
    v_fmac_f32 v5, v9, v9
    v_sub_f32 v9, v20, v6
    v_fmac_f32 v5, v9, v9
    v_sub_f32 v9, v28, v6
    v_fmac_f32 v5, v9, v9
    v_sub_f32 v9, v36, v6
    v_fmac_f32 v5, v9, v9
    v_sub_f32 v9, v44, v6
    v_fmac_f32 v5, v9, v9
    v_sub_f32 v9, v18, v6
    v_fmac_f32 v5, v9, v9
    v_sub_f32 v9, v26, v6
    v_fmac_f32 v5, v9, v9
    v_sub_f32 v9, v34, v6
    v_fmac_f32 v5, v9, v9
    v_sub_f32 v9, v42, v6
    v_fmac_f32 v5, v9, v9
    v_sub_f32 v9, v22, v6
    v_fmac_f32 v5, v9, v9
    v_sub_f32 v9, v30, v6
    v_fmac_f32 v5, v9, v9
    v_sub_f32 v9, v38, v6
    v_fmac_f32 v5, v9, v9
    v_sub_f32 v9, v46, v6
    v_fmac_f32 v5, v9, v9
    s_nop 1
    v_add_f32_dpp v5, v5, v5 quad_perm:[1,0,3,2] row_mask:0xf bank_mask:0xf
    s_nop 1
    v_add_f32_dpp v5, v5, v5 quad_perm:[2,3,0,1] row_mask:0xf bank_mask:0xf
    s_nop 1
    v_add_f32_dpp v5, v5, v5 row_half_mirror row_mask:0xf bank_mask:0xf
    s_nop 1
    v_add_f32_dpp v5, v5, v5 row_mirror row_mask:0xf bank_mask:0xf
    s_nop 1
    v_add_f32_dpp v5, v5, v5 row_bcast:15 row_mask:0xa bank_mask:0xf
    s_nop 1
    v_add_f32_dpp v5, v5, v5 row_bcast:31 row_mask:0xc bank_mask:0xf
    s_nop 0
    v_readlane_b32 s20, v5, 63
    v_mov_b32 v5, 0x3a800000
    s_nop 0
    v_mul_f32 v5, s20, v5
    v_cvt_pk_bf16_f32 v5, v5, v5
    v_lshlrev_b32 v5, 16, v5
    v_add_f32 v5, 0x3727c5ac, v5
    v_cvt_pk_bf16_f32 v5, v5, v5
    v_lshlrev_b32 v5, 16, v5
    v_sqrt_f32 v5, v5
    s_nop 0
    v_cvt_pk_bf16_f32 v5, v5, v5
    v_lshlrev_b32 v5, 16, v5
    v_rcp_f32 v5, v5
    v_cvt_pk_bf16_f32 v6, v6, v6
    v_lshlrev_b32 v6, 16, v6
    v_sub_f32 v16, v16, v6
    v_sub_f32 v24, v24, v6
    v_cvt_pk_bf16_f32 v9, v16, v24
    v_lshlrev_b32 v16, 16, v9
    v_and_b32 v24, 0xffff0000, v9
    v_mul_f32 v16, v16, v5
    v_mul_f32 v24, v24, v5
    v_cvt_pk_bf16_f32 v9, v16, v24
    v_lshlrev_b32 v16, 16, v9
    v_and_b32 v24, 0xffff0000, v9
    v_sub_f32 v32, v32, v6
    v_sub_f32 v40, v40, v6
    v_cvt_pk_bf16_f32 v9, v32, v40
    v_lshlrev_b32 v32, 16, v9
    v_and_b32 v40, 0xffff0000, v9
    v_mul_f32 v32, v32, v5
    v_mul_f32 v40, v40, v5
    v_cvt_pk_bf16_f32 v9, v32, v40
    v_lshlrev_b32 v32, 16, v9
    v_and_b32 v40, 0xffff0000, v9
    v_sub_f32 v20, v20, v6
    v_sub_f32 v28, v28, v6
    v_cvt_pk_bf16_f32 v9, v20, v28
    v_lshlrev_b32 v20, 16, v9
    v_and_b32 v28, 0xffff0000, v9
    v_mul_f32 v20, v20, v5
    v_mul_f32 v28, v28, v5
    v_cvt_pk_bf16_f32 v9, v20, v28
    v_lshlrev_b32 v20, 16, v9
    v_and_b32 v28, 0xffff0000, v9
    v_sub_f32 v36, v36, v6
    v_sub_f32 v44, v44, v6
    v_cvt_pk_bf16_f32 v9, v36, v44
    v_lshlrev_b32 v36, 16, v9
    v_and_b32 v44, 0xffff0000, v9
    v_mul_f32 v36, v36, v5
    v_mul_f32 v44, v44, v5
    v_cvt_pk_bf16_f32 v9, v36, v44
    v_lshlrev_b32 v36, 16, v9
    v_and_b32 v44, 0xffff0000, v9
    v_sub_f32 v18, v18, v6
    v_sub_f32 v26, v26, v6
    v_cvt_pk_bf16_f32 v9, v18, v26
    v_lshlrev_b32 v18, 16, v9
    v_and_b32 v26, 0xffff0000, v9
    v_mul_f32 v18, v18, v5
    v_mul_f32 v26, v26, v5
    v_cvt_pk_bf16_f32 v9, v18, v26
    v_lshlrev_b32 v18, 16, v9
    v_and_b32 v26, 0xffff0000, v9
    v_sub_f32 v34, v34, v6
    v_sub_f32 v42, v42, v6
    v_cvt_pk_bf16_f32 v9, v34, v42
    v_lshlrev_b32 v34, 16, v9
    v_and_b32 v42, 0xffff0000, v9
    v_mul_f32 v34, v34, v5
    v_mul_f32 v42, v42, v5
    v_cvt_pk_bf16_f32 v9, v34, v42
    v_lshlrev_b32 v34, 16, v9
    v_and_b32 v42, 0xffff0000, v9
    v_sub_f32 v22, v22, v6
    v_sub_f32 v30, v30, v6
    v_cvt_pk_bf16_f32 v9, v22, v30
    v_lshlrev_b32 v22, 16, v9
    v_and_b32 v30, 0xffff0000, v9
    v_mul_f32 v22, v22, v5
    v_mul_f32 v30, v30, v5
    v_cvt_pk_bf16_f32 v9, v22, v30
    v_lshlrev_b32 v22, 16, v9
    v_and_b32 v30, 0xffff0000, v9
    v_sub_f32 v38, v38, v6
    v_sub_f32 v46, v46, v6
    v_cvt_pk_bf16_f32 v9, v38, v46
    v_lshlrev_b32 v38, 16, v9
    v_and_b32 v46, 0xffff0000, v9
    v_mul_f32 v38, v38, v5
    v_mul_f32 v46, v46, v5
    v_cvt_pk_bf16_f32 v9, v38, v46
    v_lshlrev_b32 v38, 16, v9
    v_and_b32 v46, 0xffff0000, v9
    v_sub_f32 v10, v25, v8
    v_fmac_f32 v7, v10, v10
    v_sub_f32 v10, v33, v8
    v_fmac_f32 v7, v10, v10
    v_sub_f32 v10, v41, v8
    v_fmac_f32 v7, v10, v10
    v_sub_f32 v10, v21, v8
    v_fmac_f32 v7, v10, v10
    v_sub_f32 v10, v29, v8
    v_fmac_f32 v7, v10, v10
    v_sub_f32 v10, v37, v8
    v_fmac_f32 v7, v10, v10
    v_sub_f32 v10, v45, v8
    v_fmac_f32 v7, v10, v10
    v_sub_f32 v10, v19, v8
    v_fmac_f32 v7, v10, v10
    v_sub_f32 v10, v27, v8
    v_fmac_f32 v7, v10, v10
    v_sub_f32 v10, v35, v8
    v_fmac_f32 v7, v10, v10
    v_sub_f32 v10, v43, v8
    v_fmac_f32 v7, v10, v10
    v_sub_f32 v10, v23, v8
    v_fmac_f32 v7, v10, v10
    v_sub_f32 v10, v31, v8
    v_fmac_f32 v7, v10, v10
    v_sub_f32 v10, v39, v8
    v_fmac_f32 v7, v10, v10
    v_sub_f32 v10, v47, v8
    v_fmac_f32 v7, v10, v10
    s_nop 1
    v_add_f32_dpp v7, v7, v7 quad_perm:[1,0,3,2] row_mask:0xf bank_mask:0xf
    s_nop 1
    v_add_f32_dpp v7, v7, v7 quad_perm:[2,3,0,1] row_mask:0xf bank_mask:0xf
    s_nop 1
    v_add_f32_dpp v7, v7, v7 row_half_mirror row_mask:0xf bank_mask:0xf
    s_nop 1
    v_add_f32_dpp v7, v7, v7 row_mirror row_mask:0xf bank_mask:0xf
    s_nop 1
    v_add_f32_dpp v7, v7, v7 row_bcast:15 row_mask:0xa bank_mask:0xf
    s_nop 1
    v_add_f32_dpp v7, v7, v7 row_bcast:31 row_mask:0xc bank_mask:0xf
    s_nop 0
    v_readlane_b32 s22, v7, 63
    v_mov_b32 v7, 0x3a800000
    s_nop 0
    v_mul_f32 v7, s22, v7
    v_cvt_pk_bf16_f32 v7, v7, v7
    v_lshlrev_b32 v7, 16, v7
    v_add_f32 v7, 0x3727c5ac, v7
    v_cvt_pk_bf16_f32 v7, v7, v7
    v_lshlrev_b32 v7, 16, v7
    v_sqrt_f32 v7, v7
    s_nop 0
    v_cvt_pk_bf16_f32 v7, v7, v7
    v_lshlrev_b32 v7, 16, v7
    v_rcp_f32 v7, v7
    v_cvt_pk_bf16_f32 v8, v8, v8
    v_lshlrev_b32 v8, 16, v8
    v_sub_f32 v17, v17, v8
    v_sub_f32 v25, v25, v8
    v_cvt_pk_bf16_f32 v10, v17, v25
    v_lshlrev_b32 v17, 16, v10
    v_and_b32 v25, 0xffff0000, v10
    v_mul_f32 v17, v17, v7
    v_mul_f32 v25, v25, v7
    v_cvt_pk_bf16_f32 v10, v17, v25
    v_lshlrev_b32 v17, 16, v10
    v_and_b32 v25, 0xffff0000, v10
    v_sub_f32 v33, v33, v8
    v_sub_f32 v41, v41, v8
    v_cvt_pk_bf16_f32 v10, v33, v41
    v_lshlrev_b32 v33, 16, v10
    v_and_b32 v41, 0xffff0000, v10
    v_mul_f32 v33, v33, v7
    v_mul_f32 v41, v41, v7
    v_cvt_pk_bf16_f32 v10, v33, v41
    v_lshlrev_b32 v33, 16, v10
    v_and_b32 v41, 0xffff0000, v10
    v_sub_f32 v21, v21, v8
    v_sub_f32 v29, v29, v8
    v_cvt_pk_bf16_f32 v10, v21, v29
    v_lshlrev_b32 v21, 16, v10
    v_and_b32 v29, 0xffff0000, v10
    v_mul_f32 v21, v21, v7
    v_mul_f32 v29, v29, v7
    v_cvt_pk_bf16_f32 v10, v21, v29
    v_lshlrev_b32 v21, 16, v10
    v_and_b32 v29, 0xffff0000, v10
    v_sub_f32 v37, v37, v8
    v_sub_f32 v45, v45, v8
    v_cvt_pk_bf16_f32 v10, v37, v45
    v_lshlrev_b32 v37, 16, v10
    v_and_b32 v45, 0xffff0000, v10
    v_mul_f32 v37, v37, v7
    v_mul_f32 v45, v45, v7
    v_cvt_pk_bf16_f32 v10, v37, v45
    v_lshlrev_b32 v37, 16, v10
    v_and_b32 v45, 0xffff0000, v10
    v_sub_f32 v19, v19, v8
    v_sub_f32 v27, v27, v8
    v_cvt_pk_bf16_f32 v10, v19, v27
    v_lshlrev_b32 v19, 16, v10
    v_and_b32 v27, 0xffff0000, v10
    v_mul_f32 v19, v19, v7
    v_mul_f32 v27, v27, v7
    v_cvt_pk_bf16_f32 v10, v19, v27
    v_lshlrev_b32 v19, 16, v10
    v_and_b32 v27, 0xffff0000, v10
    v_sub_f32 v35, v35, v8
    v_sub_f32 v43, v43, v8
    v_cvt_pk_bf16_f32 v10, v35, v43
    v_lshlrev_b32 v35, 16, v10
    v_and_b32 v43, 0xffff0000, v10
    v_mul_f32 v35, v35, v7
    v_mul_f32 v43, v43, v7
    v_cvt_pk_bf16_f32 v10, v35, v43
    v_lshlrev_b32 v35, 16, v10
    v_and_b32 v43, 0xffff0000, v10
    v_sub_f32 v23, v23, v8
    v_sub_f32 v31, v31, v8
    v_cvt_pk_bf16_f32 v10, v23, v31
    v_lshlrev_b32 v23, 16, v10
    v_and_b32 v31, 0xffff0000, v10
    v_mul_f32 v23, v23, v7
    v_mul_f32 v31, v31, v7
    v_cvt_pk_bf16_f32 v10, v23, v31
    v_lshlrev_b32 v23, 16, v10
    v_and_b32 v31, 0xffff0000, v10
    v_sub_f32 v39, v39, v8
    v_sub_f32 v47, v47, v8
    v_cvt_pk_bf16_f32 v10, v39, v47
    v_lshlrev_b32 v39, 16, v10
    v_and_b32 v47, 0xffff0000, v10
    v_mul_f32 v39, v39, v7
    v_mul_f32 v47, v47, v7
    v_cvt_pk_bf16_f32 v10, v39, v47
    v_lshlrev_b32 v39, 16, v10
    v_and_b32 v47, 0xffff0000, v10
    buffer_store_short_d16_hi v16, v3, s[28:31], 0 offen offset:0
    buffer_store_short_d16_hi v17, v3, s[28:31], 0 offen offset:2048
    buffer_store_short_d16_hi v24, v3, s[28:31], 0 offen offset:128
    buffer_store_short_d16_hi v25, v3, s[28:31], 0 offen offset:2176
    buffer_store_short_d16_hi v32, v3, s[28:31], 0 offen offset:256
    buffer_store_short_d16_hi v33, v3, s[28:31], 0 offen offset:2304
    buffer_store_short_d16_hi v40, v3, s[28:31], 0 offen offset:384
    buffer_store_short_d16_hi v41, v3, s[28:31], 0 offen offset:2432
    buffer_store_short_d16_hi v20, v3, s[28:31], 0 offen offset:512
    buffer_store_short_d16_hi v21, v3, s[28:31], 0 offen offset:2560
    buffer_store_short_d16_hi v28, v3, s[28:31], 0 offen offset:640
    buffer_store_short_d16_hi v29, v3, s[28:31], 0 offen offset:2688
    buffer_store_short_d16_hi v36, v3, s[28:31], 0 offen offset:768
    buffer_store_short_d16_hi v37, v3, s[28:31], 0 offen offset:2816
    buffer_store_short_d16_hi v44, v3, s[28:31], 0 offen offset:896
    buffer_store_short_d16_hi v45, v3, s[28:31], 0 offen offset:2944
    buffer_store_short_d16_hi v18, v3, s[28:31], 0 offen offset:1024
    buffer_store_short_d16_hi v19, v3, s[28:31], 0 offen offset:3072
    buffer_store_short_d16_hi v26, v3, s[28:31], 0 offen offset:1152
    buffer_store_short_d16_hi v27, v3, s[28:31], 0 offen offset:3200
    buffer_store_short_d16_hi v34, v3, s[28:31], 0 offen offset:1280
    buffer_store_short_d16_hi v35, v3, s[28:31], 0 offen offset:3328
    buffer_store_short_d16_hi v42, v3, s[28:31], 0 offen offset:1408
    buffer_store_short_d16_hi v43, v3, s[28:31], 0 offen offset:3456
    buffer_store_short_d16_hi v22, v3, s[28:31], 0 offen offset:1536
    buffer_store_short_d16_hi v23, v3, s[28:31], 0 offen offset:3584
    buffer_store_short_d16_hi v30, v3, s[28:31], 0 offen offset:1664
    buffer_store_short_d16_hi v31, v3, s[28:31], 0 offen offset:3712
    buffer_store_short_d16_hi v38, v3, s[28:31], 0 offen offset:1792
    buffer_store_short_d16_hi v39, v3, s[28:31], 0 offen offset:3840
    buffer_store_short_d16_hi v46, v3, s[28:31], 0 offen offset:1920
    buffer_store_short_d16_hi v47, v3, s[28:31], 0 offen offset:3968
fc_end:
    s_endpgm
.globl gemm1_kernel
.p2align 8
.type gemm1_kernel,@function
gemm1_kernel:
    s_load_dwordx4 s[4:7], s[0:1], 32
    s_load_dwordx2 s[16:17], s[0:1], 72
    s_cmp_ge_u32 s2, 256
    s_cbranch_scc1 gemm1_kernel_end
    s_waitcnt lgkmcnt(0)
    s_mov_b32 s8, s4
    s_and_b32 s9, s5, 0xffff
    s_mov_b32 s10, 7340032
    s_mov_b32 s11, 0x00020000
    s_add_u32 s12, s16, 25165824
    s_addc_u32 s13, s17, 0
    s_and_b32 s13, s13, 0xffff
    s_mov_b32 s14, 4194304
    s_mov_b32 s15, 0x00020000
    s_mov_b32 s20, s6
    s_and_b32 s21, s7, 0xffff
    s_mov_b32 s22, 7168
    s_mov_b32 s23, 0x00020000
    s_add_u32 s24, s16, 33554432
    s_addc_u32 s25, s17, 0
    s_and_b32 s25, s25, 0xffff
    s_mov_b32 s26, 14680064
    s_mov_b32 s27, 0x00020000
    s_add_u32 s52, s16, 62914560
    s_addc_u32 s53, s17, 0
    s_and_b32 s53, s53, 0xffff
    s_mov_b32 s54, 131072
    s_mov_b32 s55, 0x00020000
    s_and_b32 s28, s2, 7
    s_lshr_b32 s29, s2, 3
    s_and_b32 s30, s28, 1
    s_lshl_b32 s30, s30, 3
    s_and_b32 s31, s29, 7
    s_add_u32 s30, s30, s31
    s_lshr_b32 s31, s28, 1
    s_lshl_b32 s31, s31, 2
    s_lshr_b32 s32, s29, 3
    s_add_u32 s31, s31, s32
    s_lshl_b32 s33, s30, 7
    s_mul_i32 s34, s31, 224
    v_and_b32 v1, 63, v0
    v_lshrrev_b32 v2, 6, v0
    v_and_b32 v3, 15, v1
    v_lshrrev_b32 v4, 4, v1
    v_readfirstlane_b32 s35, v2
    v_lshrrev_b32 v5, 3, v1
    v_and_b32 v6, 7, v1
    v_xor_b32 v6, v6, v5
    v_lshl_add_u32 v5, v2, 4, v5
    v_add_u32 v5, s33, v5
    s_mov_b32 s36, 2048
    v_mul_lo_u32 v5, v5, s36
    v_lshl_add_u32 v5, v6, 4, v5
    v_add_u32 v163, 4096, v5
    v_add_u32 v164, 19456, v5
    s_lshl_b32 s37, s34, 1
    s_mov_b32 s38, 7168
    v_mul_u32_u24 v5, 256, v2
    v_add_u32 v5, v5, v1
    v_add_u32 v5, 0, v5
    v_mul_u32_u24 v6, 2341, v5
    v_lshrrev_b32 v6, 16, v6
    v_mul_u32_u24 v7, 28, v6
    v_sub_u32 v170, v5, v7
    v_bfe_u32 v7, v6, 3, 1
    v_lshlrev_b32 v7, 1, v7
    v_xor_b32 v170, v170, v7
    v_mul_lo_u32 v6, v6, s38
    v_lshl_add_u32 v6, v170, 4, v6
    v_add_u32 v6, s37, v6
    v_add_u32 v6, 4096, v6
    v_cmp_le_u32 vcc, 1792, v5
    v_mov_b32 v7, 0x7fffffff
    s_nop 0
    v_cndmask_b32 v6, v6, v7, vcc
    v_mov_b32 v165, v6
    v_mul_u32_u24 v5, 256, v2
    v_add_u32 v5, v5, v1
    v_add_u32 v5, 64, v5
    v_mul_u32_u24 v6, 2341, v5
    v_lshrrev_b32 v6, 16, v6
    v_mul_u32_u24 v7, 28, v6
    v_sub_u32 v170, v5, v7
    v_bfe_u32 v7, v6, 3, 1
    v_lshlrev_b32 v7, 1, v7
    v_xor_b32 v170, v170, v7
    v_mul_lo_u32 v6, v6, s38
    v_lshl_add_u32 v6, v170, 4, v6
    v_add_u32 v6, s37, v6
    v_add_u32 v6, 3072, v6
    v_cmp_le_u32 vcc, 1792, v5
    v_mov_b32 v7, 0x7fffffff
    s_nop 0
    v_cndmask_b32 v6, v6, v7, vcc
    v_mov_b32 v166, v6
    v_mul_u32_u24 v5, 256, v2
    v_add_u32 v5, v5, v1
    v_add_u32 v5, 128, v5
    v_mul_u32_u24 v6, 2341, v5
    v_lshrrev_b32 v6, 16, v6
    v_mul_u32_u24 v7, 28, v6
    v_sub_u32 v170, v5, v7
    v_bfe_u32 v7, v6, 3, 1
    v_lshlrev_b32 v7, 1, v7
    v_xor_b32 v170, v170, v7
    v_mul_lo_u32 v6, v6, s38
    v_lshl_add_u32 v6, v170, 4, v6
    v_add_u32 v6, s37, v6
    v_add_u32 v6, 2048, v6
    v_cmp_le_u32 vcc, 1792, v5
    v_mov_b32 v7, 0x7fffffff
    s_nop 0
    v_cndmask_b32 v6, v6, v7, vcc
    v_mov_b32 v167, v6
    v_mul_u32_u24 v5, 256, v2
    v_add_u32 v5, v5, v1
    v_add_u32 v5, 192, v5
    v_mul_u32_u24 v6, 2341, v5
    v_lshrrev_b32 v6, 16, v6
    v_mul_u32_u24 v7, 28, v6
    v_sub_u32 v170, v5, v7
    v_bfe_u32 v7, v6, 3, 1
    v_lshlrev_b32 v7, 1, v7
    v_xor_b32 v170, v170, v7
    v_mul_lo_u32 v6, v6, s38
    v_lshl_add_u32 v6, v170, 4, v6
    v_add_u32 v6, s37, v6
    v_add_u32 v6, 1024, v6
    v_cmp_le_u32 vcc, 1792, v5
    v_mov_b32 v7, 0x7fffffff
    s_nop 0
    v_cndmask_b32 v6, v6, v7, vcc
    v_mov_b32 v168, v6
    s_sub_u32 s8, s8, 4096
    s_subb_u32 s9, s9, 0
    s_add_u32 s10, s10, 4096
    s_sub_u32 s12, s12, 4096
    s_subb_u32 s13, s13, 0
    s_add_u32 s14, s14, 4096
    v_and_b32 v5, 3, v2
    v_mul_u32_u24 v5, 32, v5
    v_add_u32 v5, v5, v3
    v_lshlrev_b32 v5, 7, v5
    v_and_b32 v6, 7, v1
    v_or_b32 v7, 0, v4
    v_xor_b32 v7, v7, v6
    v_lshl_add_u32 v7, v7, 4, v5
    v_add_u32 v136, 0, v7
    v_add_u32 v138, 49152, v7
    v_add_u32 v140, 98304, v7
    v_or_b32 v7, 4, v4
    v_xor_b32 v7, v7, v6
    v_lshl_add_u32 v7, v7, 4, v5
    v_add_u32 v137, 0, v7
    v_add_u32 v139, 49152, v7
    v_add_u32 v141, 98304, v7
    v_lshrrev_b32 v5, 2, v3
    v_lshl_add_u32 v6, v4, 3, v5
    v_mul_u32_u24 v6, 448, v6
    v_and_b32 v7, 3, v1
    v_lshl_add_u32 v6, v7, 3, v6
    v_and_b32 v7, 1, v4
    v_lshlrev_b32 v7, 1, v7
    v_lshrrev_b32 v5, 2, v2
    v_mul_u32_u24 v5, 14, v5
    v_add_u32 v170, 0, v5
    v_xor_b32 v170, v170, v7
    v_lshl_add_u32 v170, v170, 4, v6
    v_add_u32 v142, 16384, v170
    v_add_u32 v149, 65536, v170
    v_add_u32 v156, 114688, v170
    v_add_u32 v170, 2, v5
    v_xor_b32 v170, v170, v7
    v_lshl_add_u32 v170, v170, 4, v6
    v_add_u32 v143, 16384, v170
    v_add_u32 v150, 65536, v170
    v_add_u32 v157, 114688, v170
    v_add_u32 v170, 4, v5
    v_xor_b32 v170, v170, v7
    v_lshl_add_u32 v170, v170, 4, v6
    v_add_u32 v144, 16384, v170
    v_add_u32 v151, 65536, v170
    v_add_u32 v158, 114688, v170
    v_add_u32 v170, 6, v5
    v_xor_b32 v170, v170, v7
    v_lshl_add_u32 v170, v170, 4, v6
    v_add_u32 v145, 16384, v170
    v_add_u32 v152, 65536, v170
    v_add_u32 v159, 114688, v170
    v_add_u32 v170, 8, v5
    v_xor_b32 v170, v170, v7
    v_lshl_add_u32 v170, v170, 4, v6
    v_add_u32 v146, 16384, v170
    v_add_u32 v153, 65536, v170
    v_add_u32 v160, 114688, v170
    v_add_u32 v170, 10, v5
    v_xor_b32 v170, v170, v7
    v_lshl_add_u32 v170, v170, 4, v6
    v_add_u32 v147, 16384, v170
    v_add_u32 v154, 65536, v170
    v_add_u32 v161, 114688, v170
    v_add_u32 v170, 12, v5
    v_xor_b32 v170, v170, v7
    v_lshl_add_u32 v170, v170, 4, v6
    v_add_u32 v148, 16384, v170
    v_add_u32 v155, 65536, v170
    v_add_u32 v162, 114688, v170
    s_mul_i32 s40, s35, 2048
    s_mul_i32 s41, s35, 4096
    s_add_u32 s41, s41, 16384
    s_lshl_b32 s56, s35, 10
    s_mov_b32 s57, 0
    s_add_u32 m0, s40, 0
    s_lshl_b32 s42, s57, 7
    s_mul_i32 s43, s57, 458752
    buffer_load_dwordx4 v163, s[12:15], s42 offen offset:0 lds
    buffer_load_dwordx4 v164, s[12:15], s42 offen offset:1024 lds
    s_add_u32 s57, s57, 1
    s_cmp_eq_u32 s57, 16
    s_cselect_b32 s57, 0, s57
    s_add_u32 m0, s41, 0
    s_nop 0
    buffer_load_dwordx4 v165, s[8:11], s43 offen offset:0 lds
    buffer_load_dwordx4 v166, s[8:11], s43 offen offset:1024 lds
    buffer_load_dwordx4 v167, s[8:11], s43 offen offset:2048 lds
    buffer_load_dwordx4 v168, s[8:11], s43 offen offset:3072 lds
    s_add_u32 m0, s40, 49152
    s_lshl_b32 s42, s57, 7
    s_mul_i32 s43, s57, 458752
    buffer_load_dwordx4 v163, s[12:15], s42 offen offset:0 lds
    buffer_load_dwordx4 v164, s[12:15], s42 offen offset:1024 lds
    s_add_u32 s57, s57, 1
    s_cmp_eq_u32 s57, 16
    s_cselect_b32 s57, 0, s57
    s_add_u32 m0, s41, 49152
    s_nop 0
    buffer_load_dwordx4 v165, s[8:11], s43 offen offset:0 lds
    buffer_load_dwordx4 v166, s[8:11], s43 offen offset:1024 lds
    buffer_load_dwordx4 v167, s[8:11], s43 offen offset:2048 lds
    buffer_load_dwordx4 v168, s[8:11], s43 offen offset:3072 lds
    s_add_u32 m0, s40, 98304
    s_lshl_b32 s42, s57, 7
    s_mul_i32 s43, s57, 458752
    buffer_load_dwordx4 v163, s[12:15], s42 offen offset:0 lds
    buffer_load_dwordx4 v164, s[12:15], s42 offen offset:1024 lds
    s_add_u32 s57, s57, 1
    s_cmp_eq_u32 s57, 16
    s_cselect_b32 s57, 0, s57
    s_add_u32 m0, s41, 98304
    s_nop 0
    buffer_load_dwordx4 v165, s[8:11], s43 offen offset:0 lds
    buffer_load_dwordx4 v166, s[8:11], s43 offen offset:1024 lds
    buffer_load_dwordx4 v167, s[8:11], s43 offen offset:2048 lds
    buffer_load_dwordx4 v168, s[8:11], s43 offen offset:3072 lds
    s_waitcnt vmcnt(12)
    s_barrier
    ds_read_b128 v[120:123], v136 offset:0
    ds_read_b128 v[124:127], v136 offset:2048
    ds_read_b64_tr_b16 v[64:65], v142 offset:0
    ds_read_b64_tr_b16 v[66:67], v142 offset:1792
    ds_read_b64_tr_b16 v[68:69], v143 offset:0
    ds_read_b64_tr_b16 v[70:71], v143 offset:1792
    ds_read_b64_tr_b16 v[72:73], v144 offset:0
    ds_read_b64_tr_b16 v[74:75], v144 offset:1792
    ds_read_b64_tr_b16 v[76:77], v145 offset:0
    ds_read_b64_tr_b16 v[78:79], v145 offset:1792
    ds_read_b64_tr_b16 v[80:81], v146 offset:0
    ds_read_b64_tr_b16 v[82:83], v146 offset:1792
    ds_read_b64_tr_b16 v[84:85], v147 offset:0
    ds_read_b64_tr_b16 v[86:87], v147 offset:1792
    ds_read_b64_tr_b16 v[88:89], v148 offset:0
    ds_read_b64_tr_b16 v[90:91], v148 offset:1792
    s_waitcnt lgkmcnt(0)
    v_mfma_f32_16x16x32_bf16 v[8:11], v[64:67], v[120:123], 0
    ds_read_b128 v[128:131], v137 offset:0
    ds_read_b128 v[132:135], v137 offset:2048
    v_mfma_f32_16x16x32_bf16 v[36:39], v[64:67], v[124:127], 0
    ds_read_b64_tr_b16 v[92:93], v142 offset:14336
    ds_read_b64_tr_b16 v[94:95], v142 offset:16128
    v_mfma_f32_16x16x32_bf16 v[12:15], v[68:71], v[120:123], 0
    ds_read_b64_tr_b16 v[96:97], v143 offset:14336
    ds_read_b64_tr_b16 v[98:99], v143 offset:16128
    v_mfma_f32_16x16x32_bf16 v[40:43], v[68:71], v[124:127], 0
    ds_read_b64_tr_b16 v[100:101], v144 offset:14336
    ds_read_b64_tr_b16 v[102:103], v144 offset:16128
    v_mfma_f32_16x16x32_bf16 v[16:19], v[72:75], v[120:123], 0
    ds_read_b64_tr_b16 v[104:105], v145 offset:14336
    ds_read_b64_tr_b16 v[106:107], v145 offset:16128
    v_mfma_f32_16x16x32_bf16 v[44:47], v[72:75], v[124:127], 0
    ds_read_b64_tr_b16 v[108:109], v146 offset:14336
    ds_read_b64_tr_b16 v[110:111], v146 offset:16128
    v_mfma_f32_16x16x32_bf16 v[20:23], v[76:79], v[120:123], 0
    ds_read_b64_tr_b16 v[112:113], v147 offset:14336
    ds_read_b64_tr_b16 v[114:115], v147 offset:16128
    v_mfma_f32_16x16x32_bf16 v[48:51], v[76:79], v[124:127], 0
    ds_read_b64_tr_b16 v[116:117], v148 offset:14336
    ds_read_b64_tr_b16 v[118:119], v148 offset:16128
    v_mfma_f32_16x16x32_bf16 v[24:27], v[80:83], v[120:123], 0
    v_mfma_f32_16x16x32_bf16 v[52:55], v[80:83], v[124:127], 0
    v_mfma_f32_16x16x32_bf16 v[28:31], v[84:87], v[120:123], 0
    v_mfma_f32_16x16x32_bf16 v[56:59], v[84:87], v[124:127], 0
    v_mfma_f32_16x16x32_bf16 v[32:35], v[88:91], v[120:123], 0
    v_mfma_f32_16x16x32_bf16 v[60:63], v[88:91], v[124:127], 0
    s_waitcnt vmcnt(6) lgkmcnt(0)
    s_barrier
    v_mfma_f32_16x16x32_bf16 v[8:11], v[92:95], v[128:131], v[8:11]
    ds_read_b128 v[120:123], v138 offset:0
    ds_read_b128 v[124:127], v138 offset:2048
    v_mfma_f32_16x16x32_bf16 v[36:39], v[92:95], v[132:135], v[36:39]
    ds_read_b64_tr_b16 v[64:65], v149 offset:0
    ds_read_b64_tr_b16 v[66:67], v149 offset:1792
    v_mfma_f32_16x16x32_bf16 v[12:15], v[96:99], v[128:131], v[12:15]
    ds_read_b64_tr_b16 v[68:69], v150 offset:0
    ds_read_b64_tr_b16 v[70:71], v150 offset:1792
    v_mfma_f32_16x16x32_bf16 v[40:43], v[96:99], v[132:135], v[40:43]
    ds_read_b64_tr_b16 v[72:73], v151 offset:0
    ds_read_b64_tr_b16 v[74:75], v151 offset:1792
    v_mfma_f32_16x16x32_bf16 v[16:19], v[100:103], v[128:131], v[16:19]
    ds_read_b64_tr_b16 v[76:77], v152 offset:0
    ds_read_b64_tr_b16 v[78:79], v152 offset:1792
    v_mfma_f32_16x16x32_bf16 v[44:47], v[100:103], v[132:135], v[44:47]
    ds_read_b64_tr_b16 v[80:81], v153 offset:0
    ds_read_b64_tr_b16 v[82:83], v153 offset:1792
    v_mfma_f32_16x16x32_bf16 v[20:23], v[104:107], v[128:131], v[20:23]
    ds_read_b64_tr_b16 v[84:85], v154 offset:0
    ds_read_b64_tr_b16 v[86:87], v154 offset:1792
    v_mfma_f32_16x16x32_bf16 v[48:51], v[104:107], v[132:135], v[48:51]
    ds_read_b64_tr_b16 v[88:89], v155 offset:0
    ds_read_b64_tr_b16 v[90:91], v155 offset:1792
    v_mfma_f32_16x16x32_bf16 v[24:27], v[108:111], v[128:131], v[24:27]
    s_add_u32 m0, s40, 0
    s_lshl_b32 s42, s57, 7
    s_mul_i32 s43, s57, 458752
    buffer_load_dwordx4 v163, s[12:15], s42 offen offset:0 lds
    buffer_load_dwordx4 v164, s[12:15], s42 offen offset:1024 lds
    v_mfma_f32_16x16x32_bf16 v[52:55], v[108:111], v[132:135], v[52:55]
    s_add_u32 s57, s57, 1
    s_cmp_eq_u32 s57, 16
    s_cselect_b32 s57, 0, s57
    s_add_u32 m0, s41, 0
    s_nop 0
    buffer_load_dwordx4 v165, s[8:11], s43 offen offset:0 lds
    buffer_load_dwordx4 v166, s[8:11], s43 offen offset:1024 lds
    v_mfma_f32_16x16x32_bf16 v[28:31], v[112:115], v[128:131], v[28:31]
    buffer_load_dwordx4 v167, s[8:11], s43 offen offset:2048 lds
    buffer_load_dwordx4 v168, s[8:11], s43 offen offset:3072 lds
    v_mfma_f32_16x16x32_bf16 v[56:59], v[112:115], v[132:135], v[56:59]
    v_mfma_f32_16x16x32_bf16 v[32:35], v[116:119], v[128:131], v[32:35]
    v_mfma_f32_16x16x32_bf16 v[60:63], v[116:119], v[132:135], v[60:63]
    s_waitcnt lgkmcnt(0)
    v_mfma_f32_16x16x32_bf16 v[8:11], v[64:67], v[120:123], v[8:11]
    ds_read_b128 v[128:131], v139 offset:0
    ds_read_b128 v[132:135], v139 offset:2048
    v_mfma_f32_16x16x32_bf16 v[36:39], v[64:67], v[124:127], v[36:39]
    ds_read_b64_tr_b16 v[92:93], v149 offset:14336
    ds_read_b64_tr_b16 v[94:95], v149 offset:16128
    v_mfma_f32_16x16x32_bf16 v[12:15], v[68:71], v[120:123], v[12:15]
    ds_read_b64_tr_b16 v[96:97], v150 offset:14336
    ds_read_b64_tr_b16 v[98:99], v150 offset:16128
    v_mfma_f32_16x16x32_bf16 v[40:43], v[68:71], v[124:127], v[40:43]
    ds_read_b64_tr_b16 v[100:101], v151 offset:14336
    ds_read_b64_tr_b16 v[102:103], v151 offset:16128
    v_mfma_f32_16x16x32_bf16 v[16:19], v[72:75], v[120:123], v[16:19]
    ds_read_b64_tr_b16 v[104:105], v152 offset:14336
    ds_read_b64_tr_b16 v[106:107], v152 offset:16128
    v_mfma_f32_16x16x32_bf16 v[44:47], v[72:75], v[124:127], v[44:47]
    ds_read_b64_tr_b16 v[108:109], v153 offset:14336
    ds_read_b64_tr_b16 v[110:111], v153 offset:16128
    v_mfma_f32_16x16x32_bf16 v[20:23], v[76:79], v[120:123], v[20:23]
    ds_read_b64_tr_b16 v[112:113], v154 offset:14336
    ds_read_b64_tr_b16 v[114:115], v154 offset:16128
    v_mfma_f32_16x16x32_bf16 v[48:51], v[76:79], v[124:127], v[48:51]
    ds_read_b64_tr_b16 v[116:117], v155 offset:14336
    ds_read_b64_tr_b16 v[118:119], v155 offset:16128
    v_mfma_f32_16x16x32_bf16 v[24:27], v[80:83], v[120:123], v[24:27]
    v_mfma_f32_16x16x32_bf16 v[52:55], v[80:83], v[124:127], v[52:55]
    v_mfma_f32_16x16x32_bf16 v[28:31], v[84:87], v[120:123], v[28:31]
    v_mfma_f32_16x16x32_bf16 v[56:59], v[84:87], v[124:127], v[56:59]
    v_mfma_f32_16x16x32_bf16 v[32:35], v[88:91], v[120:123], v[32:35]
    v_mfma_f32_16x16x32_bf16 v[60:63], v[88:91], v[124:127], v[60:63]
    s_waitcnt vmcnt(6) lgkmcnt(0)
    s_barrier
    v_mfma_f32_16x16x32_bf16 v[8:11], v[92:95], v[128:131], v[8:11]
    ds_read_b128 v[120:123], v140 offset:0
    ds_read_b128 v[124:127], v140 offset:2048
    v_mfma_f32_16x16x32_bf16 v[36:39], v[92:95], v[132:135], v[36:39]
    ds_read_b64_tr_b16 v[64:65], v156 offset:0
    ds_read_b64_tr_b16 v[66:67], v156 offset:1792
    v_mfma_f32_16x16x32_bf16 v[12:15], v[96:99], v[128:131], v[12:15]
    ds_read_b64_tr_b16 v[68:69], v157 offset:0
    ds_read_b64_tr_b16 v[70:71], v157 offset:1792
    v_mfma_f32_16x16x32_bf16 v[40:43], v[96:99], v[132:135], v[40:43]
    ds_read_b64_tr_b16 v[72:73], v158 offset:0
    ds_read_b64_tr_b16 v[74:75], v158 offset:1792
    v_mfma_f32_16x16x32_bf16 v[16:19], v[100:103], v[128:131], v[16:19]
    ds_read_b64_tr_b16 v[76:77], v159 offset:0
    ds_read_b64_tr_b16 v[78:79], v159 offset:1792
    v_mfma_f32_16x16x32_bf16 v[44:47], v[100:103], v[132:135], v[44:47]
    ds_read_b64_tr_b16 v[80:81], v160 offset:0
    ds_read_b64_tr_b16 v[82:83], v160 offset:1792
    v_mfma_f32_16x16x32_bf16 v[20:23], v[104:107], v[128:131], v[20:23]
    ds_read_b64_tr_b16 v[84:85], v161 offset:0
    ds_read_b64_tr_b16 v[86:87], v161 offset:1792
    v_mfma_f32_16x16x32_bf16 v[48:51], v[104:107], v[132:135], v[48:51]
    ds_read_b64_tr_b16 v[88:89], v162 offset:0
    ds_read_b64_tr_b16 v[90:91], v162 offset:1792
    v_mfma_f32_16x16x32_bf16 v[24:27], v[108:111], v[128:131], v[24:27]
    s_add_u32 m0, s40, 49152
    s_lshl_b32 s42, s57, 7
    s_mul_i32 s43, s57, 458752
    buffer_load_dwordx4 v163, s[12:15], s42 offen offset:0 lds
    buffer_load_dwordx4 v164, s[12:15], s42 offen offset:1024 lds
    v_mfma_f32_16x16x32_bf16 v[52:55], v[108:111], v[132:135], v[52:55]
    s_add_u32 s57, s57, 1
    s_cmp_eq_u32 s57, 16
    s_cselect_b32 s57, 0, s57
    s_add_u32 m0, s41, 49152
    s_nop 0
    buffer_load_dwordx4 v165, s[8:11], s43 offen offset:0 lds
    buffer_load_dwordx4 v166, s[8:11], s43 offen offset:1024 lds
    v_mfma_f32_16x16x32_bf16 v[28:31], v[112:115], v[128:131], v[28:31]
    buffer_load_dwordx4 v167, s[8:11], s43 offen offset:2048 lds
    buffer_load_dwordx4 v168, s[8:11], s43 offen offset:3072 lds
    v_mfma_f32_16x16x32_bf16 v[56:59], v[112:115], v[132:135], v[56:59]
    v_mfma_f32_16x16x32_bf16 v[32:35], v[116:119], v[128:131], v[32:35]
    v_mfma_f32_16x16x32_bf16 v[60:63], v[116:119], v[132:135], v[60:63]
    s_waitcnt lgkmcnt(0)
    v_mfma_f32_16x16x32_bf16 v[8:11], v[64:67], v[120:123], v[8:11]
    ds_read_b128 v[128:131], v141 offset:0
    ds_read_b128 v[132:135], v141 offset:2048
    v_mfma_f32_16x16x32_bf16 v[36:39], v[64:67], v[124:127], v[36:39]
    ds_read_b64_tr_b16 v[92:93], v156 offset:14336
    ds_read_b64_tr_b16 v[94:95], v156 offset:16128
    v_mfma_f32_16x16x32_bf16 v[12:15], v[68:71], v[120:123], v[12:15]
    ds_read_b64_tr_b16 v[96:97], v157 offset:14336
    ds_read_b64_tr_b16 v[98:99], v157 offset:16128
    v_mfma_f32_16x16x32_bf16 v[40:43], v[68:71], v[124:127], v[40:43]
    ds_read_b64_tr_b16 v[100:101], v158 offset:14336
    ds_read_b64_tr_b16 v[102:103], v158 offset:16128
    v_mfma_f32_16x16x32_bf16 v[16:19], v[72:75], v[120:123], v[16:19]
    ds_read_b64_tr_b16 v[104:105], v159 offset:14336
    ds_read_b64_tr_b16 v[106:107], v159 offset:16128
    v_mfma_f32_16x16x32_bf16 v[44:47], v[72:75], v[124:127], v[44:47]
    ds_read_b64_tr_b16 v[108:109], v160 offset:14336
    ds_read_b64_tr_b16 v[110:111], v160 offset:16128
    v_mfma_f32_16x16x32_bf16 v[20:23], v[76:79], v[120:123], v[20:23]
    ds_read_b64_tr_b16 v[112:113], v161 offset:14336
    ds_read_b64_tr_b16 v[114:115], v161 offset:16128
    v_mfma_f32_16x16x32_bf16 v[48:51], v[76:79], v[124:127], v[48:51]
    ds_read_b64_tr_b16 v[116:117], v162 offset:14336
    ds_read_b64_tr_b16 v[118:119], v162 offset:16128
    v_mfma_f32_16x16x32_bf16 v[24:27], v[80:83], v[120:123], v[24:27]
    v_mfma_f32_16x16x32_bf16 v[52:55], v[80:83], v[124:127], v[52:55]
    v_mfma_f32_16x16x32_bf16 v[28:31], v[84:87], v[120:123], v[28:31]
    v_mfma_f32_16x16x32_bf16 v[56:59], v[84:87], v[124:127], v[56:59]
    v_mfma_f32_16x16x32_bf16 v[32:35], v[88:91], v[120:123], v[32:35]
    v_mfma_f32_16x16x32_bf16 v[60:63], v[88:91], v[124:127], v[60:63]
    s_waitcnt vmcnt(6) lgkmcnt(0)
    s_barrier
    v_mfma_f32_16x16x32_bf16 v[8:11], v[92:95], v[128:131], v[8:11]
    ds_read_b128 v[120:123], v136 offset:0
    ds_read_b128 v[124:127], v136 offset:2048
    v_mfma_f32_16x16x32_bf16 v[36:39], v[92:95], v[132:135], v[36:39]
    ds_read_b64_tr_b16 v[64:65], v142 offset:0
    ds_read_b64_tr_b16 v[66:67], v142 offset:1792
    v_mfma_f32_16x16x32_bf16 v[12:15], v[96:99], v[128:131], v[12:15]
    ds_read_b64_tr_b16 v[68:69], v143 offset:0
    ds_read_b64_tr_b16 v[70:71], v143 offset:1792
    v_mfma_f32_16x16x32_bf16 v[40:43], v[96:99], v[132:135], v[40:43]
    ds_read_b64_tr_b16 v[72:73], v144 offset:0
    ds_read_b64_tr_b16 v[74:75], v144 offset:1792
    v_mfma_f32_16x16x32_bf16 v[16:19], v[100:103], v[128:131], v[16:19]
    ds_read_b64_tr_b16 v[76:77], v145 offset:0
    ds_read_b64_tr_b16 v[78:79], v145 offset:1792
    v_mfma_f32_16x16x32_bf16 v[44:47], v[100:103], v[132:135], v[44:47]
    ds_read_b64_tr_b16 v[80:81], v146 offset:0
    ds_read_b64_tr_b16 v[82:83], v146 offset:1792
    v_mfma_f32_16x16x32_bf16 v[20:23], v[104:107], v[128:131], v[20:23]
    ds_read_b64_tr_b16 v[84:85], v147 offset:0
    ds_read_b64_tr_b16 v[86:87], v147 offset:1792
    v_mfma_f32_16x16x32_bf16 v[48:51], v[104:107], v[132:135], v[48:51]
    ds_read_b64_tr_b16 v[88:89], v148 offset:0
    ds_read_b64_tr_b16 v[90:91], v148 offset:1792
    v_mfma_f32_16x16x32_bf16 v[24:27], v[108:111], v[128:131], v[24:27]
    s_add_u32 m0, s40, 98304
    s_lshl_b32 s42, s57, 7
    s_mul_i32 s43, s57, 458752
    buffer_load_dwordx4 v163, s[12:15], s42 offen offset:0 lds
    buffer_load_dwordx4 v164, s[12:15], s42 offen offset:1024 lds
    v_mfma_f32_16x16x32_bf16 v[52:55], v[108:111], v[132:135], v[52:55]
    s_add_u32 s57, s57, 1
    s_cmp_eq_u32 s57, 16
    s_cselect_b32 s57, 0, s57
    s_add_u32 m0, s41, 98304
    s_nop 0
    buffer_load_dwordx4 v165, s[8:11], s43 offen offset:0 lds
    buffer_load_dwordx4 v166, s[8:11], s43 offen offset:1024 lds
    v_mfma_f32_16x16x32_bf16 v[28:31], v[112:115], v[128:131], v[28:31]
    buffer_load_dwordx4 v167, s[8:11], s43 offen offset:2048 lds
    buffer_load_dwordx4 v168, s[8:11], s43 offen offset:3072 lds
    v_mfma_f32_16x16x32_bf16 v[56:59], v[112:115], v[132:135], v[56:59]
    v_mfma_f32_16x16x32_bf16 v[32:35], v[116:119], v[128:131], v[32:35]
    v_mfma_f32_16x16x32_bf16 v[60:63], v[116:119], v[132:135], v[60:63]
    s_waitcnt lgkmcnt(0)
    v_mfma_f32_16x16x32_bf16 v[8:11], v[64:67], v[120:123], v[8:11]
    ds_read_b128 v[128:131], v137 offset:0
    ds_read_b128 v[132:135], v137 offset:2048
    v_mfma_f32_16x16x32_bf16 v[36:39], v[64:67], v[124:127], v[36:39]
    ds_read_b64_tr_b16 v[92:93], v142 offset:14336
    ds_read_b64_tr_b16 v[94:95], v142 offset:16128
    v_mfma_f32_16x16x32_bf16 v[12:15], v[68:71], v[120:123], v[12:15]
    ds_read_b64_tr_b16 v[96:97], v143 offset:14336
    ds_read_b64_tr_b16 v[98:99], v143 offset:16128
    v_mfma_f32_16x16x32_bf16 v[40:43], v[68:71], v[124:127], v[40:43]
    ds_read_b64_tr_b16 v[100:101], v144 offset:14336
    ds_read_b64_tr_b16 v[102:103], v144 offset:16128
    v_mfma_f32_16x16x32_bf16 v[16:19], v[72:75], v[120:123], v[16:19]
    ds_read_b64_tr_b16 v[104:105], v145 offset:14336
    ds_read_b64_tr_b16 v[106:107], v145 offset:16128
    v_mfma_f32_16x16x32_bf16 v[44:47], v[72:75], v[124:127], v[44:47]
    ds_read_b64_tr_b16 v[108:109], v146 offset:14336
    ds_read_b64_tr_b16 v[110:111], v146 offset:16128
    v_mfma_f32_16x16x32_bf16 v[20:23], v[76:79], v[120:123], v[20:23]
    ds_read_b64_tr_b16 v[112:113], v147 offset:14336
    ds_read_b64_tr_b16 v[114:115], v147 offset:16128
    v_mfma_f32_16x16x32_bf16 v[48:51], v[76:79], v[124:127], v[48:51]
    ds_read_b64_tr_b16 v[116:117], v148 offset:14336
    ds_read_b64_tr_b16 v[118:119], v148 offset:16128
    v_mfma_f32_16x16x32_bf16 v[24:27], v[80:83], v[120:123], v[24:27]
    v_mfma_f32_16x16x32_bf16 v[52:55], v[80:83], v[124:127], v[52:55]
    v_mfma_f32_16x16x32_bf16 v[28:31], v[84:87], v[120:123], v[28:31]
    v_mfma_f32_16x16x32_bf16 v[56:59], v[84:87], v[124:127], v[56:59]
    v_mfma_f32_16x16x32_bf16 v[32:35], v[88:91], v[120:123], v[32:35]
    v_mfma_f32_16x16x32_bf16 v[60:63], v[88:91], v[124:127], v[60:63]
    s_waitcnt vmcnt(6) lgkmcnt(0)
    s_barrier
    v_mfma_f32_16x16x32_bf16 v[8:11], v[92:95], v[128:131], v[8:11]
    ds_read_b128 v[120:123], v138 offset:0
    ds_read_b128 v[124:127], v138 offset:2048
    v_mfma_f32_16x16x32_bf16 v[36:39], v[92:95], v[132:135], v[36:39]
    ds_read_b64_tr_b16 v[64:65], v149 offset:0
    ds_read_b64_tr_b16 v[66:67], v149 offset:1792
    v_mfma_f32_16x16x32_bf16 v[12:15], v[96:99], v[128:131], v[12:15]
    ds_read_b64_tr_b16 v[68:69], v150 offset:0
    ds_read_b64_tr_b16 v[70:71], v150 offset:1792
    v_mfma_f32_16x16x32_bf16 v[40:43], v[96:99], v[132:135], v[40:43]
    ds_read_b64_tr_b16 v[72:73], v151 offset:0
    ds_read_b64_tr_b16 v[74:75], v151 offset:1792
    v_mfma_f32_16x16x32_bf16 v[16:19], v[100:103], v[128:131], v[16:19]
    ds_read_b64_tr_b16 v[76:77], v152 offset:0
    ds_read_b64_tr_b16 v[78:79], v152 offset:1792
    v_mfma_f32_16x16x32_bf16 v[44:47], v[100:103], v[132:135], v[44:47]
    ds_read_b64_tr_b16 v[80:81], v153 offset:0
    ds_read_b64_tr_b16 v[82:83], v153 offset:1792
    v_mfma_f32_16x16x32_bf16 v[20:23], v[104:107], v[128:131], v[20:23]
    ds_read_b64_tr_b16 v[84:85], v154 offset:0
    ds_read_b64_tr_b16 v[86:87], v154 offset:1792
    v_mfma_f32_16x16x32_bf16 v[48:51], v[104:107], v[132:135], v[48:51]
    ds_read_b64_tr_b16 v[88:89], v155 offset:0
    ds_read_b64_tr_b16 v[90:91], v155 offset:1792
    v_mfma_f32_16x16x32_bf16 v[24:27], v[108:111], v[128:131], v[24:27]
    s_add_u32 m0, s40, 0
    s_lshl_b32 s42, s57, 7
    s_mul_i32 s43, s57, 458752
    buffer_load_dwordx4 v163, s[12:15], s42 offen offset:0 lds
    buffer_load_dwordx4 v164, s[12:15], s42 offen offset:1024 lds
    v_mfma_f32_16x16x32_bf16 v[52:55], v[108:111], v[132:135], v[52:55]
    s_add_u32 s57, s57, 1
    s_cmp_eq_u32 s57, 16
    s_cselect_b32 s57, 0, s57
    s_add_u32 m0, s41, 0
    s_nop 0
    buffer_load_dwordx4 v165, s[8:11], s43 offen offset:0 lds
    buffer_load_dwordx4 v166, s[8:11], s43 offen offset:1024 lds
    v_mfma_f32_16x16x32_bf16 v[28:31], v[112:115], v[128:131], v[28:31]
    buffer_load_dwordx4 v167, s[8:11], s43 offen offset:2048 lds
    buffer_load_dwordx4 v168, s[8:11], s43 offen offset:3072 lds
    v_mfma_f32_16x16x32_bf16 v[56:59], v[112:115], v[132:135], v[56:59]
    v_mfma_f32_16x16x32_bf16 v[32:35], v[116:119], v[128:131], v[32:35]
    v_mfma_f32_16x16x32_bf16 v[60:63], v[116:119], v[132:135], v[60:63]
    s_waitcnt lgkmcnt(0)
    v_mfma_f32_16x16x32_bf16 v[8:11], v[64:67], v[120:123], v[8:11]
    ds_read_b128 v[128:131], v139 offset:0
    ds_read_b128 v[132:135], v139 offset:2048
    v_mfma_f32_16x16x32_bf16 v[36:39], v[64:67], v[124:127], v[36:39]
    ds_read_b64_tr_b16 v[92:93], v149 offset:14336
    ds_read_b64_tr_b16 v[94:95], v149 offset:16128
    v_mfma_f32_16x16x32_bf16 v[12:15], v[68:71], v[120:123], v[12:15]
    ds_read_b64_tr_b16 v[96:97], v150 offset:14336
    ds_read_b64_tr_b16 v[98:99], v150 offset:16128
    v_mfma_f32_16x16x32_bf16 v[40:43], v[68:71], v[124:127], v[40:43]
    ds_read_b64_tr_b16 v[100:101], v151 offset:14336
    ds_read_b64_tr_b16 v[102:103], v151 offset:16128
    v_mfma_f32_16x16x32_bf16 v[16:19], v[72:75], v[120:123], v[16:19]
    ds_read_b64_tr_b16 v[104:105], v152 offset:14336
    ds_read_b64_tr_b16 v[106:107], v152 offset:16128
    v_mfma_f32_16x16x32_bf16 v[44:47], v[72:75], v[124:127], v[44:47]
    ds_read_b64_tr_b16 v[108:109], v153 offset:14336
    ds_read_b64_tr_b16 v[110:111], v153 offset:16128
    v_mfma_f32_16x16x32_bf16 v[20:23], v[76:79], v[120:123], v[20:23]
    ds_read_b64_tr_b16 v[112:113], v154 offset:14336
    ds_read_b64_tr_b16 v[114:115], v154 offset:16128
    v_mfma_f32_16x16x32_bf16 v[48:51], v[76:79], v[124:127], v[48:51]
    ds_read_b64_tr_b16 v[116:117], v155 offset:14336
    ds_read_b64_tr_b16 v[118:119], v155 offset:16128
    v_mfma_f32_16x16x32_bf16 v[24:27], v[80:83], v[120:123], v[24:27]
    v_mfma_f32_16x16x32_bf16 v[52:55], v[80:83], v[124:127], v[52:55]
    v_mfma_f32_16x16x32_bf16 v[28:31], v[84:87], v[120:123], v[28:31]
    v_mfma_f32_16x16x32_bf16 v[56:59], v[84:87], v[124:127], v[56:59]
    v_mfma_f32_16x16x32_bf16 v[32:35], v[88:91], v[120:123], v[32:35]
    v_mfma_f32_16x16x32_bf16 v[60:63], v[88:91], v[124:127], v[60:63]
    s_waitcnt vmcnt(6) lgkmcnt(0)
    s_barrier
    v_mfma_f32_16x16x32_bf16 v[8:11], v[92:95], v[128:131], v[8:11]
    ds_read_b128 v[120:123], v140 offset:0
    ds_read_b128 v[124:127], v140 offset:2048
    v_mfma_f32_16x16x32_bf16 v[36:39], v[92:95], v[132:135], v[36:39]
    ds_read_b64_tr_b16 v[64:65], v156 offset:0
    ds_read_b64_tr_b16 v[66:67], v156 offset:1792
    v_mfma_f32_16x16x32_bf16 v[12:15], v[96:99], v[128:131], v[12:15]
    ds_read_b64_tr_b16 v[68:69], v157 offset:0
    ds_read_b64_tr_b16 v[70:71], v157 offset:1792
    v_mfma_f32_16x16x32_bf16 v[40:43], v[96:99], v[132:135], v[40:43]
    ds_read_b64_tr_b16 v[72:73], v158 offset:0
    ds_read_b64_tr_b16 v[74:75], v158 offset:1792
    v_mfma_f32_16x16x32_bf16 v[16:19], v[100:103], v[128:131], v[16:19]
    ds_read_b64_tr_b16 v[76:77], v159 offset:0
    ds_read_b64_tr_b16 v[78:79], v159 offset:1792
    v_mfma_f32_16x16x32_bf16 v[44:47], v[100:103], v[132:135], v[44:47]
    ds_read_b64_tr_b16 v[80:81], v160 offset:0
    ds_read_b64_tr_b16 v[82:83], v160 offset:1792
    v_mfma_f32_16x16x32_bf16 v[20:23], v[104:107], v[128:131], v[20:23]
    ds_read_b64_tr_b16 v[84:85], v161 offset:0
    ds_read_b64_tr_b16 v[86:87], v161 offset:1792
    v_mfma_f32_16x16x32_bf16 v[48:51], v[104:107], v[132:135], v[48:51]
    ds_read_b64_tr_b16 v[88:89], v162 offset:0
    ds_read_b64_tr_b16 v[90:91], v162 offset:1792
    v_mfma_f32_16x16x32_bf16 v[24:27], v[108:111], v[128:131], v[24:27]
    s_add_u32 m0, s40, 49152
    s_lshl_b32 s42, s57, 7
    s_mul_i32 s43, s57, 458752
    buffer_load_dwordx4 v163, s[12:15], s42 offen offset:0 lds
    buffer_load_dwordx4 v164, s[12:15], s42 offen offset:1024 lds
    v_mfma_f32_16x16x32_bf16 v[52:55], v[108:111], v[132:135], v[52:55]
    s_add_u32 s57, s57, 1
    s_cmp_eq_u32 s57, 16
    s_cselect_b32 s57, 0, s57
    s_add_u32 m0, s41, 49152
    s_nop 0
    buffer_load_dwordx4 v165, s[8:11], s43 offen offset:0 lds
    buffer_load_dwordx4 v166, s[8:11], s43 offen offset:1024 lds
    v_mfma_f32_16x16x32_bf16 v[28:31], v[112:115], v[128:131], v[28:31]
    buffer_load_dwordx4 v167, s[8:11], s43 offen offset:2048 lds
    buffer_load_dwordx4 v168, s[8:11], s43 offen offset:3072 lds
    v_mfma_f32_16x16x32_bf16 v[56:59], v[112:115], v[132:135], v[56:59]
    v_mfma_f32_16x16x32_bf16 v[32:35], v[116:119], v[128:131], v[32:35]
    v_mfma_f32_16x16x32_bf16 v[60:63], v[116:119], v[132:135], v[60:63]
    s_waitcnt lgkmcnt(0)
    v_mfma_f32_16x16x32_bf16 v[8:11], v[64:67], v[120:123], v[8:11]
    ds_read_b128 v[128:131], v141 offset:0
    ds_read_b128 v[132:135], v141 offset:2048
    v_mfma_f32_16x16x32_bf16 v[36:39], v[64:67], v[124:127], v[36:39]
    ds_read_b64_tr_b16 v[92:93], v156 offset:14336
    ds_read_b64_tr_b16 v[94:95], v156 offset:16128
    v_mfma_f32_16x16x32_bf16 v[12:15], v[68:71], v[120:123], v[12:15]
    ds_read_b64_tr_b16 v[96:97], v157 offset:14336
    ds_read_b64_tr_b16 v[98:99], v157 offset:16128
    v_mfma_f32_16x16x32_bf16 v[40:43], v[68:71], v[124:127], v[40:43]
    ds_read_b64_tr_b16 v[100:101], v158 offset:14336
    ds_read_b64_tr_b16 v[102:103], v158 offset:16128
    v_mfma_f32_16x16x32_bf16 v[16:19], v[72:75], v[120:123], v[16:19]
    ds_read_b64_tr_b16 v[104:105], v159 offset:14336
    ds_read_b64_tr_b16 v[106:107], v159 offset:16128
    v_mfma_f32_16x16x32_bf16 v[44:47], v[72:75], v[124:127], v[44:47]
    ds_read_b64_tr_b16 v[108:109], v160 offset:14336
    ds_read_b64_tr_b16 v[110:111], v160 offset:16128
    v_mfma_f32_16x16x32_bf16 v[20:23], v[76:79], v[120:123], v[20:23]
    ds_read_b64_tr_b16 v[112:113], v161 offset:14336
    ds_read_b64_tr_b16 v[114:115], v161 offset:16128
    v_mfma_f32_16x16x32_bf16 v[48:51], v[76:79], v[124:127], v[48:51]
    ds_read_b64_tr_b16 v[116:117], v162 offset:14336
    ds_read_b64_tr_b16 v[118:119], v162 offset:16128
    v_mfma_f32_16x16x32_bf16 v[24:27], v[80:83], v[120:123], v[24:27]
    v_mfma_f32_16x16x32_bf16 v[52:55], v[80:83], v[124:127], v[52:55]
    v_mfma_f32_16x16x32_bf16 v[28:31], v[84:87], v[120:123], v[28:31]
    v_mfma_f32_16x16x32_bf16 v[56:59], v[84:87], v[124:127], v[56:59]
    v_mfma_f32_16x16x32_bf16 v[32:35], v[88:91], v[120:123], v[32:35]
    v_mfma_f32_16x16x32_bf16 v[60:63], v[88:91], v[124:127], v[60:63]
    s_waitcnt vmcnt(6) lgkmcnt(0)
    s_barrier
    v_mfma_f32_16x16x32_bf16 v[8:11], v[92:95], v[128:131], v[8:11]
    ds_read_b128 v[120:123], v136 offset:0
    ds_read_b128 v[124:127], v136 offset:2048
    v_mfma_f32_16x16x32_bf16 v[36:39], v[92:95], v[132:135], v[36:39]
    ds_read_b64_tr_b16 v[64:65], v142 offset:0
    ds_read_b64_tr_b16 v[66:67], v142 offset:1792
    v_mfma_f32_16x16x32_bf16 v[12:15], v[96:99], v[128:131], v[12:15]
    ds_read_b64_tr_b16 v[68:69], v143 offset:0
    ds_read_b64_tr_b16 v[70:71], v143 offset:1792
    v_mfma_f32_16x16x32_bf16 v[40:43], v[96:99], v[132:135], v[40:43]
    ds_read_b64_tr_b16 v[72:73], v144 offset:0
    ds_read_b64_tr_b16 v[74:75], v144 offset:1792
    v_mfma_f32_16x16x32_bf16 v[16:19], v[100:103], v[128:131], v[16:19]
    ds_read_b64_tr_b16 v[76:77], v145 offset:0
    ds_read_b64_tr_b16 v[78:79], v145 offset:1792
    v_mfma_f32_16x16x32_bf16 v[44:47], v[100:103], v[132:135], v[44:47]
    ds_read_b64_tr_b16 v[80:81], v146 offset:0
    ds_read_b64_tr_b16 v[82:83], v146 offset:1792
    v_mfma_f32_16x16x32_bf16 v[20:23], v[104:107], v[128:131], v[20:23]
    ds_read_b64_tr_b16 v[84:85], v147 offset:0
    ds_read_b64_tr_b16 v[86:87], v147 offset:1792
    v_mfma_f32_16x16x32_bf16 v[48:51], v[104:107], v[132:135], v[48:51]
    ds_read_b64_tr_b16 v[88:89], v148 offset:0
    ds_read_b64_tr_b16 v[90:91], v148 offset:1792
    v_mfma_f32_16x16x32_bf16 v[24:27], v[108:111], v[128:131], v[24:27]
    s_add_u32 m0, s40, 98304
    s_lshl_b32 s42, s57, 7
    s_mul_i32 s43, s57, 458752
    buffer_load_dwordx4 v163, s[12:15], s42 offen offset:0 lds
    buffer_load_dwordx4 v164, s[12:15], s42 offen offset:1024 lds
    v_mfma_f32_16x16x32_bf16 v[52:55], v[108:111], v[132:135], v[52:55]
    s_add_u32 s57, s57, 1
    s_cmp_eq_u32 s57, 16
    s_cselect_b32 s57, 0, s57
    s_add_u32 m0, s41, 98304
    s_nop 0
    buffer_load_dwordx4 v165, s[8:11], s43 offen offset:0 lds
    buffer_load_dwordx4 v166, s[8:11], s43 offen offset:1024 lds
    v_mfma_f32_16x16x32_bf16 v[28:31], v[112:115], v[128:131], v[28:31]
    buffer_load_dwordx4 v167, s[8:11], s43 offen offset:2048 lds
    buffer_load_dwordx4 v168, s[8:11], s43 offen offset:3072 lds
    v_mfma_f32_16x16x32_bf16 v[56:59], v[112:115], v[132:135], v[56:59]
    v_mfma_f32_16x16x32_bf16 v[32:35], v[116:119], v[128:131], v[32:35]
    v_mfma_f32_16x16x32_bf16 v[60:63], v[116:119], v[132:135], v[60:63]
    s_waitcnt lgkmcnt(0)
    v_mfma_f32_16x16x32_bf16 v[8:11], v[64:67], v[120:123], v[8:11]
    ds_read_b128 v[128:131], v137 offset:0
    ds_read_b128 v[132:135], v137 offset:2048
    v_mfma_f32_16x16x32_bf16 v[36:39], v[64:67], v[124:127], v[36:39]
    ds_read_b64_tr_b16 v[92:93], v142 offset:14336
    ds_read_b64_tr_b16 v[94:95], v142 offset:16128
    v_mfma_f32_16x16x32_bf16 v[12:15], v[68:71], v[120:123], v[12:15]
    ds_read_b64_tr_b16 v[96:97], v143 offset:14336
    ds_read_b64_tr_b16 v[98:99], v143 offset:16128
    v_mfma_f32_16x16x32_bf16 v[40:43], v[68:71], v[124:127], v[40:43]
    ds_read_b64_tr_b16 v[100:101], v144 offset:14336
    ds_read_b64_tr_b16 v[102:103], v144 offset:16128
    v_mfma_f32_16x16x32_bf16 v[16:19], v[72:75], v[120:123], v[16:19]
    ds_read_b64_tr_b16 v[104:105], v145 offset:14336
    ds_read_b64_tr_b16 v[106:107], v145 offset:16128
    v_mfma_f32_16x16x32_bf16 v[44:47], v[72:75], v[124:127], v[44:47]
    ds_read_b64_tr_b16 v[108:109], v146 offset:14336
    ds_read_b64_tr_b16 v[110:111], v146 offset:16128
    v_mfma_f32_16x16x32_bf16 v[20:23], v[76:79], v[120:123], v[20:23]
    ds_read_b64_tr_b16 v[112:113], v147 offset:14336
    ds_read_b64_tr_b16 v[114:115], v147 offset:16128
    v_mfma_f32_16x16x32_bf16 v[48:51], v[76:79], v[124:127], v[48:51]
    ds_read_b64_tr_b16 v[116:117], v148 offset:14336
    ds_read_b64_tr_b16 v[118:119], v148 offset:16128
    v_mfma_f32_16x16x32_bf16 v[24:27], v[80:83], v[120:123], v[24:27]
    v_mfma_f32_16x16x32_bf16 v[52:55], v[80:83], v[124:127], v[52:55]
    v_mfma_f32_16x16x32_bf16 v[28:31], v[84:87], v[120:123], v[28:31]
    v_mfma_f32_16x16x32_bf16 v[56:59], v[84:87], v[124:127], v[56:59]
    v_mfma_f32_16x16x32_bf16 v[32:35], v[88:91], v[120:123], v[32:35]
    v_mfma_f32_16x16x32_bf16 v[60:63], v[88:91], v[124:127], v[60:63]
    s_waitcnt vmcnt(6) lgkmcnt(0)
    s_barrier
    v_mfma_f32_16x16x32_bf16 v[8:11], v[92:95], v[128:131], v[8:11]
    ds_read_b128 v[120:123], v138 offset:0
    ds_read_b128 v[124:127], v138 offset:2048
    v_mfma_f32_16x16x32_bf16 v[36:39], v[92:95], v[132:135], v[36:39]
    ds_read_b64_tr_b16 v[64:65], v149 offset:0
    ds_read_b64_tr_b16 v[66:67], v149 offset:1792
    v_mfma_f32_16x16x32_bf16 v[12:15], v[96:99], v[128:131], v[12:15]
    ds_read_b64_tr_b16 v[68:69], v150 offset:0
    ds_read_b64_tr_b16 v[70:71], v150 offset:1792
    v_mfma_f32_16x16x32_bf16 v[40:43], v[96:99], v[132:135], v[40:43]
    ds_read_b64_tr_b16 v[72:73], v151 offset:0
    ds_read_b64_tr_b16 v[74:75], v151 offset:1792
    v_mfma_f32_16x16x32_bf16 v[16:19], v[100:103], v[128:131], v[16:19]
    ds_read_b64_tr_b16 v[76:77], v152 offset:0
    ds_read_b64_tr_b16 v[78:79], v152 offset:1792
    v_mfma_f32_16x16x32_bf16 v[44:47], v[100:103], v[132:135], v[44:47]
    ds_read_b64_tr_b16 v[80:81], v153 offset:0
    ds_read_b64_tr_b16 v[82:83], v153 offset:1792
    v_mfma_f32_16x16x32_bf16 v[20:23], v[104:107], v[128:131], v[20:23]
    ds_read_b64_tr_b16 v[84:85], v154 offset:0
    ds_read_b64_tr_b16 v[86:87], v154 offset:1792
    v_mfma_f32_16x16x32_bf16 v[48:51], v[104:107], v[132:135], v[48:51]
    ds_read_b64_tr_b16 v[88:89], v155 offset:0
    ds_read_b64_tr_b16 v[90:91], v155 offset:1792
    v_mfma_f32_16x16x32_bf16 v[24:27], v[108:111], v[128:131], v[24:27]
    s_add_u32 m0, s40, 0
    s_lshl_b32 s42, s57, 7
    s_mul_i32 s43, s57, 458752
    buffer_load_dwordx4 v163, s[12:15], s42 offen offset:0 lds
    buffer_load_dwordx4 v164, s[12:15], s42 offen offset:1024 lds
    v_mfma_f32_16x16x32_bf16 v[52:55], v[108:111], v[132:135], v[52:55]
    s_add_u32 s57, s57, 1
    s_cmp_eq_u32 s57, 16
    s_cselect_b32 s57, 0, s57
    s_add_u32 m0, s41, 0
    s_nop 0
    buffer_load_dwordx4 v165, s[8:11], s43 offen offset:0 lds
    buffer_load_dwordx4 v166, s[8:11], s43 offen offset:1024 lds
    v_mfma_f32_16x16x32_bf16 v[28:31], v[112:115], v[128:131], v[28:31]
    buffer_load_dwordx4 v167, s[8:11], s43 offen offset:2048 lds
    buffer_load_dwordx4 v168, s[8:11], s43 offen offset:3072 lds
    v_mfma_f32_16x16x32_bf16 v[56:59], v[112:115], v[132:135], v[56:59]
    v_mfma_f32_16x16x32_bf16 v[32:35], v[116:119], v[128:131], v[32:35]
    v_mfma_f32_16x16x32_bf16 v[60:63], v[116:119], v[132:135], v[60:63]
    s_waitcnt lgkmcnt(0)
    v_mfma_f32_16x16x32_bf16 v[8:11], v[64:67], v[120:123], v[8:11]
    ds_read_b128 v[128:131], v139 offset:0
    ds_read_b128 v[132:135], v139 offset:2048
    v_mfma_f32_16x16x32_bf16 v[36:39], v[64:67], v[124:127], v[36:39]
    ds_read_b64_tr_b16 v[92:93], v149 offset:14336
    ds_read_b64_tr_b16 v[94:95], v149 offset:16128
    v_mfma_f32_16x16x32_bf16 v[12:15], v[68:71], v[120:123], v[12:15]
    ds_read_b64_tr_b16 v[96:97], v150 offset:14336
    ds_read_b64_tr_b16 v[98:99], v150 offset:16128
    v_mfma_f32_16x16x32_bf16 v[40:43], v[68:71], v[124:127], v[40:43]
    ds_read_b64_tr_b16 v[100:101], v151 offset:14336
    ds_read_b64_tr_b16 v[102:103], v151 offset:16128
    v_mfma_f32_16x16x32_bf16 v[16:19], v[72:75], v[120:123], v[16:19]
    ds_read_b64_tr_b16 v[104:105], v152 offset:14336
    ds_read_b64_tr_b16 v[106:107], v152 offset:16128
    v_mfma_f32_16x16x32_bf16 v[44:47], v[72:75], v[124:127], v[44:47]
    ds_read_b64_tr_b16 v[108:109], v153 offset:14336
    ds_read_b64_tr_b16 v[110:111], v153 offset:16128
    v_mfma_f32_16x16x32_bf16 v[20:23], v[76:79], v[120:123], v[20:23]
    ds_read_b64_tr_b16 v[112:113], v154 offset:14336
    ds_read_b64_tr_b16 v[114:115], v154 offset:16128
    v_mfma_f32_16x16x32_bf16 v[48:51], v[76:79], v[124:127], v[48:51]
    ds_read_b64_tr_b16 v[116:117], v155 offset:14336
    ds_read_b64_tr_b16 v[118:119], v155 offset:16128
    v_mfma_f32_16x16x32_bf16 v[24:27], v[80:83], v[120:123], v[24:27]
    v_mfma_f32_16x16x32_bf16 v[52:55], v[80:83], v[124:127], v[52:55]
    v_mfma_f32_16x16x32_bf16 v[28:31], v[84:87], v[120:123], v[28:31]
    v_mfma_f32_16x16x32_bf16 v[56:59], v[84:87], v[124:127], v[56:59]
    v_mfma_f32_16x16x32_bf16 v[32:35], v[88:91], v[120:123], v[32:35]
    v_mfma_f32_16x16x32_bf16 v[60:63], v[88:91], v[124:127], v[60:63]
    s_waitcnt vmcnt(6) lgkmcnt(0)
    s_barrier
    v_mfma_f32_16x16x32_bf16 v[8:11], v[92:95], v[128:131], v[8:11]
    ds_read_b128 v[120:123], v140 offset:0
    ds_read_b128 v[124:127], v140 offset:2048
    v_mfma_f32_16x16x32_bf16 v[36:39], v[92:95], v[132:135], v[36:39]
    ds_read_b64_tr_b16 v[64:65], v156 offset:0
    ds_read_b64_tr_b16 v[66:67], v156 offset:1792
    v_mfma_f32_16x16x32_bf16 v[12:15], v[96:99], v[128:131], v[12:15]
    ds_read_b64_tr_b16 v[68:69], v157 offset:0
    ds_read_b64_tr_b16 v[70:71], v157 offset:1792
    v_mfma_f32_16x16x32_bf16 v[40:43], v[96:99], v[132:135], v[40:43]
    ds_read_b64_tr_b16 v[72:73], v158 offset:0
    ds_read_b64_tr_b16 v[74:75], v158 offset:1792
    v_mfma_f32_16x16x32_bf16 v[16:19], v[100:103], v[128:131], v[16:19]
    ds_read_b64_tr_b16 v[76:77], v159 offset:0
    ds_read_b64_tr_b16 v[78:79], v159 offset:1792
    v_mfma_f32_16x16x32_bf16 v[44:47], v[100:103], v[132:135], v[44:47]
    ds_read_b64_tr_b16 v[80:81], v160 offset:0
    ds_read_b64_tr_b16 v[82:83], v160 offset:1792
    v_mfma_f32_16x16x32_bf16 v[20:23], v[104:107], v[128:131], v[20:23]
    ds_read_b64_tr_b16 v[84:85], v161 offset:0
    ds_read_b64_tr_b16 v[86:87], v161 offset:1792
    v_mfma_f32_16x16x32_bf16 v[48:51], v[104:107], v[132:135], v[48:51]
    ds_read_b64_tr_b16 v[88:89], v162 offset:0
    ds_read_b64_tr_b16 v[90:91], v162 offset:1792
    v_mfma_f32_16x16x32_bf16 v[24:27], v[108:111], v[128:131], v[24:27]
    s_add_u32 m0, s40, 49152
    s_lshl_b32 s42, s57, 7
    s_mul_i32 s43, s57, 458752
    buffer_load_dwordx4 v163, s[12:15], s42 offen offset:0 lds
    buffer_load_dwordx4 v164, s[12:15], s42 offen offset:1024 lds
    v_mfma_f32_16x16x32_bf16 v[52:55], v[108:111], v[132:135], v[52:55]
    s_add_u32 s57, s57, 1
    s_cmp_eq_u32 s57, 16
    s_cselect_b32 s57, 0, s57
    s_add_u32 m0, s41, 49152
    s_nop 0
    buffer_load_dwordx4 v165, s[8:11], s43 offen offset:0 lds
    buffer_load_dwordx4 v166, s[8:11], s43 offen offset:1024 lds
    v_mfma_f32_16x16x32_bf16 v[28:31], v[112:115], v[128:131], v[28:31]
    buffer_load_dwordx4 v167, s[8:11], s43 offen offset:2048 lds
    buffer_load_dwordx4 v168, s[8:11], s43 offen offset:3072 lds
    v_mfma_f32_16x16x32_bf16 v[56:59], v[112:115], v[132:135], v[56:59]
    v_mfma_f32_16x16x32_bf16 v[32:35], v[116:119], v[128:131], v[32:35]
    v_mfma_f32_16x16x32_bf16 v[60:63], v[116:119], v[132:135], v[60:63]
    s_waitcnt lgkmcnt(0)
    v_mfma_f32_16x16x32_bf16 v[8:11], v[64:67], v[120:123], v[8:11]
    ds_read_b128 v[128:131], v141 offset:0
    ds_read_b128 v[132:135], v141 offset:2048
    v_mfma_f32_16x16x32_bf16 v[36:39], v[64:67], v[124:127], v[36:39]
    ds_read_b64_tr_b16 v[92:93], v156 offset:14336
    ds_read_b64_tr_b16 v[94:95], v156 offset:16128
    v_mfma_f32_16x16x32_bf16 v[12:15], v[68:71], v[120:123], v[12:15]
    ds_read_b64_tr_b16 v[96:97], v157 offset:14336
    ds_read_b64_tr_b16 v[98:99], v157 offset:16128
    v_mfma_f32_16x16x32_bf16 v[40:43], v[68:71], v[124:127], v[40:43]
    ds_read_b64_tr_b16 v[100:101], v158 offset:14336
    ds_read_b64_tr_b16 v[102:103], v158 offset:16128
    v_mfma_f32_16x16x32_bf16 v[16:19], v[72:75], v[120:123], v[16:19]
    ds_read_b64_tr_b16 v[104:105], v159 offset:14336
    ds_read_b64_tr_b16 v[106:107], v159 offset:16128
    v_mfma_f32_16x16x32_bf16 v[44:47], v[72:75], v[124:127], v[44:47]
    ds_read_b64_tr_b16 v[108:109], v160 offset:14336
    ds_read_b64_tr_b16 v[110:111], v160 offset:16128
    v_mfma_f32_16x16x32_bf16 v[20:23], v[76:79], v[120:123], v[20:23]
    ds_read_b64_tr_b16 v[112:113], v161 offset:14336
    ds_read_b64_tr_b16 v[114:115], v161 offset:16128
    v_mfma_f32_16x16x32_bf16 v[48:51], v[76:79], v[124:127], v[48:51]
    ds_read_b64_tr_b16 v[116:117], v162 offset:14336
    ds_read_b64_tr_b16 v[118:119], v162 offset:16128
    v_mfma_f32_16x16x32_bf16 v[24:27], v[80:83], v[120:123], v[24:27]
    v_mfma_f32_16x16x32_bf16 v[52:55], v[80:83], v[124:127], v[52:55]
    v_mfma_f32_16x16x32_bf16 v[28:31], v[84:87], v[120:123], v[28:31]
    v_mfma_f32_16x16x32_bf16 v[56:59], v[84:87], v[124:127], v[56:59]
    v_mfma_f32_16x16x32_bf16 v[32:35], v[88:91], v[120:123], v[32:35]
    v_mfma_f32_16x16x32_bf16 v[60:63], v[88:91], v[124:127], v[60:63]
    s_waitcnt vmcnt(6) lgkmcnt(0)
    s_barrier
    v_mfma_f32_16x16x32_bf16 v[8:11], v[92:95], v[128:131], v[8:11]
    ds_read_b128 v[120:123], v136 offset:0
    ds_read_b128 v[124:127], v136 offset:2048
    v_mfma_f32_16x16x32_bf16 v[36:39], v[92:95], v[132:135], v[36:39]
    ds_read_b64_tr_b16 v[64:65], v142 offset:0
    ds_read_b64_tr_b16 v[66:67], v142 offset:1792
    v_mfma_f32_16x16x32_bf16 v[12:15], v[96:99], v[128:131], v[12:15]
    ds_read_b64_tr_b16 v[68:69], v143 offset:0
    ds_read_b64_tr_b16 v[70:71], v143 offset:1792
    v_mfma_f32_16x16x32_bf16 v[40:43], v[96:99], v[132:135], v[40:43]
    ds_read_b64_tr_b16 v[72:73], v144 offset:0
    ds_read_b64_tr_b16 v[74:75], v144 offset:1792
    v_mfma_f32_16x16x32_bf16 v[16:19], v[100:103], v[128:131], v[16:19]
    ds_read_b64_tr_b16 v[76:77], v145 offset:0
    ds_read_b64_tr_b16 v[78:79], v145 offset:1792
    v_mfma_f32_16x16x32_bf16 v[44:47], v[100:103], v[132:135], v[44:47]
    ds_read_b64_tr_b16 v[80:81], v146 offset:0
    ds_read_b64_tr_b16 v[82:83], v146 offset:1792
    v_mfma_f32_16x16x32_bf16 v[20:23], v[104:107], v[128:131], v[20:23]
    ds_read_b64_tr_b16 v[84:85], v147 offset:0
    ds_read_b64_tr_b16 v[86:87], v147 offset:1792
    v_mfma_f32_16x16x32_bf16 v[48:51], v[104:107], v[132:135], v[48:51]
    ds_read_b64_tr_b16 v[88:89], v148 offset:0
    ds_read_b64_tr_b16 v[90:91], v148 offset:1792
    v_mfma_f32_16x16x32_bf16 v[24:27], v[108:111], v[128:131], v[24:27]
    s_add_u32 m0, s40, 98304
    s_lshl_b32 s42, s57, 7
    s_mul_i32 s43, s57, 458752
    buffer_load_dwordx4 v163, s[12:15], s42 offen offset:0 lds
    buffer_load_dwordx4 v164, s[12:15], s42 offen offset:1024 lds
    v_mfma_f32_16x16x32_bf16 v[52:55], v[108:111], v[132:135], v[52:55]
    s_add_u32 s57, s57, 1
    s_cmp_eq_u32 s57, 16
    s_cselect_b32 s57, 0, s57
    s_add_u32 m0, s41, 98304
    s_nop 0
    buffer_load_dwordx4 v165, s[8:11], s43 offen offset:0 lds
    buffer_load_dwordx4 v166, s[8:11], s43 offen offset:1024 lds
    v_mfma_f32_16x16x32_bf16 v[28:31], v[112:115], v[128:131], v[28:31]
    buffer_load_dwordx4 v167, s[8:11], s43 offen offset:2048 lds
    buffer_load_dwordx4 v168, s[8:11], s43 offen offset:3072 lds
    v_mfma_f32_16x16x32_bf16 v[56:59], v[112:115], v[132:135], v[56:59]
    v_mfma_f32_16x16x32_bf16 v[32:35], v[116:119], v[128:131], v[32:35]
    v_mfma_f32_16x16x32_bf16 v[60:63], v[116:119], v[132:135], v[60:63]
    s_waitcnt lgkmcnt(0)
    v_mfma_f32_16x16x32_bf16 v[8:11], v[64:67], v[120:123], v[8:11]
    ds_read_b128 v[128:131], v137 offset:0
    ds_read_b128 v[132:135], v137 offset:2048
    v_mfma_f32_16x16x32_bf16 v[36:39], v[64:67], v[124:127], v[36:39]
    ds_read_b64_tr_b16 v[92:93], v142 offset:14336
    ds_read_b64_tr_b16 v[94:95], v142 offset:16128
    v_mfma_f32_16x16x32_bf16 v[12:15], v[68:71], v[120:123], v[12:15]
    ds_read_b64_tr_b16 v[96:97], v143 offset:14336
    ds_read_b64_tr_b16 v[98:99], v143 offset:16128
    v_mfma_f32_16x16x32_bf16 v[40:43], v[68:71], v[124:127], v[40:43]
    ds_read_b64_tr_b16 v[100:101], v144 offset:14336
    ds_read_b64_tr_b16 v[102:103], v144 offset:16128
    v_mfma_f32_16x16x32_bf16 v[16:19], v[72:75], v[120:123], v[16:19]
    ds_read_b64_tr_b16 v[104:105], v145 offset:14336
    ds_read_b64_tr_b16 v[106:107], v145 offset:16128
    v_mfma_f32_16x16x32_bf16 v[44:47], v[72:75], v[124:127], v[44:47]
    ds_read_b64_tr_b16 v[108:109], v146 offset:14336
    ds_read_b64_tr_b16 v[110:111], v146 offset:16128
    v_mfma_f32_16x16x32_bf16 v[20:23], v[76:79], v[120:123], v[20:23]
    ds_read_b64_tr_b16 v[112:113], v147 offset:14336
    ds_read_b64_tr_b16 v[114:115], v147 offset:16128
    v_mfma_f32_16x16x32_bf16 v[48:51], v[76:79], v[124:127], v[48:51]
    ds_read_b64_tr_b16 v[116:117], v148 offset:14336
    ds_read_b64_tr_b16 v[118:119], v148 offset:16128
    v_mfma_f32_16x16x32_bf16 v[24:27], v[80:83], v[120:123], v[24:27]
    v_mfma_f32_16x16x32_bf16 v[52:55], v[80:83], v[124:127], v[52:55]
    v_mfma_f32_16x16x32_bf16 v[28:31], v[84:87], v[120:123], v[28:31]
    v_mfma_f32_16x16x32_bf16 v[56:59], v[84:87], v[124:127], v[56:59]
    v_mfma_f32_16x16x32_bf16 v[32:35], v[88:91], v[120:123], v[32:35]
    v_mfma_f32_16x16x32_bf16 v[60:63], v[88:91], v[124:127], v[60:63]
    s_waitcnt vmcnt(6) lgkmcnt(0)
    s_barrier
    v_mfma_f32_16x16x32_bf16 v[8:11], v[92:95], v[128:131], v[8:11]
    ds_read_b128 v[120:123], v138 offset:0
    ds_read_b128 v[124:127], v138 offset:2048
    v_mfma_f32_16x16x32_bf16 v[36:39], v[92:95], v[132:135], v[36:39]
    ds_read_b64_tr_b16 v[64:65], v149 offset:0
    ds_read_b64_tr_b16 v[66:67], v149 offset:1792
    v_mfma_f32_16x16x32_bf16 v[12:15], v[96:99], v[128:131], v[12:15]
    ds_read_b64_tr_b16 v[68:69], v150 offset:0
    ds_read_b64_tr_b16 v[70:71], v150 offset:1792
    v_mfma_f32_16x16x32_bf16 v[40:43], v[96:99], v[132:135], v[40:43]
    ds_read_b64_tr_b16 v[72:73], v151 offset:0
    ds_read_b64_tr_b16 v[74:75], v151 offset:1792
    v_mfma_f32_16x16x32_bf16 v[16:19], v[100:103], v[128:131], v[16:19]
    ds_read_b64_tr_b16 v[76:77], v152 offset:0
    ds_read_b64_tr_b16 v[78:79], v152 offset:1792
    v_mfma_f32_16x16x32_bf16 v[44:47], v[100:103], v[132:135], v[44:47]
    ds_read_b64_tr_b16 v[80:81], v153 offset:0
    ds_read_b64_tr_b16 v[82:83], v153 offset:1792
    v_mfma_f32_16x16x32_bf16 v[20:23], v[104:107], v[128:131], v[20:23]
    ds_read_b64_tr_b16 v[84:85], v154 offset:0
    ds_read_b64_tr_b16 v[86:87], v154 offset:1792
    v_mfma_f32_16x16x32_bf16 v[48:51], v[104:107], v[132:135], v[48:51]
    ds_read_b64_tr_b16 v[88:89], v155 offset:0
    ds_read_b64_tr_b16 v[90:91], v155 offset:1792
    v_mfma_f32_16x16x32_bf16 v[24:27], v[108:111], v[128:131], v[24:27]
    s_add_u32 m0, s40, 0
    s_lshl_b32 s42, s57, 7
    s_mul_i32 s43, s57, 458752
    buffer_load_dwordx4 v163, s[12:15], s42 offen offset:0 lds
    buffer_load_dwordx4 v164, s[12:15], s42 offen offset:1024 lds
    v_mfma_f32_16x16x32_bf16 v[52:55], v[108:111], v[132:135], v[52:55]
    s_add_u32 s57, s57, 1
    s_cmp_eq_u32 s57, 16
    s_cselect_b32 s57, 0, s57
    s_add_u32 m0, s41, 0
    s_nop 0
    buffer_load_dwordx4 v165, s[8:11], s43 offen offset:0 lds
    buffer_load_dwordx4 v166, s[8:11], s43 offen offset:1024 lds
    v_mfma_f32_16x16x32_bf16 v[28:31], v[112:115], v[128:131], v[28:31]
    buffer_load_dwordx4 v167, s[8:11], s43 offen offset:2048 lds
    buffer_load_dwordx4 v168, s[8:11], s43 offen offset:3072 lds
    v_mfma_f32_16x16x32_bf16 v[56:59], v[112:115], v[132:135], v[56:59]
    v_mfma_f32_16x16x32_bf16 v[32:35], v[116:119], v[128:131], v[32:35]
    v_mfma_f32_16x16x32_bf16 v[60:63], v[116:119], v[132:135], v[60:63]
    s_waitcnt lgkmcnt(0)
    v_mfma_f32_16x16x32_bf16 v[8:11], v[64:67], v[120:123], v[8:11]
    ds_read_b128 v[128:131], v139 offset:0
    ds_read_b128 v[132:135], v139 offset:2048
    v_mfma_f32_16x16x32_bf16 v[36:39], v[64:67], v[124:127], v[36:39]
    ds_read_b64_tr_b16 v[92:93], v149 offset:14336
    ds_read_b64_tr_b16 v[94:95], v149 offset:16128
    v_mfma_f32_16x16x32_bf16 v[12:15], v[68:71], v[120:123], v[12:15]
    ds_read_b64_tr_b16 v[96:97], v150 offset:14336
    ds_read_b64_tr_b16 v[98:99], v150 offset:16128
    v_mfma_f32_16x16x32_bf16 v[40:43], v[68:71], v[124:127], v[40:43]
    ds_read_b64_tr_b16 v[100:101], v151 offset:14336
    ds_read_b64_tr_b16 v[102:103], v151 offset:16128
    v_mfma_f32_16x16x32_bf16 v[16:19], v[72:75], v[120:123], v[16:19]
    ds_read_b64_tr_b16 v[104:105], v152 offset:14336
    ds_read_b64_tr_b16 v[106:107], v152 offset:16128
    v_mfma_f32_16x16x32_bf16 v[44:47], v[72:75], v[124:127], v[44:47]
    ds_read_b64_tr_b16 v[108:109], v153 offset:14336
    ds_read_b64_tr_b16 v[110:111], v153 offset:16128
    v_mfma_f32_16x16x32_bf16 v[20:23], v[76:79], v[120:123], v[20:23]
    ds_read_b64_tr_b16 v[112:113], v154 offset:14336
    ds_read_b64_tr_b16 v[114:115], v154 offset:16128
    v_mfma_f32_16x16x32_bf16 v[48:51], v[76:79], v[124:127], v[48:51]
    ds_read_b64_tr_b16 v[116:117], v155 offset:14336
    ds_read_b64_tr_b16 v[118:119], v155 offset:16128
    v_mfma_f32_16x16x32_bf16 v[24:27], v[80:83], v[120:123], v[24:27]
    v_mfma_f32_16x16x32_bf16 v[52:55], v[80:83], v[124:127], v[52:55]
    v_mfma_f32_16x16x32_bf16 v[28:31], v[84:87], v[120:123], v[28:31]
    v_mfma_f32_16x16x32_bf16 v[56:59], v[84:87], v[124:127], v[56:59]
    v_mfma_f32_16x16x32_bf16 v[32:35], v[88:91], v[120:123], v[32:35]
    v_mfma_f32_16x16x32_bf16 v[60:63], v[88:91], v[124:127], v[60:63]
    s_waitcnt vmcnt(6) lgkmcnt(0)
    s_barrier
    v_mfma_f32_16x16x32_bf16 v[8:11], v[92:95], v[128:131], v[8:11]
    ds_read_b128 v[120:123], v140 offset:0
    ds_read_b128 v[124:127], v140 offset:2048
    v_mfma_f32_16x16x32_bf16 v[36:39], v[92:95], v[132:135], v[36:39]
    ds_read_b64_tr_b16 v[64:65], v156 offset:0
    ds_read_b64_tr_b16 v[66:67], v156 offset:1792
    v_mfma_f32_16x16x32_bf16 v[12:15], v[96:99], v[128:131], v[12:15]
    ds_read_b64_tr_b16 v[68:69], v157 offset:0
    ds_read_b64_tr_b16 v[70:71], v157 offset:1792
    v_mfma_f32_16x16x32_bf16 v[40:43], v[96:99], v[132:135], v[40:43]
    ds_read_b64_tr_b16 v[72:73], v158 offset:0
    ds_read_b64_tr_b16 v[74:75], v158 offset:1792
    v_mfma_f32_16x16x32_bf16 v[16:19], v[100:103], v[128:131], v[16:19]
    ds_read_b64_tr_b16 v[76:77], v159 offset:0
    ds_read_b64_tr_b16 v[78:79], v159 offset:1792
    v_mfma_f32_16x16x32_bf16 v[44:47], v[100:103], v[132:135], v[44:47]
    ds_read_b64_tr_b16 v[80:81], v160 offset:0
    ds_read_b64_tr_b16 v[82:83], v160 offset:1792
    v_mfma_f32_16x16x32_bf16 v[20:23], v[104:107], v[128:131], v[20:23]
    ds_read_b64_tr_b16 v[84:85], v161 offset:0
    ds_read_b64_tr_b16 v[86:87], v161 offset:1792
    v_mfma_f32_16x16x32_bf16 v[48:51], v[104:107], v[132:135], v[48:51]
    ds_read_b64_tr_b16 v[88:89], v162 offset:0
    ds_read_b64_tr_b16 v[90:91], v162 offset:1792
    v_mfma_f32_16x16x32_bf16 v[24:27], v[108:111], v[128:131], v[24:27]
    s_add_u32 m0, s40, 49152
    s_lshl_b32 s42, s57, 7
    s_mul_i32 s43, s57, 458752
    buffer_load_dwordx4 v163, s[12:15], s42 offen offset:0 lds
    buffer_load_dwordx4 v164, s[12:15], s42 offen offset:1024 lds
    v_mfma_f32_16x16x32_bf16 v[52:55], v[108:111], v[132:135], v[52:55]
    s_add_u32 s57, s57, 1
    s_cmp_eq_u32 s57, 16
    s_cselect_b32 s57, 0, s57
    s_add_u32 m0, s41, 49152
    s_nop 0
    buffer_load_dwordx4 v165, s[8:11], s43 offen offset:0 lds
    buffer_load_dwordx4 v166, s[8:11], s43 offen offset:1024 lds
    v_mfma_f32_16x16x32_bf16 v[28:31], v[112:115], v[128:131], v[28:31]
    buffer_load_dwordx4 v167, s[8:11], s43 offen offset:2048 lds
    buffer_load_dwordx4 v168, s[8:11], s43 offen offset:3072 lds
    v_mfma_f32_16x16x32_bf16 v[56:59], v[112:115], v[132:135], v[56:59]
    v_mfma_f32_16x16x32_bf16 v[32:35], v[116:119], v[128:131], v[32:35]
    v_mfma_f32_16x16x32_bf16 v[60:63], v[116:119], v[132:135], v[60:63]
    s_waitcnt lgkmcnt(0)
    v_mfma_f32_16x16x32_bf16 v[8:11], v[64:67], v[120:123], v[8:11]
    ds_read_b128 v[128:131], v141 offset:0
    ds_read_b128 v[132:135], v141 offset:2048
    v_mfma_f32_16x16x32_bf16 v[36:39], v[64:67], v[124:127], v[36:39]
    ds_read_b64_tr_b16 v[92:93], v156 offset:14336
    ds_read_b64_tr_b16 v[94:95], v156 offset:16128
    v_mfma_f32_16x16x32_bf16 v[12:15], v[68:71], v[120:123], v[12:15]
    ds_read_b64_tr_b16 v[96:97], v157 offset:14336
    ds_read_b64_tr_b16 v[98:99], v157 offset:16128
    v_mfma_f32_16x16x32_bf16 v[40:43], v[68:71], v[124:127], v[40:43]
    ds_read_b64_tr_b16 v[100:101], v158 offset:14336
    ds_read_b64_tr_b16 v[102:103], v158 offset:16128
    v_mfma_f32_16x16x32_bf16 v[16:19], v[72:75], v[120:123], v[16:19]
    ds_read_b64_tr_b16 v[104:105], v159 offset:14336
    ds_read_b64_tr_b16 v[106:107], v159 offset:16128
    v_mfma_f32_16x16x32_bf16 v[44:47], v[72:75], v[124:127], v[44:47]
    ds_read_b64_tr_b16 v[108:109], v160 offset:14336
    ds_read_b64_tr_b16 v[110:111], v160 offset:16128
    v_mfma_f32_16x16x32_bf16 v[20:23], v[76:79], v[120:123], v[20:23]
    ds_read_b64_tr_b16 v[112:113], v161 offset:14336
    ds_read_b64_tr_b16 v[114:115], v161 offset:16128
    v_mfma_f32_16x16x32_bf16 v[48:51], v[76:79], v[124:127], v[48:51]
    ds_read_b64_tr_b16 v[116:117], v162 offset:14336
    ds_read_b64_tr_b16 v[118:119], v162 offset:16128
    v_mfma_f32_16x16x32_bf16 v[24:27], v[80:83], v[120:123], v[24:27]
    v_mfma_f32_16x16x32_bf16 v[52:55], v[80:83], v[124:127], v[52:55]
    v_mfma_f32_16x16x32_bf16 v[28:31], v[84:87], v[120:123], v[28:31]
    v_mfma_f32_16x16x32_bf16 v[56:59], v[84:87], v[124:127], v[56:59]
    v_mfma_f32_16x16x32_bf16 v[32:35], v[88:91], v[120:123], v[32:35]
    v_mfma_f32_16x16x32_bf16 v[60:63], v[88:91], v[124:127], v[60:63]
    s_waitcnt vmcnt(6) lgkmcnt(0)
    s_barrier
    v_mfma_f32_16x16x32_bf16 v[8:11], v[92:95], v[128:131], v[8:11]
    ds_read_b128 v[120:123], v136 offset:0
    ds_read_b128 v[124:127], v136 offset:2048
    v_mfma_f32_16x16x32_bf16 v[36:39], v[92:95], v[132:135], v[36:39]
    ds_read_b64_tr_b16 v[64:65], v142 offset:0
    ds_read_b64_tr_b16 v[66:67], v142 offset:1792
    v_mfma_f32_16x16x32_bf16 v[12:15], v[96:99], v[128:131], v[12:15]
    ds_read_b64_tr_b16 v[68:69], v143 offset:0
    ds_read_b64_tr_b16 v[70:71], v143 offset:1792
    v_mfma_f32_16x16x32_bf16 v[40:43], v[96:99], v[132:135], v[40:43]
    ds_read_b64_tr_b16 v[72:73], v144 offset:0
    ds_read_b64_tr_b16 v[74:75], v144 offset:1792
    v_mfma_f32_16x16x32_bf16 v[16:19], v[100:103], v[128:131], v[16:19]
    ds_read_b64_tr_b16 v[76:77], v145 offset:0
    ds_read_b64_tr_b16 v[78:79], v145 offset:1792
    v_mfma_f32_16x16x32_bf16 v[44:47], v[100:103], v[132:135], v[44:47]
    ds_read_b64_tr_b16 v[80:81], v146 offset:0
    ds_read_b64_tr_b16 v[82:83], v146 offset:1792
    v_mfma_f32_16x16x32_bf16 v[20:23], v[104:107], v[128:131], v[20:23]
    ds_read_b64_tr_b16 v[84:85], v147 offset:0
    ds_read_b64_tr_b16 v[86:87], v147 offset:1792
    v_mfma_f32_16x16x32_bf16 v[48:51], v[104:107], v[132:135], v[48:51]
    ds_read_b64_tr_b16 v[88:89], v148 offset:0
    ds_read_b64_tr_b16 v[90:91], v148 offset:1792
    v_mfma_f32_16x16x32_bf16 v[24:27], v[108:111], v[128:131], v[24:27]
    s_add_u32 m0, s40, 98304
    s_lshl_b32 s42, s57, 7
    s_mul_i32 s43, s57, 458752
    buffer_load_dwordx4 v163, s[12:15], s42 offen offset:0 lds
    buffer_load_dwordx4 v164, s[12:15], s42 offen offset:1024 lds
    v_mfma_f32_16x16x32_bf16 v[52:55], v[108:111], v[132:135], v[52:55]
    s_add_u32 s57, s57, 1
    s_cmp_eq_u32 s57, 16
    s_cselect_b32 s57, 0, s57
    s_add_u32 m0, s41, 98304
    s_nop 0
    buffer_load_dwordx4 v165, s[8:11], s43 offen offset:0 lds
    buffer_load_dwordx4 v166, s[8:11], s43 offen offset:1024 lds
    v_mfma_f32_16x16x32_bf16 v[28:31], v[112:115], v[128:131], v[28:31]
    buffer_load_dwordx4 v167, s[8:11], s43 offen offset:2048 lds
    buffer_load_dwordx4 v168, s[8:11], s43 offen offset:3072 lds
    v_mfma_f32_16x16x32_bf16 v[56:59], v[112:115], v[132:135], v[56:59]
    v_mfma_f32_16x16x32_bf16 v[32:35], v[116:119], v[128:131], v[32:35]
    v_mfma_f32_16x16x32_bf16 v[60:63], v[116:119], v[132:135], v[60:63]
    s_waitcnt lgkmcnt(0)
    v_mfma_f32_16x16x32_bf16 v[8:11], v[64:67], v[120:123], v[8:11]
    ds_read_b128 v[128:131], v137 offset:0
    ds_read_b128 v[132:135], v137 offset:2048
    v_mfma_f32_16x16x32_bf16 v[36:39], v[64:67], v[124:127], v[36:39]
    ds_read_b64_tr_b16 v[92:93], v142 offset:14336
    ds_read_b64_tr_b16 v[94:95], v142 offset:16128
    v_mfma_f32_16x16x32_bf16 v[12:15], v[68:71], v[120:123], v[12:15]
    ds_read_b64_tr_b16 v[96:97], v143 offset:14336
    ds_read_b64_tr_b16 v[98:99], v143 offset:16128
    v_mfma_f32_16x16x32_bf16 v[40:43], v[68:71], v[124:127], v[40:43]
    ds_read_b64_tr_b16 v[100:101], v144 offset:14336
    ds_read_b64_tr_b16 v[102:103], v144 offset:16128
    v_mfma_f32_16x16x32_bf16 v[16:19], v[72:75], v[120:123], v[16:19]
    ds_read_b64_tr_b16 v[104:105], v145 offset:14336
    ds_read_b64_tr_b16 v[106:107], v145 offset:16128
    v_mfma_f32_16x16x32_bf16 v[44:47], v[72:75], v[124:127], v[44:47]
    ds_read_b64_tr_b16 v[108:109], v146 offset:14336
    ds_read_b64_tr_b16 v[110:111], v146 offset:16128
    v_mfma_f32_16x16x32_bf16 v[20:23], v[76:79], v[120:123], v[20:23]
    ds_read_b64_tr_b16 v[112:113], v147 offset:14336
    ds_read_b64_tr_b16 v[114:115], v147 offset:16128
    v_mfma_f32_16x16x32_bf16 v[48:51], v[76:79], v[124:127], v[48:51]
    ds_read_b64_tr_b16 v[116:117], v148 offset:14336
    ds_read_b64_tr_b16 v[118:119], v148 offset:16128
    v_mfma_f32_16x16x32_bf16 v[24:27], v[80:83], v[120:123], v[24:27]
    v_mfma_f32_16x16x32_bf16 v[52:55], v[80:83], v[124:127], v[52:55]
    v_mfma_f32_16x16x32_bf16 v[28:31], v[84:87], v[120:123], v[28:31]
    v_mfma_f32_16x16x32_bf16 v[56:59], v[84:87], v[124:127], v[56:59]
    v_mfma_f32_16x16x32_bf16 v[32:35], v[88:91], v[120:123], v[32:35]
    v_mfma_f32_16x16x32_bf16 v[60:63], v[88:91], v[124:127], v[60:63]
    s_waitcnt vmcnt(6) lgkmcnt(0)
    s_barrier
    v_mfma_f32_16x16x32_bf16 v[8:11], v[92:95], v[128:131], v[8:11]
    ds_read_b128 v[120:123], v138 offset:0
    ds_read_b128 v[124:127], v138 offset:2048
    v_mfma_f32_16x16x32_bf16 v[36:39], v[92:95], v[132:135], v[36:39]
    ds_read_b64_tr_b16 v[64:65], v149 offset:0
    ds_read_b64_tr_b16 v[66:67], v149 offset:1792
    v_mfma_f32_16x16x32_bf16 v[12:15], v[96:99], v[128:131], v[12:15]
    ds_read_b64_tr_b16 v[68:69], v150 offset:0
    ds_read_b64_tr_b16 v[70:71], v150 offset:1792
    v_mfma_f32_16x16x32_bf16 v[40:43], v[96:99], v[132:135], v[40:43]
    ds_read_b64_tr_b16 v[72:73], v151 offset:0
    ds_read_b64_tr_b16 v[74:75], v151 offset:1792
    v_mfma_f32_16x16x32_bf16 v[16:19], v[100:103], v[128:131], v[16:19]
    ds_read_b64_tr_b16 v[76:77], v152 offset:0
    ds_read_b64_tr_b16 v[78:79], v152 offset:1792
    v_mfma_f32_16x16x32_bf16 v[44:47], v[100:103], v[132:135], v[44:47]
    ds_read_b64_tr_b16 v[80:81], v153 offset:0
    ds_read_b64_tr_b16 v[82:83], v153 offset:1792
    v_mfma_f32_16x16x32_bf16 v[20:23], v[104:107], v[128:131], v[20:23]
    ds_read_b64_tr_b16 v[84:85], v154 offset:0
    ds_read_b64_tr_b16 v[86:87], v154 offset:1792
    v_mfma_f32_16x16x32_bf16 v[48:51], v[104:107], v[132:135], v[48:51]
    ds_read_b64_tr_b16 v[88:89], v155 offset:0
    ds_read_b64_tr_b16 v[90:91], v155 offset:1792
    v_mfma_f32_16x16x32_bf16 v[24:27], v[108:111], v[128:131], v[24:27]
    s_add_u32 m0, s40, 0
    s_lshl_b32 s42, s57, 7
    s_mul_i32 s43, s57, 458752
    buffer_load_dwordx4 v163, s[12:15], s42 offen offset:0 lds
    buffer_load_dwordx4 v164, s[12:15], s42 offen offset:1024 lds
    v_mfma_f32_16x16x32_bf16 v[52:55], v[108:111], v[132:135], v[52:55]
    s_add_u32 s57, s57, 1
    s_cmp_eq_u32 s57, 16
    s_cselect_b32 s57, 0, s57
    s_add_u32 m0, s41, 0
    s_nop 0
    buffer_load_dwordx4 v165, s[8:11], s43 offen offset:0 lds
    buffer_load_dwordx4 v166, s[8:11], s43 offen offset:1024 lds
    v_mfma_f32_16x16x32_bf16 v[28:31], v[112:115], v[128:131], v[28:31]
    buffer_load_dwordx4 v167, s[8:11], s43 offen offset:2048 lds
    buffer_load_dwordx4 v168, s[8:11], s43 offen offset:3072 lds
    v_mfma_f32_16x16x32_bf16 v[56:59], v[112:115], v[132:135], v[56:59]
    v_mfma_f32_16x16x32_bf16 v[32:35], v[116:119], v[128:131], v[32:35]
    v_mfma_f32_16x16x32_bf16 v[60:63], v[116:119], v[132:135], v[60:63]
    s_waitcnt lgkmcnt(0)
    v_mfma_f32_16x16x32_bf16 v[8:11], v[64:67], v[120:123], v[8:11]
    ds_read_b128 v[128:131], v139 offset:0
    ds_read_b128 v[132:135], v139 offset:2048
    v_mfma_f32_16x16x32_bf16 v[36:39], v[64:67], v[124:127], v[36:39]
    ds_read_b64_tr_b16 v[92:93], v149 offset:14336
    ds_read_b64_tr_b16 v[94:95], v149 offset:16128
    v_mfma_f32_16x16x32_bf16 v[12:15], v[68:71], v[120:123], v[12:15]
    ds_read_b64_tr_b16 v[96:97], v150 offset:14336
    ds_read_b64_tr_b16 v[98:99], v150 offset:16128
    v_mfma_f32_16x16x32_bf16 v[40:43], v[68:71], v[124:127], v[40:43]
    ds_read_b64_tr_b16 v[100:101], v151 offset:14336
    ds_read_b64_tr_b16 v[102:103], v151 offset:16128
    v_mfma_f32_16x16x32_bf16 v[16:19], v[72:75], v[120:123], v[16:19]
    ds_read_b64_tr_b16 v[104:105], v152 offset:14336
    ds_read_b64_tr_b16 v[106:107], v152 offset:16128
    v_mfma_f32_16x16x32_bf16 v[44:47], v[72:75], v[124:127], v[44:47]
    ds_read_b64_tr_b16 v[108:109], v153 offset:14336
    ds_read_b64_tr_b16 v[110:111], v153 offset:16128
    v_mfma_f32_16x16x32_bf16 v[20:23], v[76:79], v[120:123], v[20:23]
    ds_read_b64_tr_b16 v[112:113], v154 offset:14336
    ds_read_b64_tr_b16 v[114:115], v154 offset:16128
    v_mfma_f32_16x16x32_bf16 v[48:51], v[76:79], v[124:127], v[48:51]
    ds_read_b64_tr_b16 v[116:117], v155 offset:14336
    ds_read_b64_tr_b16 v[118:119], v155 offset:16128
    v_mfma_f32_16x16x32_bf16 v[24:27], v[80:83], v[120:123], v[24:27]
    v_mfma_f32_16x16x32_bf16 v[52:55], v[80:83], v[124:127], v[52:55]
    v_mfma_f32_16x16x32_bf16 v[28:31], v[84:87], v[120:123], v[28:31]
    v_mfma_f32_16x16x32_bf16 v[56:59], v[84:87], v[124:127], v[56:59]
    v_mfma_f32_16x16x32_bf16 v[32:35], v[88:91], v[120:123], v[32:35]
    v_mfma_f32_16x16x32_bf16 v[60:63], v[88:91], v[124:127], v[60:63]
    s_waitcnt vmcnt(6) lgkmcnt(0)
    s_barrier
    v_lshlrev_b32 v169, 4, v1
    v_mfma_f32_16x16x32_bf16 v[8:11], v[92:95], v[128:131], v[8:11]
    ds_read_b128 v[120:123], v140 offset:0
    ds_read_b128 v[124:127], v140 offset:2048
    v_mfma_f32_16x16x32_bf16 v[36:39], v[92:95], v[132:135], v[36:39]
    ds_read_b64_tr_b16 v[64:65], v156 offset:0
    ds_read_b64_tr_b16 v[66:67], v156 offset:1792
    v_mfma_f32_16x16x32_bf16 v[12:15], v[96:99], v[128:131], v[12:15]
    ds_read_b64_tr_b16 v[68:69], v157 offset:0
    ds_read_b64_tr_b16 v[70:71], v157 offset:1792
    v_mfma_f32_16x16x32_bf16 v[40:43], v[96:99], v[132:135], v[40:43]
    ds_read_b64_tr_b16 v[72:73], v158 offset:0
    ds_read_b64_tr_b16 v[74:75], v158 offset:1792
    v_mfma_f32_16x16x32_bf16 v[16:19], v[100:103], v[128:131], v[16:19]
    ds_read_b64_tr_b16 v[76:77], v159 offset:0
    ds_read_b64_tr_b16 v[78:79], v159 offset:1792
    v_mfma_f32_16x16x32_bf16 v[44:47], v[100:103], v[132:135], v[44:47]
    ds_read_b64_tr_b16 v[80:81], v160 offset:0
    ds_read_b64_tr_b16 v[82:83], v160 offset:1792
    v_mfma_f32_16x16x32_bf16 v[20:23], v[104:107], v[128:131], v[20:23]
    ds_read_b64_tr_b16 v[84:85], v161 offset:0
    ds_read_b64_tr_b16 v[86:87], v161 offset:1792
    v_mfma_f32_16x16x32_bf16 v[48:51], v[104:107], v[132:135], v[48:51]
    ds_read_b64_tr_b16 v[88:89], v162 offset:0
    ds_read_b64_tr_b16 v[90:91], v162 offset:1792
    v_mfma_f32_16x16x32_bf16 v[24:27], v[108:111], v[128:131], v[24:27]
    s_add_u32 m0, s56, 49152
    s_mov_b32 s42, m0
    buffer_load_dwordx4 v169, s[52:55], s42 offen lds
    s_add_u32 m0, s56, 57344
    s_mov_b32 s42, m0
    buffer_load_dwordx4 v169, s[52:55], s42 offen lds
    v_mfma_f32_16x16x32_bf16 v[52:55], v[108:111], v[132:135], v[52:55]
    s_add_u32 m0, s56, 65536
    s_mov_b32 s42, m0
    buffer_load_dwordx4 v169, s[52:55], s42 offen lds
    s_add_u32 m0, s56, 73728
    s_mov_b32 s42, m0
    buffer_load_dwordx4 v169, s[52:55], s42 offen lds
    v_mfma_f32_16x16x32_bf16 v[28:31], v[112:115], v[128:131], v[28:31]
    s_add_u32 m0, s56, 81920
    s_mov_b32 s42, m0
    buffer_load_dwordx4 v169, s[52:55], s42 offen lds
    s_add_u32 m0, s56, 90112
    s_mov_b32 s42, m0
    buffer_load_dwordx4 v169, s[52:55], s42 offen lds
    v_mfma_f32_16x16x32_bf16 v[56:59], v[112:115], v[132:135], v[56:59]
    v_mfma_f32_16x16x32_bf16 v[32:35], v[116:119], v[128:131], v[32:35]
    v_mfma_f32_16x16x32_bf16 v[60:63], v[116:119], v[132:135], v[60:63]
    s_waitcnt lgkmcnt(0)
    v_mfma_f32_16x16x32_bf16 v[8:11], v[64:67], v[120:123], v[8:11]
    ds_read_b128 v[128:131], v141 offset:0
    ds_read_b128 v[132:135], v141 offset:2048
    v_mfma_f32_16x16x32_bf16 v[36:39], v[64:67], v[124:127], v[36:39]
    ds_read_b64_tr_b16 v[92:93], v156 offset:14336
    ds_read_b64_tr_b16 v[94:95], v156 offset:16128
    v_mfma_f32_16x16x32_bf16 v[12:15], v[68:71], v[120:123], v[12:15]
    ds_read_b64_tr_b16 v[96:97], v157 offset:14336
    ds_read_b64_tr_b16 v[98:99], v157 offset:16128
    v_mfma_f32_16x16x32_bf16 v[40:43], v[68:71], v[124:127], v[40:43]
    ds_read_b64_tr_b16 v[100:101], v158 offset:14336
    ds_read_b64_tr_b16 v[102:103], v158 offset:16128
    v_mfma_f32_16x16x32_bf16 v[16:19], v[72:75], v[120:123], v[16:19]
    ds_read_b64_tr_b16 v[104:105], v159 offset:14336
    ds_read_b64_tr_b16 v[106:107], v159 offset:16128
    v_mfma_f32_16x16x32_bf16 v[44:47], v[72:75], v[124:127], v[44:47]
    ds_read_b64_tr_b16 v[108:109], v160 offset:14336
    ds_read_b64_tr_b16 v[110:111], v160 offset:16128
    v_mfma_f32_16x16x32_bf16 v[20:23], v[76:79], v[120:123], v[20:23]
    ds_read_b64_tr_b16 v[112:113], v161 offset:14336
    ds_read_b64_tr_b16 v[114:115], v161 offset:16128
    v_mfma_f32_16x16x32_bf16 v[48:51], v[76:79], v[124:127], v[48:51]
    ds_read_b64_tr_b16 v[116:117], v162 offset:14336
    ds_read_b64_tr_b16 v[118:119], v162 offset:16128
    v_mfma_f32_16x16x32_bf16 v[24:27], v[80:83], v[120:123], v[24:27]
    v_mfma_f32_16x16x32_bf16 v[52:55], v[80:83], v[124:127], v[52:55]
    v_mfma_f32_16x16x32_bf16 v[28:31], v[84:87], v[120:123], v[28:31]
    v_mfma_f32_16x16x32_bf16 v[56:59], v[84:87], v[124:127], v[56:59]
    v_mfma_f32_16x16x32_bf16 v[32:35], v[88:91], v[120:123], v[32:35]
    v_mfma_f32_16x16x32_bf16 v[60:63], v[88:91], v[124:127], v[60:63]
    s_waitcnt vmcnt(6) lgkmcnt(0)
    s_barrier
    v_mfma_f32_16x16x32_bf16 v[8:11], v[92:95], v[128:131], v[8:11]
    ds_read_b128 v[120:123], v136 offset:0
    ds_read_b128 v[124:127], v136 offset:2048
    v_mfma_f32_16x16x32_bf16 v[36:39], v[92:95], v[132:135], v[36:39]
    ds_read_b64_tr_b16 v[64:65], v142 offset:0
    ds_read_b64_tr_b16 v[66:67], v142 offset:1792
    v_mfma_f32_16x16x32_bf16 v[12:15], v[96:99], v[128:131], v[12:15]
    ds_read_b64_tr_b16 v[68:69], v143 offset:0
    ds_read_b64_tr_b16 v[70:71], v143 offset:1792
    v_mfma_f32_16x16x32_bf16 v[40:43], v[96:99], v[132:135], v[40:43]
    ds_read_b64_tr_b16 v[72:73], v144 offset:0
    ds_read_b64_tr_b16 v[74:75], v144 offset:1792
    v_mfma_f32_16x16x32_bf16 v[16:19], v[100:103], v[128:131], v[16:19]
    ds_read_b64_tr_b16 v[76:77], v145 offset:0
    ds_read_b64_tr_b16 v[78:79], v145 offset:1792
    v_mfma_f32_16x16x32_bf16 v[44:47], v[100:103], v[132:135], v[44:47]
    ds_read_b64_tr_b16 v[80:81], v146 offset:0
    ds_read_b64_tr_b16 v[82:83], v146 offset:1792
    v_mfma_f32_16x16x32_bf16 v[20:23], v[104:107], v[128:131], v[20:23]
    ds_read_b64_tr_b16 v[84:85], v147 offset:0
    ds_read_b64_tr_b16 v[86:87], v147 offset:1792
    v_mfma_f32_16x16x32_bf16 v[48:51], v[104:107], v[132:135], v[48:51]
    ds_read_b64_tr_b16 v[88:89], v148 offset:0
    ds_read_b64_tr_b16 v[90:91], v148 offset:1792
    v_mfma_f32_16x16x32_bf16 v[24:27], v[108:111], v[128:131], v[24:27]
    s_add_u32 m0, s56, 98304
    s_mov_b32 s42, m0
    buffer_load_dwordx4 v169, s[52:55], s42 offen lds
    s_add_u32 m0, s56, 106496
    s_mov_b32 s42, m0
    buffer_load_dwordx4 v169, s[52:55], s42 offen lds
    v_mfma_f32_16x16x32_bf16 v[52:55], v[108:111], v[132:135], v[52:55]
    s_add_u32 m0, s56, 114688
    s_mov_b32 s42, m0
    buffer_load_dwordx4 v169, s[52:55], s42 offen lds
    s_add_u32 m0, s56, 122880
    s_mov_b32 s42, m0
    buffer_load_dwordx4 v169, s[52:55], s42 offen lds
    v_mfma_f32_16x16x32_bf16 v[28:31], v[112:115], v[128:131], v[28:31]
    v_mfma_f32_16x16x32_bf16 v[56:59], v[112:115], v[132:135], v[56:59]
    v_mfma_f32_16x16x32_bf16 v[32:35], v[116:119], v[128:131], v[32:35]
    v_mfma_f32_16x16x32_bf16 v[60:63], v[116:119], v[132:135], v[60:63]
    s_waitcnt lgkmcnt(0)
    v_mfma_f32_16x16x32_bf16 v[8:11], v[64:67], v[120:123], v[8:11]
    ds_read_b128 v[128:131], v137 offset:0
    ds_read_b128 v[132:135], v137 offset:2048
    v_mfma_f32_16x16x32_bf16 v[36:39], v[64:67], v[124:127], v[36:39]
    ds_read_b64_tr_b16 v[92:93], v142 offset:14336
    ds_read_b64_tr_b16 v[94:95], v142 offset:16128
    v_mfma_f32_16x16x32_bf16 v[12:15], v[68:71], v[120:123], v[12:15]
    ds_read_b64_tr_b16 v[96:97], v143 offset:14336
    ds_read_b64_tr_b16 v[98:99], v143 offset:16128
    v_mfma_f32_16x16x32_bf16 v[40:43], v[68:71], v[124:127], v[40:43]
    ds_read_b64_tr_b16 v[100:101], v144 offset:14336
    ds_read_b64_tr_b16 v[102:103], v144 offset:16128
    v_mfma_f32_16x16x32_bf16 v[16:19], v[72:75], v[120:123], v[16:19]
    ds_read_b64_tr_b16 v[104:105], v145 offset:14336
    ds_read_b64_tr_b16 v[106:107], v145 offset:16128
    v_mfma_f32_16x16x32_bf16 v[44:47], v[72:75], v[124:127], v[44:47]
    ds_read_b64_tr_b16 v[108:109], v146 offset:14336
    ds_read_b64_tr_b16 v[110:111], v146 offset:16128
    v_mfma_f32_16x16x32_bf16 v[20:23], v[76:79], v[120:123], v[20:23]
    ds_read_b64_tr_b16 v[112:113], v147 offset:14336
    ds_read_b64_tr_b16 v[114:115], v147 offset:16128
    v_mfma_f32_16x16x32_bf16 v[48:51], v[76:79], v[124:127], v[48:51]
    ds_read_b64_tr_b16 v[116:117], v148 offset:14336
    ds_read_b64_tr_b16 v[118:119], v148 offset:16128
    v_mfma_f32_16x16x32_bf16 v[24:27], v[80:83], v[120:123], v[24:27]
    v_mfma_f32_16x16x32_bf16 v[52:55], v[80:83], v[124:127], v[52:55]
    v_mfma_f32_16x16x32_bf16 v[28:31], v[84:87], v[120:123], v[28:31]
    v_mfma_f32_16x16x32_bf16 v[56:59], v[84:87], v[124:127], v[56:59]
    v_mfma_f32_16x16x32_bf16 v[32:35], v[88:91], v[120:123], v[32:35]
    v_mfma_f32_16x16x32_bf16 v[60:63], v[88:91], v[124:127], v[60:63]
    s_waitcnt lgkmcnt(0)
    v_mfma_f32_16x16x32_bf16 v[8:11], v[92:95], v[128:131], v[8:11]
    v_mfma_f32_16x16x32_bf16 v[36:39], v[92:95], v[132:135], v[36:39]
    v_mfma_f32_16x16x32_bf16 v[12:15], v[96:99], v[128:131], v[12:15]
    v_mfma_f32_16x16x32_bf16 v[40:43], v[96:99], v[132:135], v[40:43]
    v_mfma_f32_16x16x32_bf16 v[16:19], v[100:103], v[128:131], v[16:19]
    v_mfma_f32_16x16x32_bf16 v[44:47], v[100:103], v[132:135], v[44:47]
    v_mfma_f32_16x16x32_bf16 v[20:23], v[104:107], v[128:131], v[20:23]
    v_mfma_f32_16x16x32_bf16 v[48:51], v[104:107], v[132:135], v[48:51]
    v_mfma_f32_16x16x32_bf16 v[24:27], v[108:111], v[128:131], v[24:27]
    v_mfma_f32_16x16x32_bf16 v[52:55], v[108:111], v[132:135], v[52:55]
    v_mfma_f32_16x16x32_bf16 v[28:31], v[112:115], v[128:131], v[28:31]
    v_mfma_f32_16x16x32_bf16 v[56:59], v[112:115], v[132:135], v[56:59]
    v_mfma_f32_16x16x32_bf16 v[32:35], v[116:119], v[128:131], v[32:35]
    v_mfma_f32_16x16x32_bf16 v[60:63], v[116:119], v[132:135], v[60:63]
    s_barrier
    s_add_u32 m0, s56, 0
    s_mov_b32 s42, m0
    buffer_load_dwordx4 v169, s[52:55], s42 offen lds
    s_add_u32 m0, s56, 8192
    s_mov_b32 s42, m0
    buffer_load_dwordx4 v169, s[52:55], s42 offen lds
    s_add_u32 m0, s56, 16384
    s_mov_b32 s42, m0
    buffer_load_dwordx4 v169, s[52:55], s42 offen lds
    s_add_u32 m0, s56, 24576
    s_mov_b32 s42, m0
    buffer_load_dwordx4 v169, s[52:55], s42 offen lds
    s_add_u32 m0, s56, 32768
    s_mov_b32 s42, m0
    buffer_load_dwordx4 v169, s[52:55], s42 offen lds
    s_add_u32 m0, s56, 40960
    s_mov_b32 s42, m0
    buffer_load_dwordx4 v169, s[52:55], s42 offen lds
    v_and_b32 v5, 3, v2
    v_mul_u32_u24 v5, 32, v5
    v_add_u32 v5, v5, v3
    v_add_u32 v5, s33, v5
    s_mov_b32 s36, 7168
    v_mul_lo_u32 v5, v5, s36
    v_lshrrev_b32 v6, 2, v2
    v_mul_u32_u24 v6, 112, v6
    v_lshl_add_u32 v6, v4, 2, v6
    v_add_u32 v6, s34, v6
    v_lshlrev_b32 v6, 1, v6
    v_add_u32 v5, v5, v6
    buffer_load_dwordx2 v[64:65], v6, s[20:23], 0 offen offset:0
    buffer_load_dwordx2 v[68:69], v6, s[20:23], 0 offen offset:32
    buffer_load_dwordx2 v[72:73], v6, s[20:23], 0 offen offset:64
    buffer_load_dwordx2 v[76:77], v6, s[20:23], 0 offen offset:96
    buffer_load_dwordx2 v[80:81], v6, s[20:23], 0 offen offset:128
    buffer_load_dwordx2 v[84:85], v6, s[20:23], 0 offen offset:160
    buffer_load_dwordx2 v[88:89], v6, s[20:23], 0 offen offset:192
    s_waitcnt vmcnt(0)
    s_barrier
    v_and_b32 v67, 0xffff0000, v65
    v_lshlrev_b32 v66, 16, v65
    v_and_b32 v65, 0xffff0000, v64
    v_lshlrev_b32 v64, 16, v64
    v_and_b32 v71, 0xffff0000, v69
    v_lshlrev_b32 v70, 16, v69
    v_and_b32 v69, 0xffff0000, v68
    v_lshlrev_b32 v68, 16, v68
    v_and_b32 v75, 0xffff0000, v73
    v_lshlrev_b32 v74, 16, v73
    v_and_b32 v73, 0xffff0000, v72
    v_lshlrev_b32 v72, 16, v72
    v_and_b32 v79, 0xffff0000, v77
    v_lshlrev_b32 v78, 16, v77
    v_and_b32 v77, 0xffff0000, v76
    v_lshlrev_b32 v76, 16, v76
    v_and_b32 v83, 0xffff0000, v81
    v_lshlrev_b32 v82, 16, v81
    v_and_b32 v81, 0xffff0000, v80
    v_lshlrev_b32 v80, 16, v80
    v_and_b32 v87, 0xffff0000, v85
    v_lshlrev_b32 v86, 16, v85
    v_and_b32 v85, 0xffff0000, v84
    v_lshlrev_b32 v84, 16, v84
    v_and_b32 v91, 0xffff0000, v89
    v_lshlrev_b32 v90, 16, v89
    v_and_b32 v89, 0xffff0000, v88
    v_lshlrev_b32 v88, 16, v88
    v_cvt_pk_bf16_f32 v92, v8, v9
    v_lshlrev_b32 v8, 16, v92
    v_and_b32 v9, 0xffff0000, v92
    v_pk_add_f32 v[8:9], v[8:9], v[64:65]
    v_cvt_pk_bf16_f32 v92, v8, v9
    v_lshlrev_b32 v8, 1, v92
    v_and_b32 v8, 0x1fffe, v8
    v_lshrrev_b32 v9, 15, v92
    v_and_b32 v9, 0x1fffe, v9
    v_cvt_pk_bf16_f32 v93, v10, v11
    v_lshlrev_b32 v10, 16, v93
    v_and_b32 v11, 0xffff0000, v93
    v_pk_add_f32 v[10:11], v[10:11], v[66:67]
    v_cvt_pk_bf16_f32 v93, v10, v11
    v_lshlrev_b32 v10, 1, v93
    v_and_b32 v10, 0x1fffe, v10
    v_lshrrev_b32 v11, 15, v93
    v_and_b32 v11, 0x1fffe, v11
    ds_read_u16 v8, v8
    ds_read_u16_d16_hi v9, v9
    ds_read_u16 v10, v10
    ds_read_u16_d16_hi v11, v11
    v_cvt_pk_bf16_f32 v92, v12, v13
    v_lshlrev_b32 v12, 16, v92
    v_and_b32 v13, 0xffff0000, v92
    v_pk_add_f32 v[12:13], v[12:13], v[68:69]
    v_cvt_pk_bf16_f32 v92, v12, v13
    v_lshlrev_b32 v12, 1, v92
    v_and_b32 v12, 0x1fffe, v12
    v_lshrrev_b32 v13, 15, v92
    v_and_b32 v13, 0x1fffe, v13
    v_cvt_pk_bf16_f32 v93, v14, v15
    v_lshlrev_b32 v14, 16, v93
    v_and_b32 v15, 0xffff0000, v93
    v_pk_add_f32 v[14:15], v[14:15], v[70:71]
    v_cvt_pk_bf16_f32 v93, v14, v15
    v_lshlrev_b32 v14, 1, v93
    v_and_b32 v14, 0x1fffe, v14
    v_lshrrev_b32 v15, 15, v93
    v_and_b32 v15, 0x1fffe, v15
    ds_read_u16 v12, v12
    ds_read_u16_d16_hi v13, v13
    ds_read_u16 v14, v14
    ds_read_u16_d16_hi v15, v15
    v_cvt_pk_bf16_f32 v92, v16, v17
    v_lshlrev_b32 v16, 16, v92
    v_and_b32 v17, 0xffff0000, v92
    v_pk_add_f32 v[16:17], v[16:17], v[72:73]
    v_cvt_pk_bf16_f32 v92, v16, v17
    v_lshlrev_b32 v16, 1, v92
    v_and_b32 v16, 0x1fffe, v16
    v_lshrrev_b32 v17, 15, v92
    v_and_b32 v17, 0x1fffe, v17
    v_cvt_pk_bf16_f32 v93, v18, v19
    v_lshlrev_b32 v18, 16, v93
    v_and_b32 v19, 0xffff0000, v93
    v_pk_add_f32 v[18:19], v[18:19], v[74:75]
    v_cvt_pk_bf16_f32 v93, v18, v19
    v_lshlrev_b32 v18, 1, v93
    v_and_b32 v18, 0x1fffe, v18
    v_lshrrev_b32 v19, 15, v93
    v_and_b32 v19, 0x1fffe, v19
    ds_read_u16 v16, v16
    ds_read_u16_d16_hi v17, v17
    ds_read_u16 v18, v18
    ds_read_u16_d16_hi v19, v19
    s_waitcnt lgkmcnt(0)
    v_or_b32 v8, v8, v9
    v_or_b32 v9, v10, v11
    s_mov_b32 s43, 0
    buffer_store_dwordx2 v[8:9], v5, s[24:27], s43 offen offset:0
    v_or_b32 v12, v12, v13
    v_or_b32 v13, v14, v15
    s_mov_b32 s43, 0
    buffer_store_dwordx2 v[12:13], v5, s[24:27], s43 offen offset:32
    v_or_b32 v16, v16, v17
    v_or_b32 v17, v18, v19
    s_mov_b32 s43, 0
    buffer_store_dwordx2 v[16:17], v5, s[24:27], s43 offen offset:64
    v_cvt_pk_bf16_f32 v92, v20, v21
    v_lshlrev_b32 v20, 16, v92
    v_and_b32 v21, 0xffff0000, v92
    v_pk_add_f32 v[20:21], v[20:21], v[76:77]
    v_cvt_pk_bf16_f32 v92, v20, v21
    v_lshlrev_b32 v20, 1, v92
    v_and_b32 v20, 0x1fffe, v20
    v_lshrrev_b32 v21, 15, v92
    v_and_b32 v21, 0x1fffe, v21
    v_cvt_pk_bf16_f32 v93, v22, v23
    v_lshlrev_b32 v22, 16, v93
    v_and_b32 v23, 0xffff0000, v93
    v_pk_add_f32 v[22:23], v[22:23], v[78:79]
    v_cvt_pk_bf16_f32 v93, v22, v23
    v_lshlrev_b32 v22, 1, v93
    v_and_b32 v22, 0x1fffe, v22
    v_lshrrev_b32 v23, 15, v93
    v_and_b32 v23, 0x1fffe, v23
    ds_read_u16 v20, v20
    ds_read_u16_d16_hi v21, v21
    ds_read_u16 v22, v22
    ds_read_u16_d16_hi v23, v23
    v_cvt_pk_bf16_f32 v92, v24, v25
    v_lshlrev_b32 v24, 16, v92
    v_and_b32 v25, 0xffff0000, v92
    v_pk_add_f32 v[24:25], v[24:25], v[80:81]
    v_cvt_pk_bf16_f32 v92, v24, v25
    v_lshlrev_b32 v24, 1, v92
    v_and_b32 v24, 0x1fffe, v24
    v_lshrrev_b32 v25, 15, v92
    v_and_b32 v25, 0x1fffe, v25
    v_cvt_pk_bf16_f32 v93, v26, v27
    v_lshlrev_b32 v26, 16, v93
    v_and_b32 v27, 0xffff0000, v93
    v_pk_add_f32 v[26:27], v[26:27], v[82:83]
    v_cvt_pk_bf16_f32 v93, v26, v27
    v_lshlrev_b32 v26, 1, v93
    v_and_b32 v26, 0x1fffe, v26
    v_lshrrev_b32 v27, 15, v93
    v_and_b32 v27, 0x1fffe, v27
    ds_read_u16 v24, v24
    ds_read_u16_d16_hi v25, v25
    ds_read_u16 v26, v26
    ds_read_u16_d16_hi v27, v27
    v_cvt_pk_bf16_f32 v92, v28, v29
    v_lshlrev_b32 v28, 16, v92
    v_and_b32 v29, 0xffff0000, v92
    v_pk_add_f32 v[28:29], v[28:29], v[84:85]
    v_cvt_pk_bf16_f32 v92, v28, v29
    v_lshlrev_b32 v28, 1, v92
    v_and_b32 v28, 0x1fffe, v28
    v_lshrrev_b32 v29, 15, v92
    v_and_b32 v29, 0x1fffe, v29
    v_cvt_pk_bf16_f32 v93, v30, v31
    v_lshlrev_b32 v30, 16, v93
    v_and_b32 v31, 0xffff0000, v93
    v_pk_add_f32 v[30:31], v[30:31], v[86:87]
    v_cvt_pk_bf16_f32 v93, v30, v31
    v_lshlrev_b32 v30, 1, v93
    v_and_b32 v30, 0x1fffe, v30
    v_lshrrev_b32 v31, 15, v93
    v_and_b32 v31, 0x1fffe, v31
    ds_read_u16 v28, v28
    ds_read_u16_d16_hi v29, v29
    ds_read_u16 v30, v30
    ds_read_u16_d16_hi v31, v31
    s_waitcnt lgkmcnt(0)
    v_or_b32 v20, v20, v21
    v_or_b32 v21, v22, v23
    s_mov_b32 s43, 0
    buffer_store_dwordx2 v[20:21], v5, s[24:27], s43 offen offset:96
    v_or_b32 v24, v24, v25
    v_or_b32 v25, v26, v27
    s_mov_b32 s43, 0
    buffer_store_dwordx2 v[24:25], v5, s[24:27], s43 offen offset:128
    v_or_b32 v28, v28, v29
    v_or_b32 v29, v30, v31
    s_mov_b32 s43, 0
    buffer_store_dwordx2 v[28:29], v5, s[24:27], s43 offen offset:160
    v_cvt_pk_bf16_f32 v92, v32, v33
    v_lshlrev_b32 v32, 16, v92
    v_and_b32 v33, 0xffff0000, v92
    v_pk_add_f32 v[32:33], v[32:33], v[88:89]
    v_cvt_pk_bf16_f32 v92, v32, v33
    v_lshlrev_b32 v32, 1, v92
    v_and_b32 v32, 0x1fffe, v32
    v_lshrrev_b32 v33, 15, v92
    v_and_b32 v33, 0x1fffe, v33
    v_cvt_pk_bf16_f32 v93, v34, v35
    v_lshlrev_b32 v34, 16, v93
    v_and_b32 v35, 0xffff0000, v93
    v_pk_add_f32 v[34:35], v[34:35], v[90:91]
    v_cvt_pk_bf16_f32 v93, v34, v35
    v_lshlrev_b32 v34, 1, v93
    v_and_b32 v34, 0x1fffe, v34
    v_lshrrev_b32 v35, 15, v93
    v_and_b32 v35, 0x1fffe, v35
    ds_read_u16 v32, v32
    ds_read_u16_d16_hi v33, v33
    ds_read_u16 v34, v34
    ds_read_u16_d16_hi v35, v35
    v_cvt_pk_bf16_f32 v92, v36, v37
    v_lshlrev_b32 v36, 16, v92
    v_and_b32 v37, 0xffff0000, v92
    v_pk_add_f32 v[36:37], v[36:37], v[64:65]
    v_cvt_pk_bf16_f32 v92, v36, v37
    v_lshlrev_b32 v36, 1, v92
    v_and_b32 v36, 0x1fffe, v36
    v_lshrrev_b32 v37, 15, v92
    v_and_b32 v37, 0x1fffe, v37
    v_cvt_pk_bf16_f32 v93, v38, v39
    v_lshlrev_b32 v38, 16, v93
    v_and_b32 v39, 0xffff0000, v93
    v_pk_add_f32 v[38:39], v[38:39], v[66:67]
    v_cvt_pk_bf16_f32 v93, v38, v39
    v_lshlrev_b32 v38, 1, v93
    v_and_b32 v38, 0x1fffe, v38
    v_lshrrev_b32 v39, 15, v93
    v_and_b32 v39, 0x1fffe, v39
    ds_read_u16 v36, v36
    ds_read_u16_d16_hi v37, v37
    ds_read_u16 v38, v38
    ds_read_u16_d16_hi v39, v39
    v_cvt_pk_bf16_f32 v92, v40, v41
    v_lshlrev_b32 v40, 16, v92
    v_and_b32 v41, 0xffff0000, v92
    v_pk_add_f32 v[40:41], v[40:41], v[68:69]
    v_cvt_pk_bf16_f32 v92, v40, v41
    v_lshlrev_b32 v40, 1, v92
    v_and_b32 v40, 0x1fffe, v40
    v_lshrrev_b32 v41, 15, v92
    v_and_b32 v41, 0x1fffe, v41
    v_cvt_pk_bf16_f32 v93, v42, v43
    v_lshlrev_b32 v42, 16, v93
    v_and_b32 v43, 0xffff0000, v93
    v_pk_add_f32 v[42:43], v[42:43], v[70:71]
    v_cvt_pk_bf16_f32 v93, v42, v43
    v_lshlrev_b32 v42, 1, v93
    v_and_b32 v42, 0x1fffe, v42
    v_lshrrev_b32 v43, 15, v93
    v_and_b32 v43, 0x1fffe, v43
    ds_read_u16 v40, v40
    ds_read_u16_d16_hi v41, v41
    ds_read_u16 v42, v42
    ds_read_u16_d16_hi v43, v43
    s_waitcnt lgkmcnt(0)
    v_or_b32 v32, v32, v33
    v_or_b32 v33, v34, v35
    s_mov_b32 s43, 0
    buffer_store_dwordx2 v[32:33], v5, s[24:27], s43 offen offset:192
    v_or_b32 v36, v36, v37
    v_or_b32 v37, v38, v39
    s_mov_b32 s43, 114688
    buffer_store_dwordx2 v[36:37], v5, s[24:27], s43 offen offset:0
    v_or_b32 v40, v40, v41
    v_or_b32 v41, v42, v43
    s_mov_b32 s43, 114688
    buffer_store_dwordx2 v[40:41], v5, s[24:27], s43 offen offset:32
    v_cvt_pk_bf16_f32 v92, v44, v45
    v_lshlrev_b32 v44, 16, v92
    v_and_b32 v45, 0xffff0000, v92
    v_pk_add_f32 v[44:45], v[44:45], v[72:73]
    v_cvt_pk_bf16_f32 v92, v44, v45
    v_lshlrev_b32 v44, 1, v92
    v_and_b32 v44, 0x1fffe, v44
    v_lshrrev_b32 v45, 15, v92
    v_and_b32 v45, 0x1fffe, v45
    v_cvt_pk_bf16_f32 v93, v46, v47
    v_lshlrev_b32 v46, 16, v93
    v_and_b32 v47, 0xffff0000, v93
    v_pk_add_f32 v[46:47], v[46:47], v[74:75]
    v_cvt_pk_bf16_f32 v93, v46, v47
    v_lshlrev_b32 v46, 1, v93
    v_and_b32 v46, 0x1fffe, v46
    v_lshrrev_b32 v47, 15, v93
    v_and_b32 v47, 0x1fffe, v47
    ds_read_u16 v44, v44
    ds_read_u16_d16_hi v45, v45
    ds_read_u16 v46, v46
    ds_read_u16_d16_hi v47, v47
    v_cvt_pk_bf16_f32 v92, v48, v49
    v_lshlrev_b32 v48, 16, v92
    v_and_b32 v49, 0xffff0000, v92
    v_pk_add_f32 v[48:49], v[48:49], v[76:77]
    v_cvt_pk_bf16_f32 v92, v48, v49
    v_lshlrev_b32 v48, 1, v92
    v_and_b32 v48, 0x1fffe, v48
    v_lshrrev_b32 v49, 15, v92
    v_and_b32 v49, 0x1fffe, v49
    v_cvt_pk_bf16_f32 v93, v50, v51
    v_lshlrev_b32 v50, 16, v93
    v_and_b32 v51, 0xffff0000, v93
    v_pk_add_f32 v[50:51], v[50:51], v[78:79]
    v_cvt_pk_bf16_f32 v93, v50, v51
    v_lshlrev_b32 v50, 1, v93
    v_and_b32 v50, 0x1fffe, v50
    v_lshrrev_b32 v51, 15, v93
    v_and_b32 v51, 0x1fffe, v51
    ds_read_u16 v48, v48
    ds_read_u16_d16_hi v49, v49
    ds_read_u16 v50, v50
    ds_read_u16_d16_hi v51, v51
    v_cvt_pk_bf16_f32 v92, v52, v53
    v_lshlrev_b32 v52, 16, v92
    v_and_b32 v53, 0xffff0000, v92
    v_pk_add_f32 v[52:53], v[52:53], v[80:81]
    v_cvt_pk_bf16_f32 v92, v52, v53
    v_lshlrev_b32 v52, 1, v92
    v_and_b32 v52, 0x1fffe, v52
    v_lshrrev_b32 v53, 15, v92
    v_and_b32 v53, 0x1fffe, v53
    v_cvt_pk_bf16_f32 v93, v54, v55
    v_lshlrev_b32 v54, 16, v93
    v_and_b32 v55, 0xffff0000, v93
    v_pk_add_f32 v[54:55], v[54:55], v[82:83]
    v_cvt_pk_bf16_f32 v93, v54, v55
    v_lshlrev_b32 v54, 1, v93
    v_and_b32 v54, 0x1fffe, v54
    v_lshrrev_b32 v55, 15, v93
    v_and_b32 v55, 0x1fffe, v55
    ds_read_u16 v52, v52
    ds_read_u16_d16_hi v53, v53
    ds_read_u16 v54, v54
    ds_read_u16_d16_hi v55, v55
    s_waitcnt lgkmcnt(0)
    v_or_b32 v44, v44, v45
    v_or_b32 v45, v46, v47
    s_mov_b32 s43, 114688
    buffer_store_dwordx2 v[44:45], v5, s[24:27], s43 offen offset:64
    v_or_b32 v48, v48, v49
    v_or_b32 v49, v50, v51
    s_mov_b32 s43, 114688
    buffer_store_dwordx2 v[48:49], v5, s[24:27], s43 offen offset:96
    v_or_b32 v52, v52, v53
    v_or_b32 v53, v54, v55
    s_mov_b32 s43, 114688
    buffer_store_dwordx2 v[52:53], v5, s[24:27], s43 offen offset:128
    v_cvt_pk_bf16_f32 v92, v56, v57
    v_lshlrev_b32 v56, 16, v92
    v_and_b32 v57, 0xffff0000, v92
    v_pk_add_f32 v[56:57], v[56:57], v[84:85]
    v_cvt_pk_bf16_f32 v92, v56, v57
    v_lshlrev_b32 v56, 1, v92
    v_and_b32 v56, 0x1fffe, v56
    v_lshrrev_b32 v57, 15, v92
    v_and_b32 v57, 0x1fffe, v57
    v_cvt_pk_bf16_f32 v93, v58, v59
    v_lshlrev_b32 v58, 16, v93
    v_and_b32 v59, 0xffff0000, v93
    v_pk_add_f32 v[58:59], v[58:59], v[86:87]
    v_cvt_pk_bf16_f32 v93, v58, v59
    v_lshlrev_b32 v58, 1, v93
    v_and_b32 v58, 0x1fffe, v58
    v_lshrrev_b32 v59, 15, v93
    v_and_b32 v59, 0x1fffe, v59
    ds_read_u16 v56, v56
    ds_read_u16_d16_hi v57, v57
    ds_read_u16 v58, v58
    ds_read_u16_d16_hi v59, v59
    v_cvt_pk_bf16_f32 v92, v60, v61
    v_lshlrev_b32 v60, 16, v92
    v_and_b32 v61, 0xffff0000, v92
    v_pk_add_f32 v[60:61], v[60:61], v[88:89]
    v_cvt_pk_bf16_f32 v92, v60, v61
    v_lshlrev_b32 v60, 1, v92
    v_and_b32 v60, 0x1fffe, v60
    v_lshrrev_b32 v61, 15, v92
    v_and_b32 v61, 0x1fffe, v61
    v_cvt_pk_bf16_f32 v93, v62, v63
    v_lshlrev_b32 v62, 16, v93
    v_and_b32 v63, 0xffff0000, v93
    v_pk_add_f32 v[62:63], v[62:63], v[90:91]
    v_cvt_pk_bf16_f32 v93, v62, v63
    v_lshlrev_b32 v62, 1, v93
    v_and_b32 v62, 0x1fffe, v62
    v_lshrrev_b32 v63, 15, v93
    v_and_b32 v63, 0x1fffe, v63
    ds_read_u16 v60, v60
    ds_read_u16_d16_hi v61, v61
    ds_read_u16 v62, v62
    ds_read_u16_d16_hi v63, v63
    s_waitcnt lgkmcnt(0)
    v_or_b32 v56, v56, v57
    v_or_b32 v57, v58, v59
    s_mov_b32 s43, 114688
    buffer_store_dwordx2 v[56:57], v5, s[24:27], s43 offen offset:160
    v_or_b32 v60, v60, v61
    v_or_b32 v61, v62, v63
    s_mov_b32 s43, 114688
    buffer_store_dwordx2 v[60:61], v5, s[24:27], s43 offen offset:192
gemm1_kernel_end:
    s_endpgm
.globl gemm2_kernel
.p2align 8
.type gemm2_kernel,@function
gemm2_kernel:
    s_load_dwordx4 s[4:7], s[0:1], 48
    s_load_dwordx2 s[16:17], s[0:1], 72
    s_cmp_ge_u32 s2, 256
    s_cbranch_scc1 gemm2_kernel_end
    s_waitcnt lgkmcnt(0)
    s_mov_b32 s8, s4
    s_and_b32 s9, s5, 0xffff
    s_mov_b32 s10, 7340032
    s_mov_b32 s11, 0x00020000
    s_add_u32 s12, s16, 33554432
    s_addc_u32 s13, s17, 0
    s_and_b32 s13, s13, 0xffff
    s_mov_b32 s14, 14680064
    s_mov_b32 s15, 0x00020000
    s_add_u32 s20, s16, 16777216
    s_addc_u32 s21, s17, 0
    s_and_b32 s21, s21, 0xffff
    s_mov_b32 s22, 4194304
    s_mov_b32 s23, 0x00020000
    s_mov_b32 s24, s6
    s_and_b32 s25, s7, 0xffff
    s_mov_b32 s26, 4194304
    s_mov_b32 s27, 0x00020000
    s_and_b32 s28, s2, 7
    s_lshr_b32 s29, s2, 3
    s_and_b32 s30, s28, 3
    s_lshl_b32 s30, s30, 2
    s_and_b32 s31, s29, 3
    s_add_u32 s30, s30, s31
    s_lshr_b32 s31, s28, 2
    s_lshl_b32 s31, s31, 3
    s_lshr_b32 s32, s29, 2
    s_add_u32 s31, s31, s32
    s_lshl_b32 s33, s30, 7
    s_mul_i32 s34, s31, 64
    v_and_b32 v1, 63, v0
    v_lshrrev_b32 v2, 6, v0
    v_and_b32 v3, 15, v1
    v_lshrrev_b32 v4, 4, v1
    v_readfirstlane_b32 s35, v2
    v_lshrrev_b32 v5, 3, v1
    v_and_b32 v6, 7, v1
    v_xor_b32 v6, v6, v5
    v_lshl_add_u32 v5, v2, 4, v5
    v_add_u32 v5, s33, v5
    s_mov_b32 s36, 7168
    v_mul_lo_u32 v5, v5, s36
    v_lshl_add_u32 v5, v6, 4, v5
    v_add_u32 v80, 4096, v5
    v_add_u32 v81, 60416, v5
    s_lshl_b32 s37, s34, 1
    s_mov_b32 s38, 2048
    v_mul_u32_u24 v5, 64, v2
    v_add_u32 v5, v5, v1
    v_add_u32 v5, 0, v5
    v_mul_u32_u24 v6, 8192, v5
    v_lshrrev_b32 v6, 16, v6
    v_mul_u32_u24 v7, 8, v6
    v_sub_u32 v84, v5, v7
    v_bfe_u32 v7, v6, 3, 1
    v_lshlrev_b32 v7, 2, v7
    v_and_b32 v83, 2, v6
    v_or_b32 v7, v7, v83
    v_xor_b32 v84, v84, v7
    v_mul_lo_u32 v6, v6, s38
    v_lshl_add_u32 v6, v84, 4, v6
    v_add_u32 v6, s37, v6
    v_add_u32 v6, 4096, v6
    v_mov_b32 v82, v6
    s_sub_u32 s8, s8, 4096
    s_subb_u32 s9, s9, 0
    s_add_u32 s10, s10, 4096
    s_sub_u32 s12, s12, 4096
    s_subb_u32 s13, s13, 0
    s_add_u32 s14, s14, 4096
    v_and_b32 v5, 3, v2
    v_mul_u32_u24 v5, 32, v5
    v_add_u32 v5, v5, v3
    v_lshlrev_b32 v5, 7, v5
    v_and_b32 v6, 7, v1
    v_or_b32 v7, 0, v4
    v_xor_b32 v7, v7, v6
    v_lshl_add_u32 v7, v7, 4, v5
    v_add_u32 v56, 0, v7
    v_add_u32 v58, 24576, v7
    v_add_u32 v60, 49152, v7
    v_add_u32 v62, 73728, v7
    v_add_u32 v64, 98304, v7
    v_add_u32 v66, 122880, v7
    v_or_b32 v7, 4, v4
    v_xor_b32 v7, v7, v6
    v_lshl_add_u32 v7, v7, 4, v5
    v_add_u32 v57, 0, v7
    v_add_u32 v59, 24576, v7
    v_add_u32 v61, 49152, v7
    v_add_u32 v63, 73728, v7
    v_add_u32 v65, 98304, v7
    v_add_u32 v67, 122880, v7
    v_lshrrev_b32 v5, 2, v3
    v_lshl_add_u32 v6, v4, 3, v5
    v_mul_u32_u24 v6, 128, v6
    v_and_b32 v7, 3, v1
    v_lshl_add_u32 v6, v7, 3, v6
    v_and_b32 v7, 1, v4
    v_lshlrev_b32 v7, 2, v7
    v_and_b32 v5, 2, v5
    v_or_b32 v7, v7, v5
    v_lshrrev_b32 v5, 2, v2
    v_mul_u32_u24 v5, 4, v5
    v_add_u32 v84, 0, v5
    v_xor_b32 v84, v84, v7
    v_lshl_add_u32 v84, v84, 4, v6
    v_add_u32 v68, 16384, v84
    v_add_u32 v70, 40960, v84
    v_add_u32 v72, 65536, v84
    v_add_u32 v74, 90112, v84
    v_add_u32 v76, 114688, v84
    v_add_u32 v78, 139264, v84
    v_add_u32 v84, 2, v5
    v_xor_b32 v84, v84, v7
    v_lshl_add_u32 v84, v84, 4, v6
    v_add_u32 v69, 16384, v84
    v_add_u32 v71, 40960, v84
    v_add_u32 v73, 65536, v84
    v_add_u32 v75, 90112, v84
    v_add_u32 v77, 114688, v84
    v_add_u32 v79, 139264, v84
    s_mul_i32 s40, s35, 2048
    s_mul_i32 s41, s35, 1024
    s_add_u32 s41, s41, 16384
    s_lshl_b32 s56, s35, 10
    s_mov_b32 s57, 0
    s_add_u32 m0, s40, 0
    s_lshl_b32 s42, s57, 7
    s_mul_i32 s43, s57, 131072
    buffer_load_dwordx4 v80, s[12:15], s42 offen offset:0 lds
    buffer_load_dwordx4 v81, s[12:15], s42 offen offset:1024 lds
    s_add_u32 s57, s57, 1
    s_cmp_eq_u32 s57, 56
    s_cselect_b32 s57, 0, s57
    s_add_u32 m0, s41, 0
    s_nop 0
    buffer_load_dwordx4 v82, s[8:11], s43 offen offset:0 lds
    s_add_u32 m0, s40, 24576
    s_lshl_b32 s42, s57, 7
    s_mul_i32 s43, s57, 131072
    buffer_load_dwordx4 v80, s[12:15], s42 offen offset:0 lds
    buffer_load_dwordx4 v81, s[12:15], s42 offen offset:1024 lds
    s_add_u32 s57, s57, 1
    s_cmp_eq_u32 s57, 56
    s_cselect_b32 s57, 0, s57
    s_add_u32 m0, s41, 24576
    s_nop 0
    buffer_load_dwordx4 v82, s[8:11], s43 offen offset:0 lds
    s_add_u32 m0, s40, 49152
    s_lshl_b32 s42, s57, 7
    s_mul_i32 s43, s57, 131072
    buffer_load_dwordx4 v80, s[12:15], s42 offen offset:0 lds
    buffer_load_dwordx4 v81, s[12:15], s42 offen offset:1024 lds
    s_add_u32 s57, s57, 1
    s_cmp_eq_u32 s57, 56
    s_cselect_b32 s57, 0, s57
    s_add_u32 m0, s41, 49152
    s_nop 0
    buffer_load_dwordx4 v82, s[8:11], s43 offen offset:0 lds
    s_add_u32 m0, s40, 73728
    s_lshl_b32 s42, s57, 7
    s_mul_i32 s43, s57, 131072
    buffer_load_dwordx4 v80, s[12:15], s42 offen offset:0 lds
    buffer_load_dwordx4 v81, s[12:15], s42 offen offset:1024 lds
    s_add_u32 s57, s57, 1
    s_cmp_eq_u32 s57, 56
    s_cselect_b32 s57, 0, s57
    s_add_u32 m0, s41, 73728
    s_nop 0
    buffer_load_dwordx4 v82, s[8:11], s43 offen offset:0 lds
    s_add_u32 m0, s40, 98304
    s_lshl_b32 s42, s57, 7
    s_mul_i32 s43, s57, 131072
    buffer_load_dwordx4 v80, s[12:15], s42 offen offset:0 lds
    buffer_load_dwordx4 v81, s[12:15], s42 offen offset:1024 lds
    s_add_u32 s57, s57, 1
    s_cmp_eq_u32 s57, 56
    s_cselect_b32 s57, 0, s57
    s_add_u32 m0, s41, 98304
    s_nop 0
    buffer_load_dwordx4 v82, s[8:11], s43 offen offset:0 lds
    s_add_u32 m0, s40, 122880
    s_lshl_b32 s42, s57, 7
    s_mul_i32 s43, s57, 131072
    buffer_load_dwordx4 v80, s[12:15], s42 offen offset:0 lds
    buffer_load_dwordx4 v81, s[12:15], s42 offen offset:1024 lds
    s_add_u32 s57, s57, 1
    s_cmp_eq_u32 s57, 56
    s_cselect_b32 s57, 0, s57
    s_add_u32 m0, s41, 122880
    s_nop 0
    buffer_load_dwordx4 v82, s[8:11], s43 offen offset:0 lds
    s_waitcnt vmcnt(15)
    s_barrier
    ds_read_b128 v[40:43], v56 offset:0
    ds_read_b128 v[44:47], v56 offset:2048
    ds_read_b64_tr_b16 v[24:25], v68 offset:0
    ds_read_b64_tr_b16 v[26:27], v68 offset:512
    ds_read_b64_tr_b16 v[28:29], v69 offset:0
    ds_read_b64_tr_b16 v[30:31], v69 offset:512
    s_waitcnt lgkmcnt(0)
    v_mfma_f32_16x16x32_bf16 v[8:11], v[24:27], v[40:43], 0
    ds_read_b128 v[48:51], v57 offset:0
    ds_read_b128 v[52:55], v57 offset:2048
    v_mfma_f32_16x16x32_bf16 v[16:19], v[24:27], v[44:47], 0
    ds_read_b64_tr_b16 v[32:33], v68 offset:4096
    ds_read_b64_tr_b16 v[34:35], v68 offset:4608
    v_mfma_f32_16x16x32_bf16 v[12:15], v[28:31], v[40:43], 0
    ds_read_b64_tr_b16 v[36:37], v69 offset:4096
    ds_read_b64_tr_b16 v[38:39], v69 offset:4608
    v_mfma_f32_16x16x32_bf16 v[20:23], v[28:31], v[44:47], 0
    s_waitcnt vmcnt(12) lgkmcnt(0)
    s_barrier
    v_mfma_f32_16x16x32_bf16 v[8:11], v[32:35], v[48:51], v[8:11]
    ds_read_b128 v[40:43], v58 offset:0
    ds_read_b128 v[44:47], v58 offset:2048
    v_mfma_f32_16x16x32_bf16 v[16:19], v[32:35], v[52:55], v[16:19]
    ds_read_b64_tr_b16 v[24:25], v70 offset:0
    ds_read_b64_tr_b16 v[26:27], v70 offset:512
    v_mfma_f32_16x16x32_bf16 v[12:15], v[36:39], v[48:51], v[12:15]
    ds_read_b64_tr_b16 v[28:29], v71 offset:0
    ds_read_b64_tr_b16 v[30:31], v71 offset:512
    v_mfma_f32_16x16x32_bf16 v[20:23], v[36:39], v[52:55], v[20:23]
    s_add_u32 m0, s40, 0
    s_lshl_b32 s42, s57, 7
    s_mul_i32 s43, s57, 131072
    buffer_load_dwordx4 v80, s[12:15], s42 offen offset:0 lds
    buffer_load_dwordx4 v81, s[12:15], s42 offen offset:1024 lds
    s_add_u32 s57, s57, 1
    s_cmp_eq_u32 s57, 56
    s_cselect_b32 s57, 0, s57
    s_add_u32 m0, s41, 0
    s_nop 0
    buffer_load_dwordx4 v82, s[8:11], s43 offen offset:0 lds
    s_waitcnt lgkmcnt(0)
    v_mfma_f32_16x16x32_bf16 v[8:11], v[24:27], v[40:43], v[8:11]
    ds_read_b128 v[48:51], v59 offset:0
    ds_read_b128 v[52:55], v59 offset:2048
    v_mfma_f32_16x16x32_bf16 v[16:19], v[24:27], v[44:47], v[16:19]
    ds_read_b64_tr_b16 v[32:33], v70 offset:4096
    ds_read_b64_tr_b16 v[34:35], v70 offset:4608
    v_mfma_f32_16x16x32_bf16 v[12:15], v[28:31], v[40:43], v[12:15]
    ds_read_b64_tr_b16 v[36:37], v71 offset:4096
    ds_read_b64_tr_b16 v[38:39], v71 offset:4608
    v_mfma_f32_16x16x32_bf16 v[20:23], v[28:31], v[44:47], v[20:23]
    s_waitcnt vmcnt(12) lgkmcnt(0)
    s_barrier
    v_mfma_f32_16x16x32_bf16 v[8:11], v[32:35], v[48:51], v[8:11]
    ds_read_b128 v[40:43], v60 offset:0
    ds_read_b128 v[44:47], v60 offset:2048
    v_mfma_f32_16x16x32_bf16 v[16:19], v[32:35], v[52:55], v[16:19]
    ds_read_b64_tr_b16 v[24:25], v72 offset:0
    ds_read_b64_tr_b16 v[26:27], v72 offset:512
    v_mfma_f32_16x16x32_bf16 v[12:15], v[36:39], v[48:51], v[12:15]
    ds_read_b64_tr_b16 v[28:29], v73 offset:0
    ds_read_b64_tr_b16 v[30:31], v73 offset:512
    v_mfma_f32_16x16x32_bf16 v[20:23], v[36:39], v[52:55], v[20:23]
    s_add_u32 m0, s40, 24576
    s_lshl_b32 s42, s57, 7
    s_mul_i32 s43, s57, 131072
    buffer_load_dwordx4 v80, s[12:15], s42 offen offset:0 lds
    buffer_load_dwordx4 v81, s[12:15], s42 offen offset:1024 lds
    s_add_u32 s57, s57, 1
    s_cmp_eq_u32 s57, 56
    s_cselect_b32 s57, 0, s57
    s_add_u32 m0, s41, 24576
    s_nop 0
    buffer_load_dwordx4 v82, s[8:11], s43 offen offset:0 lds
    s_waitcnt lgkmcnt(0)
    v_mfma_f32_16x16x32_bf16 v[8:11], v[24:27], v[40:43], v[8:11]
    ds_read_b128 v[48:51], v61 offset:0
    ds_read_b128 v[52:55], v61 offset:2048
    v_mfma_f32_16x16x32_bf16 v[16:19], v[24:27], v[44:47], v[16:19]
    ds_read_b64_tr_b16 v[32:33], v72 offset:4096
    ds_read_b64_tr_b16 v[34:35], v72 offset:4608
    v_mfma_f32_16x16x32_bf16 v[12:15], v[28:31], v[40:43], v[12:15]
    ds_read_b64_tr_b16 v[36:37], v73 offset:4096
    ds_read_b64_tr_b16 v[38:39], v73 offset:4608
    v_mfma_f32_16x16x32_bf16 v[20:23], v[28:31], v[44:47], v[20:23]
    s_waitcnt vmcnt(12) lgkmcnt(0)
    s_barrier
    v_mfma_f32_16x16x32_bf16 v[8:11], v[32:35], v[48:51], v[8:11]
    ds_read_b128 v[40:43], v62 offset:0
    ds_read_b128 v[44:47], v62 offset:2048
    v_mfma_f32_16x16x32_bf16 v[16:19], v[32:35], v[52:55], v[16:19]
    ds_read_b64_tr_b16 v[24:25], v74 offset:0
    ds_read_b64_tr_b16 v[26:27], v74 offset:512
    v_mfma_f32_16x16x32_bf16 v[12:15], v[36:39], v[48:51], v[12:15]
    ds_read_b64_tr_b16 v[28:29], v75 offset:0
    ds_read_b64_tr_b16 v[30:31], v75 offset:512
    v_mfma_f32_16x16x32_bf16 v[20:23], v[36:39], v[52:55], v[20:23]
    s_add_u32 m0, s40, 49152
    s_lshl_b32 s42, s57, 7
    s_mul_i32 s43, s57, 131072
    buffer_load_dwordx4 v80, s[12:15], s42 offen offset:0 lds
    buffer_load_dwordx4 v81, s[12:15], s42 offen offset:1024 lds
    s_add_u32 s57, s57, 1
    s_cmp_eq_u32 s57, 56
    s_cselect_b32 s57, 0, s57
    s_add_u32 m0, s41, 49152
    s_nop 0
    buffer_load_dwordx4 v82, s[8:11], s43 offen offset:0 lds
    s_waitcnt lgkmcnt(0)
    v_mfma_f32_16x16x32_bf16 v[8:11], v[24:27], v[40:43], v[8:11]
    ds_read_b128 v[48:51], v63 offset:0
    ds_read_b128 v[52:55], v63 offset:2048
    v_mfma_f32_16x16x32_bf16 v[16:19], v[24:27], v[44:47], v[16:19]
    ds_read_b64_tr_b16 v[32:33], v74 offset:4096
    ds_read_b64_tr_b16 v[34:35], v74 offset:4608
    v_mfma_f32_16x16x32_bf16 v[12:15], v[28:31], v[40:43], v[12:15]
    ds_read_b64_tr_b16 v[36:37], v75 offset:4096
    ds_read_b64_tr_b16 v[38:39], v75 offset:4608
    v_mfma_f32_16x16x32_bf16 v[20:23], v[28:31], v[44:47], v[20:23]
    s_waitcnt vmcnt(12) lgkmcnt(0)
    s_barrier
    v_mfma_f32_16x16x32_bf16 v[8:11], v[32:35], v[48:51], v[8:11]
    ds_read_b128 v[40:43], v64 offset:0
    ds_read_b128 v[44:47], v64 offset:2048
    v_mfma_f32_16x16x32_bf16 v[16:19], v[32:35], v[52:55], v[16:19]
    ds_read_b64_tr_b16 v[24:25], v76 offset:0
    ds_read_b64_tr_b16 v[26:27], v76 offset:512
    v_mfma_f32_16x16x32_bf16 v[12:15], v[36:39], v[48:51], v[12:15]
    ds_read_b64_tr_b16 v[28:29], v77 offset:0
    ds_read_b64_tr_b16 v[30:31], v77 offset:512
    v_mfma_f32_16x16x32_bf16 v[20:23], v[36:39], v[52:55], v[20:23]
    s_add_u32 m0, s40, 73728
    s_lshl_b32 s42, s57, 7
    s_mul_i32 s43, s57, 131072
    buffer_load_dwordx4 v80, s[12:15], s42 offen offset:0 lds
    buffer_load_dwordx4 v81, s[12:15], s42 offen offset:1024 lds
    s_add_u32 s57, s57, 1
    s_cmp_eq_u32 s57, 56
    s_cselect_b32 s57, 0, s57
    s_add_u32 m0, s41, 73728
    s_nop 0
    buffer_load_dwordx4 v82, s[8:11], s43 offen offset:0 lds
    s_waitcnt lgkmcnt(0)
    v_mfma_f32_16x16x32_bf16 v[8:11], v[24:27], v[40:43], v[8:11]
    ds_read_b128 v[48:51], v65 offset:0
    ds_read_b128 v[52:55], v65 offset:2048
    v_mfma_f32_16x16x32_bf16 v[16:19], v[24:27], v[44:47], v[16:19]
    ds_read_b64_tr_b16 v[32:33], v76 offset:4096
    ds_read_b64_tr_b16 v[34:35], v76 offset:4608
    v_mfma_f32_16x16x32_bf16 v[12:15], v[28:31], v[40:43], v[12:15]
    ds_read_b64_tr_b16 v[36:37], v77 offset:4096
    ds_read_b64_tr_b16 v[38:39], v77 offset:4608
    v_mfma_f32_16x16x32_bf16 v[20:23], v[28:31], v[44:47], v[20:23]
    s_waitcnt vmcnt(12) lgkmcnt(0)
    s_barrier
    v_mfma_f32_16x16x32_bf16 v[8:11], v[32:35], v[48:51], v[8:11]
    ds_read_b128 v[40:43], v66 offset:0
    ds_read_b128 v[44:47], v66 offset:2048
    v_mfma_f32_16x16x32_bf16 v[16:19], v[32:35], v[52:55], v[16:19]
    ds_read_b64_tr_b16 v[24:25], v78 offset:0
    ds_read_b64_tr_b16 v[26:27], v78 offset:512
    v_mfma_f32_16x16x32_bf16 v[12:15], v[36:39], v[48:51], v[12:15]
    ds_read_b64_tr_b16 v[28:29], v79 offset:0
    ds_read_b64_tr_b16 v[30:31], v79 offset:512
    v_mfma_f32_16x16x32_bf16 v[20:23], v[36:39], v[52:55], v[20:23]
    s_add_u32 m0, s40, 98304
    s_lshl_b32 s42, s57, 7
    s_mul_i32 s43, s57, 131072
    buffer_load_dwordx4 v80, s[12:15], s42 offen offset:0 lds
    buffer_load_dwordx4 v81, s[12:15], s42 offen offset:1024 lds
    s_add_u32 s57, s57, 1
    s_cmp_eq_u32 s57, 56
    s_cselect_b32 s57, 0, s57
    s_add_u32 m0, s41, 98304
    s_nop 0
    buffer_load_dwordx4 v82, s[8:11], s43 offen offset:0 lds
    s_waitcnt lgkmcnt(0)
    v_mfma_f32_16x16x32_bf16 v[8:11], v[24:27], v[40:43], v[8:11]
    ds_read_b128 v[48:51], v67 offset:0
    ds_read_b128 v[52:55], v67 offset:2048
    v_mfma_f32_16x16x32_bf16 v[16:19], v[24:27], v[44:47], v[16:19]
    ds_read_b64_tr_b16 v[32:33], v78 offset:4096
    ds_read_b64_tr_b16 v[34:35], v78 offset:4608
    v_mfma_f32_16x16x32_bf16 v[12:15], v[28:31], v[40:43], v[12:15]
    ds_read_b64_tr_b16 v[36:37], v79 offset:4096
    ds_read_b64_tr_b16 v[38:39], v79 offset:4608
    v_mfma_f32_16x16x32_bf16 v[20:23], v[28:31], v[44:47], v[20:23]
    s_waitcnt vmcnt(12) lgkmcnt(0)
    s_barrier
    v_mfma_f32_16x16x32_bf16 v[8:11], v[32:35], v[48:51], v[8:11]
    ds_read_b128 v[40:43], v56 offset:0
    ds_read_b128 v[44:47], v56 offset:2048
    v_mfma_f32_16x16x32_bf16 v[16:19], v[32:35], v[52:55], v[16:19]
    ds_read_b64_tr_b16 v[24:25], v68 offset:0
    ds_read_b64_tr_b16 v[26:27], v68 offset:512
    v_mfma_f32_16x16x32_bf16 v[12:15], v[36:39], v[48:51], v[12:15]
    ds_read_b64_tr_b16 v[28:29], v69 offset:0
    ds_read_b64_tr_b16 v[30:31], v69 offset:512
    v_mfma_f32_16x16x32_bf16 v[20:23], v[36:39], v[52:55], v[20:23]
    s_add_u32 m0, s40, 122880
    s_lshl_b32 s42, s57, 7
    s_mul_i32 s43, s57, 131072
    buffer_load_dwordx4 v80, s[12:15], s42 offen offset:0 lds
    buffer_load_dwordx4 v81, s[12:15], s42 offen offset:1024 lds
    s_add_u32 s57, s57, 1
    s_cmp_eq_u32 s57, 56
    s_cselect_b32 s57, 0, s57
    s_add_u32 m0, s41, 122880
    s_nop 0
    buffer_load_dwordx4 v82, s[8:11], s43 offen offset:0 lds
    s_waitcnt lgkmcnt(0)
    v_mfma_f32_16x16x32_bf16 v[8:11], v[24:27], v[40:43], v[8:11]
    ds_read_b128 v[48:51], v57 offset:0
    ds_read_b128 v[52:55], v57 offset:2048
    v_mfma_f32_16x16x32_bf16 v[16:19], v[24:27], v[44:47], v[16:19]
    ds_read_b64_tr_b16 v[32:33], v68 offset:4096
    ds_read_b64_tr_b16 v[34:35], v68 offset:4608
    v_mfma_f32_16x16x32_bf16 v[12:15], v[28:31], v[40:43], v[12:15]
    ds_read_b64_tr_b16 v[36:37], v69 offset:4096
    ds_read_b64_tr_b16 v[38:39], v69 offset:4608
    v_mfma_f32_16x16x32_bf16 v[20:23], v[28:31], v[44:47], v[20:23]
    s_waitcnt vmcnt(12) lgkmcnt(0)
    s_barrier
    v_mfma_f32_16x16x32_bf16 v[8:11], v[32:35], v[48:51], v[8:11]
    ds_read_b128 v[40:43], v58 offset:0
    ds_read_b128 v[44:47], v58 offset:2048
    v_mfma_f32_16x16x32_bf16 v[16:19], v[32:35], v[52:55], v[16:19]
    ds_read_b64_tr_b16 v[24:25], v70 offset:0
    ds_read_b64_tr_b16 v[26:27], v70 offset:512
    v_mfma_f32_16x16x32_bf16 v[12:15], v[36:39], v[48:51], v[12:15]
    ds_read_b64_tr_b16 v[28:29], v71 offset:0
    ds_read_b64_tr_b16 v[30:31], v71 offset:512
    v_mfma_f32_16x16x32_bf16 v[20:23], v[36:39], v[52:55], v[20:23]
    s_add_u32 m0, s40, 0
    s_lshl_b32 s42, s57, 7
    s_mul_i32 s43, s57, 131072
    buffer_load_dwordx4 v80, s[12:15], s42 offen offset:0 lds
    buffer_load_dwordx4 v81, s[12:15], s42 offen offset:1024 lds
    s_add_u32 s57, s57, 1
    s_cmp_eq_u32 s57, 56
    s_cselect_b32 s57, 0, s57
    s_add_u32 m0, s41, 0
    s_nop 0
    buffer_load_dwordx4 v82, s[8:11], s43 offen offset:0 lds
    s_waitcnt lgkmcnt(0)
    v_mfma_f32_16x16x32_bf16 v[8:11], v[24:27], v[40:43], v[8:11]
    ds_read_b128 v[48:51], v59 offset:0
    ds_read_b128 v[52:55], v59 offset:2048
    v_mfma_f32_16x16x32_bf16 v[16:19], v[24:27], v[44:47], v[16:19]
    ds_read_b64_tr_b16 v[32:33], v70 offset:4096
    ds_read_b64_tr_b16 v[34:35], v70 offset:4608
    v_mfma_f32_16x16x32_bf16 v[12:15], v[28:31], v[40:43], v[12:15]
    ds_read_b64_tr_b16 v[36:37], v71 offset:4096
    ds_read_b64_tr_b16 v[38:39], v71 offset:4608
    v_mfma_f32_16x16x32_bf16 v[20:23], v[28:31], v[44:47], v[20:23]
    s_waitcnt vmcnt(12) lgkmcnt(0)
    s_barrier
    v_mfma_f32_16x16x32_bf16 v[8:11], v[32:35], v[48:51], v[8:11]
    ds_read_b128 v[40:43], v60 offset:0
    ds_read_b128 v[44:47], v60 offset:2048
    v_mfma_f32_16x16x32_bf16 v[16:19], v[32:35], v[52:55], v[16:19]
    ds_read_b64_tr_b16 v[24:25], v72 offset:0
    ds_read_b64_tr_b16 v[26:27], v72 offset:512
    v_mfma_f32_16x16x32_bf16 v[12:15], v[36:39], v[48:51], v[12:15]
    ds_read_b64_tr_b16 v[28:29], v73 offset:0
    ds_read_b64_tr_b16 v[30:31], v73 offset:512
    v_mfma_f32_16x16x32_bf16 v[20:23], v[36:39], v[52:55], v[20:23]
    s_add_u32 m0, s40, 24576
    s_lshl_b32 s42, s57, 7
    s_mul_i32 s43, s57, 131072
    buffer_load_dwordx4 v80, s[12:15], s42 offen offset:0 lds
    buffer_load_dwordx4 v81, s[12:15], s42 offen offset:1024 lds
    s_add_u32 s57, s57, 1
    s_cmp_eq_u32 s57, 56
    s_cselect_b32 s57, 0, s57
    s_add_u32 m0, s41, 24576
    s_nop 0
    buffer_load_dwordx4 v82, s[8:11], s43 offen offset:0 lds
    s_waitcnt lgkmcnt(0)
    v_mfma_f32_16x16x32_bf16 v[8:11], v[24:27], v[40:43], v[8:11]
    ds_read_b128 v[48:51], v61 offset:0
    ds_read_b128 v[52:55], v61 offset:2048
    v_mfma_f32_16x16x32_bf16 v[16:19], v[24:27], v[44:47], v[16:19]
    ds_read_b64_tr_b16 v[32:33], v72 offset:4096
    ds_read_b64_tr_b16 v[34:35], v72 offset:4608
    v_mfma_f32_16x16x32_bf16 v[12:15], v[28:31], v[40:43], v[12:15]
    ds_read_b64_tr_b16 v[36:37], v73 offset:4096
    ds_read_b64_tr_b16 v[38:39], v73 offset:4608
    v_mfma_f32_16x16x32_bf16 v[20:23], v[28:31], v[44:47], v[20:23]
    s_waitcnt vmcnt(12) lgkmcnt(0)
    s_barrier
    v_mfma_f32_16x16x32_bf16 v[8:11], v[32:35], v[48:51], v[8:11]
    ds_read_b128 v[40:43], v62 offset:0
    ds_read_b128 v[44:47], v62 offset:2048
    v_mfma_f32_16x16x32_bf16 v[16:19], v[32:35], v[52:55], v[16:19]
    ds_read_b64_tr_b16 v[24:25], v74 offset:0
    ds_read_b64_tr_b16 v[26:27], v74 offset:512
    v_mfma_f32_16x16x32_bf16 v[12:15], v[36:39], v[48:51], v[12:15]
    ds_read_b64_tr_b16 v[28:29], v75 offset:0
    ds_read_b64_tr_b16 v[30:31], v75 offset:512
    v_mfma_f32_16x16x32_bf16 v[20:23], v[36:39], v[52:55], v[20:23]
    s_add_u32 m0, s40, 49152
    s_lshl_b32 s42, s57, 7
    s_mul_i32 s43, s57, 131072
    buffer_load_dwordx4 v80, s[12:15], s42 offen offset:0 lds
    buffer_load_dwordx4 v81, s[12:15], s42 offen offset:1024 lds
    s_add_u32 s57, s57, 1
    s_cmp_eq_u32 s57, 56
    s_cselect_b32 s57, 0, s57
    s_add_u32 m0, s41, 49152
    s_nop 0
    buffer_load_dwordx4 v82, s[8:11], s43 offen offset:0 lds
    s_waitcnt lgkmcnt(0)
    v_mfma_f32_16x16x32_bf16 v[8:11], v[24:27], v[40:43], v[8:11]
    ds_read_b128 v[48:51], v63 offset:0
    ds_read_b128 v[52:55], v63 offset:2048
    v_mfma_f32_16x16x32_bf16 v[16:19], v[24:27], v[44:47], v[16:19]
    ds_read_b64_tr_b16 v[32:33], v74 offset:4096
    ds_read_b64_tr_b16 v[34:35], v74 offset:4608
    v_mfma_f32_16x16x32_bf16 v[12:15], v[28:31], v[40:43], v[12:15]
    ds_read_b64_tr_b16 v[36:37], v75 offset:4096
    ds_read_b64_tr_b16 v[38:39], v75 offset:4608
    v_mfma_f32_16x16x32_bf16 v[20:23], v[28:31], v[44:47], v[20:23]
    s_waitcnt vmcnt(12) lgkmcnt(0)
    s_barrier
    v_mfma_f32_16x16x32_bf16 v[8:11], v[32:35], v[48:51], v[8:11]
    ds_read_b128 v[40:43], v64 offset:0
    ds_read_b128 v[44:47], v64 offset:2048
    v_mfma_f32_16x16x32_bf16 v[16:19], v[32:35], v[52:55], v[16:19]
    ds_read_b64_tr_b16 v[24:25], v76 offset:0
    ds_read_b64_tr_b16 v[26:27], v76 offset:512
    v_mfma_f32_16x16x32_bf16 v[12:15], v[36:39], v[48:51], v[12:15]
    ds_read_b64_tr_b16 v[28:29], v77 offset:0
    ds_read_b64_tr_b16 v[30:31], v77 offset:512
    v_mfma_f32_16x16x32_bf16 v[20:23], v[36:39], v[52:55], v[20:23]
    s_add_u32 m0, s40, 73728
    s_lshl_b32 s42, s57, 7
    s_mul_i32 s43, s57, 131072
    buffer_load_dwordx4 v80, s[12:15], s42 offen offset:0 lds
    buffer_load_dwordx4 v81, s[12:15], s42 offen offset:1024 lds
    s_add_u32 s57, s57, 1
    s_cmp_eq_u32 s57, 56
    s_cselect_b32 s57, 0, s57
    s_add_u32 m0, s41, 73728
    s_nop 0
    buffer_load_dwordx4 v82, s[8:11], s43 offen offset:0 lds
    s_waitcnt lgkmcnt(0)
    v_mfma_f32_16x16x32_bf16 v[8:11], v[24:27], v[40:43], v[8:11]
    ds_read_b128 v[48:51], v65 offset:0
    ds_read_b128 v[52:55], v65 offset:2048
    v_mfma_f32_16x16x32_bf16 v[16:19], v[24:27], v[44:47], v[16:19]
    ds_read_b64_tr_b16 v[32:33], v76 offset:4096
    ds_read_b64_tr_b16 v[34:35], v76 offset:4608
    v_mfma_f32_16x16x32_bf16 v[12:15], v[28:31], v[40:43], v[12:15]
    ds_read_b64_tr_b16 v[36:37], v77 offset:4096
    ds_read_b64_tr_b16 v[38:39], v77 offset:4608
    v_mfma_f32_16x16x32_bf16 v[20:23], v[28:31], v[44:47], v[20:23]
    s_waitcnt vmcnt(12) lgkmcnt(0)
    s_barrier
    v_mfma_f32_16x16x32_bf16 v[8:11], v[32:35], v[48:51], v[8:11]
    ds_read_b128 v[40:43], v66 offset:0
    ds_read_b128 v[44:47], v66 offset:2048
    v_mfma_f32_16x16x32_bf16 v[16:19], v[32:35], v[52:55], v[16:19]
    ds_read_b64_tr_b16 v[24:25], v78 offset:0
    ds_read_b64_tr_b16 v[26:27], v78 offset:512
    v_mfma_f32_16x16x32_bf16 v[12:15], v[36:39], v[48:51], v[12:15]
    ds_read_b64_tr_b16 v[28:29], v79 offset:0
    ds_read_b64_tr_b16 v[30:31], v79 offset:512
    v_mfma_f32_16x16x32_bf16 v[20:23], v[36:39], v[52:55], v[20:23]
    s_add_u32 m0, s40, 98304
    s_lshl_b32 s42, s57, 7
    s_mul_i32 s43, s57, 131072
    buffer_load_dwordx4 v80, s[12:15], s42 offen offset:0 lds
    buffer_load_dwordx4 v81, s[12:15], s42 offen offset:1024 lds
    s_add_u32 s57, s57, 1
    s_cmp_eq_u32 s57, 56
    s_cselect_b32 s57, 0, s57
    s_add_u32 m0, s41, 98304
    s_nop 0
    buffer_load_dwordx4 v82, s[8:11], s43 offen offset:0 lds
    s_waitcnt lgkmcnt(0)
    v_mfma_f32_16x16x32_bf16 v[8:11], v[24:27], v[40:43], v[8:11]
    ds_read_b128 v[48:51], v67 offset:0
    ds_read_b128 v[52:55], v67 offset:2048
    v_mfma_f32_16x16x32_bf16 v[16:19], v[24:27], v[44:47], v[16:19]
    ds_read_b64_tr_b16 v[32:33], v78 offset:4096
    ds_read_b64_tr_b16 v[34:35], v78 offset:4608
    v_mfma_f32_16x16x32_bf16 v[12:15], v[28:31], v[40:43], v[12:15]
    ds_read_b64_tr_b16 v[36:37], v79 offset:4096
    ds_read_b64_tr_b16 v[38:39], v79 offset:4608
    v_mfma_f32_16x16x32_bf16 v[20:23], v[28:31], v[44:47], v[20:23]
    s_waitcnt vmcnt(12) lgkmcnt(0)
    s_barrier
    v_mfma_f32_16x16x32_bf16 v[8:11], v[32:35], v[48:51], v[8:11]
    ds_read_b128 v[40:43], v56 offset:0
    ds_read_b128 v[44:47], v56 offset:2048
    v_mfma_f32_16x16x32_bf16 v[16:19], v[32:35], v[52:55], v[16:19]
    ds_read_b64_tr_b16 v[24:25], v68 offset:0
    ds_read_b64_tr_b16 v[26:27], v68 offset:512
    v_mfma_f32_16x16x32_bf16 v[12:15], v[36:39], v[48:51], v[12:15]
    ds_read_b64_tr_b16 v[28:29], v69 offset:0
    ds_read_b64_tr_b16 v[30:31], v69 offset:512
    v_mfma_f32_16x16x32_bf16 v[20:23], v[36:39], v[52:55], v[20:23]
    s_add_u32 m0, s40, 122880
    s_lshl_b32 s42, s57, 7
    s_mul_i32 s43, s57, 131072
    buffer_load_dwordx4 v80, s[12:15], s42 offen offset:0 lds
    buffer_load_dwordx4 v81, s[12:15], s42 offen offset:1024 lds
    s_add_u32 s57, s57, 1
    s_cmp_eq_u32 s57, 56
    s_cselect_b32 s57, 0, s57
    s_add_u32 m0, s41, 122880
    s_nop 0
    buffer_load_dwordx4 v82, s[8:11], s43 offen offset:0 lds
    s_waitcnt lgkmcnt(0)
    v_mfma_f32_16x16x32_bf16 v[8:11], v[24:27], v[40:43], v[8:11]
    ds_read_b128 v[48:51], v57 offset:0
    ds_read_b128 v[52:55], v57 offset:2048
    v_mfma_f32_16x16x32_bf16 v[16:19], v[24:27], v[44:47], v[16:19]
    ds_read_b64_tr_b16 v[32:33], v68 offset:4096
    ds_read_b64_tr_b16 v[34:35], v68 offset:4608
    v_mfma_f32_16x16x32_bf16 v[12:15], v[28:31], v[40:43], v[12:15]
    ds_read_b64_tr_b16 v[36:37], v69 offset:4096
    ds_read_b64_tr_b16 v[38:39], v69 offset:4608
    v_mfma_f32_16x16x32_bf16 v[20:23], v[28:31], v[44:47], v[20:23]
    s_waitcnt vmcnt(12) lgkmcnt(0)
    s_barrier
    v_mfma_f32_16x16x32_bf16 v[8:11], v[32:35], v[48:51], v[8:11]
    ds_read_b128 v[40:43], v58 offset:0
    ds_read_b128 v[44:47], v58 offset:2048
    v_mfma_f32_16x16x32_bf16 v[16:19], v[32:35], v[52:55], v[16:19]
    ds_read_b64_tr_b16 v[24:25], v70 offset:0
    ds_read_b64_tr_b16 v[26:27], v70 offset:512
    v_mfma_f32_16x16x32_bf16 v[12:15], v[36:39], v[48:51], v[12:15]
    ds_read_b64_tr_b16 v[28:29], v71 offset:0
    ds_read_b64_tr_b16 v[30:31], v71 offset:512
    v_mfma_f32_16x16x32_bf16 v[20:23], v[36:39], v[52:55], v[20:23]
    s_add_u32 m0, s40, 0
    s_lshl_b32 s42, s57, 7
    s_mul_i32 s43, s57, 131072
    buffer_load_dwordx4 v80, s[12:15], s42 offen offset:0 lds
    buffer_load_dwordx4 v81, s[12:15], s42 offen offset:1024 lds
    s_add_u32 s57, s57, 1
    s_cmp_eq_u32 s57, 56
    s_cselect_b32 s57, 0, s57
    s_add_u32 m0, s41, 0
    s_nop 0
    buffer_load_dwordx4 v82, s[8:11], s43 offen offset:0 lds
    s_waitcnt lgkmcnt(0)
    v_mfma_f32_16x16x32_bf16 v[8:11], v[24:27], v[40:43], v[8:11]
    ds_read_b128 v[48:51], v59 offset:0
    ds_read_b128 v[52:55], v59 offset:2048
    v_mfma_f32_16x16x32_bf16 v[16:19], v[24:27], v[44:47], v[16:19]
    ds_read_b64_tr_b16 v[32:33], v70 offset:4096
    ds_read_b64_tr_b16 v[34:35], v70 offset:4608
    v_mfma_f32_16x16x32_bf16 v[12:15], v[28:31], v[40:43], v[12:15]
    ds_read_b64_tr_b16 v[36:37], v71 offset:4096
    ds_read_b64_tr_b16 v[38:39], v71 offset:4608
    v_mfma_f32_16x16x32_bf16 v[20:23], v[28:31], v[44:47], v[20:23]
    s_waitcnt vmcnt(12) lgkmcnt(0)
    s_barrier
    v_mfma_f32_16x16x32_bf16 v[8:11], v[32:35], v[48:51], v[8:11]
    ds_read_b128 v[40:43], v60 offset:0
    ds_read_b128 v[44:47], v60 offset:2048
    v_mfma_f32_16x16x32_bf16 v[16:19], v[32:35], v[52:55], v[16:19]
    ds_read_b64_tr_b16 v[24:25], v72 offset:0
    ds_read_b64_tr_b16 v[26:27], v72 offset:512
    v_mfma_f32_16x16x32_bf16 v[12:15], v[36:39], v[48:51], v[12:15]
    ds_read_b64_tr_b16 v[28:29], v73 offset:0
    ds_read_b64_tr_b16 v[30:31], v73 offset:512
    v_mfma_f32_16x16x32_bf16 v[20:23], v[36:39], v[52:55], v[20:23]
    s_add_u32 m0, s40, 24576
    s_lshl_b32 s42, s57, 7
    s_mul_i32 s43, s57, 131072
    buffer_load_dwordx4 v80, s[12:15], s42 offen offset:0 lds
    buffer_load_dwordx4 v81, s[12:15], s42 offen offset:1024 lds
    s_add_u32 s57, s57, 1
    s_cmp_eq_u32 s57, 56
    s_cselect_b32 s57, 0, s57
    s_add_u32 m0, s41, 24576
    s_nop 0
    buffer_load_dwordx4 v82, s[8:11], s43 offen offset:0 lds
    s_waitcnt lgkmcnt(0)
    v_mfma_f32_16x16x32_bf16 v[8:11], v[24:27], v[40:43], v[8:11]
    ds_read_b128 v[48:51], v61 offset:0
    ds_read_b128 v[52:55], v61 offset:2048
    v_mfma_f32_16x16x32_bf16 v[16:19], v[24:27], v[44:47], v[16:19]
    ds_read_b64_tr_b16 v[32:33], v72 offset:4096
    ds_read_b64_tr_b16 v[34:35], v72 offset:4608
    v_mfma_f32_16x16x32_bf16 v[12:15], v[28:31], v[40:43], v[12:15]
    ds_read_b64_tr_b16 v[36:37], v73 offset:4096
    ds_read_b64_tr_b16 v[38:39], v73 offset:4608
    v_mfma_f32_16x16x32_bf16 v[20:23], v[28:31], v[44:47], v[20:23]
    s_waitcnt vmcnt(12) lgkmcnt(0)
    s_barrier
    v_mfma_f32_16x16x32_bf16 v[8:11], v[32:35], v[48:51], v[8:11]
    ds_read_b128 v[40:43], v62 offset:0
    ds_read_b128 v[44:47], v62 offset:2048
    v_mfma_f32_16x16x32_bf16 v[16:19], v[32:35], v[52:55], v[16:19]
    ds_read_b64_tr_b16 v[24:25], v74 offset:0
    ds_read_b64_tr_b16 v[26:27], v74 offset:512
    v_mfma_f32_16x16x32_bf16 v[12:15], v[36:39], v[48:51], v[12:15]
    ds_read_b64_tr_b16 v[28:29], v75 offset:0
    ds_read_b64_tr_b16 v[30:31], v75 offset:512
    v_mfma_f32_16x16x32_bf16 v[20:23], v[36:39], v[52:55], v[20:23]
    s_add_u32 m0, s40, 49152
    s_lshl_b32 s42, s57, 7
    s_mul_i32 s43, s57, 131072
    buffer_load_dwordx4 v80, s[12:15], s42 offen offset:0 lds
    buffer_load_dwordx4 v81, s[12:15], s42 offen offset:1024 lds
    s_add_u32 s57, s57, 1
    s_cmp_eq_u32 s57, 56
    s_cselect_b32 s57, 0, s57
    s_add_u32 m0, s41, 49152
    s_nop 0
    buffer_load_dwordx4 v82, s[8:11], s43 offen offset:0 lds
    s_waitcnt lgkmcnt(0)
    v_mfma_f32_16x16x32_bf16 v[8:11], v[24:27], v[40:43], v[8:11]
    ds_read_b128 v[48:51], v63 offset:0
    ds_read_b128 v[52:55], v63 offset:2048
    v_mfma_f32_16x16x32_bf16 v[16:19], v[24:27], v[44:47], v[16:19]
    ds_read_b64_tr_b16 v[32:33], v74 offset:4096
    ds_read_b64_tr_b16 v[34:35], v74 offset:4608
    v_mfma_f32_16x16x32_bf16 v[12:15], v[28:31], v[40:43], v[12:15]
    ds_read_b64_tr_b16 v[36:37], v75 offset:4096
    ds_read_b64_tr_b16 v[38:39], v75 offset:4608
    v_mfma_f32_16x16x32_bf16 v[20:23], v[28:31], v[44:47], v[20:23]
    s_waitcnt vmcnt(12) lgkmcnt(0)
    s_barrier
    v_mfma_f32_16x16x32_bf16 v[8:11], v[32:35], v[48:51], v[8:11]
    ds_read_b128 v[40:43], v64 offset:0
    ds_read_b128 v[44:47], v64 offset:2048
    v_mfma_f32_16x16x32_bf16 v[16:19], v[32:35], v[52:55], v[16:19]
    ds_read_b64_tr_b16 v[24:25], v76 offset:0
    ds_read_b64_tr_b16 v[26:27], v76 offset:512
    v_mfma_f32_16x16x32_bf16 v[12:15], v[36:39], v[48:51], v[12:15]
    ds_read_b64_tr_b16 v[28:29], v77 offset:0
    ds_read_b64_tr_b16 v[30:31], v77 offset:512
    v_mfma_f32_16x16x32_bf16 v[20:23], v[36:39], v[52:55], v[20:23]
    s_add_u32 m0, s40, 73728
    s_lshl_b32 s42, s57, 7
    s_mul_i32 s43, s57, 131072
    buffer_load_dwordx4 v80, s[12:15], s42 offen offset:0 lds
    buffer_load_dwordx4 v81, s[12:15], s42 offen offset:1024 lds
    s_add_u32 s57, s57, 1
    s_cmp_eq_u32 s57, 56
    s_cselect_b32 s57, 0, s57
    s_add_u32 m0, s41, 73728
    s_nop 0
    buffer_load_dwordx4 v82, s[8:11], s43 offen offset:0 lds
    s_waitcnt lgkmcnt(0)
    v_mfma_f32_16x16x32_bf16 v[8:11], v[24:27], v[40:43], v[8:11]
    ds_read_b128 v[48:51], v65 offset:0
    ds_read_b128 v[52:55], v65 offset:2048
    v_mfma_f32_16x16x32_bf16 v[16:19], v[24:27], v[44:47], v[16:19]
    ds_read_b64_tr_b16 v[32:33], v76 offset:4096
    ds_read_b64_tr_b16 v[34:35], v76 offset:4608
    v_mfma_f32_16x16x32_bf16 v[12:15], v[28:31], v[40:43], v[12:15]
    ds_read_b64_tr_b16 v[36:37], v77 offset:4096
    ds_read_b64_tr_b16 v[38:39], v77 offset:4608
    v_mfma_f32_16x16x32_bf16 v[20:23], v[28:31], v[44:47], v[20:23]
    s_waitcnt vmcnt(12) lgkmcnt(0)
    s_barrier
    v_mfma_f32_16x16x32_bf16 v[8:11], v[32:35], v[48:51], v[8:11]
    ds_read_b128 v[40:43], v66 offset:0
    ds_read_b128 v[44:47], v66 offset:2048
    v_mfma_f32_16x16x32_bf16 v[16:19], v[32:35], v[52:55], v[16:19]
    ds_read_b64_tr_b16 v[24:25], v78 offset:0
    ds_read_b64_tr_b16 v[26:27], v78 offset:512
    v_mfma_f32_16x16x32_bf16 v[12:15], v[36:39], v[48:51], v[12:15]
    ds_read_b64_tr_b16 v[28:29], v79 offset:0
    ds_read_b64_tr_b16 v[30:31], v79 offset:512
    v_mfma_f32_16x16x32_bf16 v[20:23], v[36:39], v[52:55], v[20:23]
    s_add_u32 m0, s40, 98304
    s_lshl_b32 s42, s57, 7
    s_mul_i32 s43, s57, 131072
    buffer_load_dwordx4 v80, s[12:15], s42 offen offset:0 lds
    buffer_load_dwordx4 v81, s[12:15], s42 offen offset:1024 lds
    s_add_u32 s57, s57, 1
    s_cmp_eq_u32 s57, 56
    s_cselect_b32 s57, 0, s57
    s_add_u32 m0, s41, 98304
    s_nop 0
    buffer_load_dwordx4 v82, s[8:11], s43 offen offset:0 lds
    s_waitcnt lgkmcnt(0)
    v_mfma_f32_16x16x32_bf16 v[8:11], v[24:27], v[40:43], v[8:11]
    ds_read_b128 v[48:51], v67 offset:0
    ds_read_b128 v[52:55], v67 offset:2048
    v_mfma_f32_16x16x32_bf16 v[16:19], v[24:27], v[44:47], v[16:19]
    ds_read_b64_tr_b16 v[32:33], v78 offset:4096
    ds_read_b64_tr_b16 v[34:35], v78 offset:4608
    v_mfma_f32_16x16x32_bf16 v[12:15], v[28:31], v[40:43], v[12:15]
    ds_read_b64_tr_b16 v[36:37], v79 offset:4096
    ds_read_b64_tr_b16 v[38:39], v79 offset:4608
    v_mfma_f32_16x16x32_bf16 v[20:23], v[28:31], v[44:47], v[20:23]
    s_waitcnt vmcnt(12) lgkmcnt(0)
    s_barrier
    v_mfma_f32_16x16x32_bf16 v[8:11], v[32:35], v[48:51], v[8:11]
    ds_read_b128 v[40:43], v56 offset:0
    ds_read_b128 v[44:47], v56 offset:2048
    v_mfma_f32_16x16x32_bf16 v[16:19], v[32:35], v[52:55], v[16:19]
    ds_read_b64_tr_b16 v[24:25], v68 offset:0
    ds_read_b64_tr_b16 v[26:27], v68 offset:512
    v_mfma_f32_16x16x32_bf16 v[12:15], v[36:39], v[48:51], v[12:15]
    ds_read_b64_tr_b16 v[28:29], v69 offset:0
    ds_read_b64_tr_b16 v[30:31], v69 offset:512
    v_mfma_f32_16x16x32_bf16 v[20:23], v[36:39], v[52:55], v[20:23]
    s_add_u32 m0, s40, 122880
    s_lshl_b32 s42, s57, 7
    s_mul_i32 s43, s57, 131072
    buffer_load_dwordx4 v80, s[12:15], s42 offen offset:0 lds
    buffer_load_dwordx4 v81, s[12:15], s42 offen offset:1024 lds
    s_add_u32 s57, s57, 1
    s_cmp_eq_u32 s57, 56
    s_cselect_b32 s57, 0, s57
    s_add_u32 m0, s41, 122880
    s_nop 0
    buffer_load_dwordx4 v82, s[8:11], s43 offen offset:0 lds
    s_waitcnt lgkmcnt(0)
    v_mfma_f32_16x16x32_bf16 v[8:11], v[24:27], v[40:43], v[8:11]
    ds_read_b128 v[48:51], v57 offset:0
    ds_read_b128 v[52:55], v57 offset:2048
    v_mfma_f32_16x16x32_bf16 v[16:19], v[24:27], v[44:47], v[16:19]
    ds_read_b64_tr_b16 v[32:33], v68 offset:4096
    ds_read_b64_tr_b16 v[34:35], v68 offset:4608
    v_mfma_f32_16x16x32_bf16 v[12:15], v[28:31], v[40:43], v[12:15]
    ds_read_b64_tr_b16 v[36:37], v69 offset:4096
    ds_read_b64_tr_b16 v[38:39], v69 offset:4608
    v_mfma_f32_16x16x32_bf16 v[20:23], v[28:31], v[44:47], v[20:23]
    s_waitcnt vmcnt(12) lgkmcnt(0)
    s_barrier
    v_mfma_f32_16x16x32_bf16 v[8:11], v[32:35], v[48:51], v[8:11]
    ds_read_b128 v[40:43], v58 offset:0
    ds_read_b128 v[44:47], v58 offset:2048
    v_mfma_f32_16x16x32_bf16 v[16:19], v[32:35], v[52:55], v[16:19]
    ds_read_b64_tr_b16 v[24:25], v70 offset:0
    ds_read_b64_tr_b16 v[26:27], v70 offset:512
    v_mfma_f32_16x16x32_bf16 v[12:15], v[36:39], v[48:51], v[12:15]
    ds_read_b64_tr_b16 v[28:29], v71 offset:0
    ds_read_b64_tr_b16 v[30:31], v71 offset:512
    v_mfma_f32_16x16x32_bf16 v[20:23], v[36:39], v[52:55], v[20:23]
    s_add_u32 m0, s40, 0
    s_lshl_b32 s42, s57, 7
    s_mul_i32 s43, s57, 131072
    buffer_load_dwordx4 v80, s[12:15], s42 offen offset:0 lds
    buffer_load_dwordx4 v81, s[12:15], s42 offen offset:1024 lds
    s_add_u32 s57, s57, 1
    s_cmp_eq_u32 s57, 56
    s_cselect_b32 s57, 0, s57
    s_add_u32 m0, s41, 0
    s_nop 0
    buffer_load_dwordx4 v82, s[8:11], s43 offen offset:0 lds
    s_waitcnt lgkmcnt(0)
    v_mfma_f32_16x16x32_bf16 v[8:11], v[24:27], v[40:43], v[8:11]
    ds_read_b128 v[48:51], v59 offset:0
    ds_read_b128 v[52:55], v59 offset:2048
    v_mfma_f32_16x16x32_bf16 v[16:19], v[24:27], v[44:47], v[16:19]
    ds_read_b64_tr_b16 v[32:33], v70 offset:4096
    ds_read_b64_tr_b16 v[34:35], v70 offset:4608
    v_mfma_f32_16x16x32_bf16 v[12:15], v[28:31], v[40:43], v[12:15]
    ds_read_b64_tr_b16 v[36:37], v71 offset:4096
    ds_read_b64_tr_b16 v[38:39], v71 offset:4608
    v_mfma_f32_16x16x32_bf16 v[20:23], v[28:31], v[44:47], v[20:23]
    s_waitcnt vmcnt(12) lgkmcnt(0)
    s_barrier
    v_mfma_f32_16x16x32_bf16 v[8:11], v[32:35], v[48:51], v[8:11]
    ds_read_b128 v[40:43], v60 offset:0
    ds_read_b128 v[44:47], v60 offset:2048
    v_mfma_f32_16x16x32_bf16 v[16:19], v[32:35], v[52:55], v[16:19]
    ds_read_b64_tr_b16 v[24:25], v72 offset:0
    ds_read_b64_tr_b16 v[26:27], v72 offset:512
    v_mfma_f32_16x16x32_bf16 v[12:15], v[36:39], v[48:51], v[12:15]
    ds_read_b64_tr_b16 v[28:29], v73 offset:0
    ds_read_b64_tr_b16 v[30:31], v73 offset:512
    v_mfma_f32_16x16x32_bf16 v[20:23], v[36:39], v[52:55], v[20:23]
    s_add_u32 m0, s40, 24576
    s_lshl_b32 s42, s57, 7
    s_mul_i32 s43, s57, 131072
    buffer_load_dwordx4 v80, s[12:15], s42 offen offset:0 lds
    buffer_load_dwordx4 v81, s[12:15], s42 offen offset:1024 lds
    s_add_u32 s57, s57, 1
    s_cmp_eq_u32 s57, 56
    s_cselect_b32 s57, 0, s57
    s_add_u32 m0, s41, 24576
    s_nop 0
    buffer_load_dwordx4 v82, s[8:11], s43 offen offset:0 lds
    s_waitcnt lgkmcnt(0)
    v_mfma_f32_16x16x32_bf16 v[8:11], v[24:27], v[40:43], v[8:11]
    ds_read_b128 v[48:51], v61 offset:0
    ds_read_b128 v[52:55], v61 offset:2048
    v_mfma_f32_16x16x32_bf16 v[16:19], v[24:27], v[44:47], v[16:19]
    ds_read_b64_tr_b16 v[32:33], v72 offset:4096
    ds_read_b64_tr_b16 v[34:35], v72 offset:4608
    v_mfma_f32_16x16x32_bf16 v[12:15], v[28:31], v[40:43], v[12:15]
    ds_read_b64_tr_b16 v[36:37], v73 offset:4096
    ds_read_b64_tr_b16 v[38:39], v73 offset:4608
    v_mfma_f32_16x16x32_bf16 v[20:23], v[28:31], v[44:47], v[20:23]
    s_waitcnt vmcnt(12) lgkmcnt(0)
    s_barrier
    v_mfma_f32_16x16x32_bf16 v[8:11], v[32:35], v[48:51], v[8:11]
    ds_read_b128 v[40:43], v62 offset:0
    ds_read_b128 v[44:47], v62 offset:2048
    v_mfma_f32_16x16x32_bf16 v[16:19], v[32:35], v[52:55], v[16:19]
    ds_read_b64_tr_b16 v[24:25], v74 offset:0
    ds_read_b64_tr_b16 v[26:27], v74 offset:512
    v_mfma_f32_16x16x32_bf16 v[12:15], v[36:39], v[48:51], v[12:15]
    ds_read_b64_tr_b16 v[28:29], v75 offset:0
    ds_read_b64_tr_b16 v[30:31], v75 offset:512
    v_mfma_f32_16x16x32_bf16 v[20:23], v[36:39], v[52:55], v[20:23]
    s_add_u32 m0, s40, 49152
    s_lshl_b32 s42, s57, 7
    s_mul_i32 s43, s57, 131072
    buffer_load_dwordx4 v80, s[12:15], s42 offen offset:0 lds
    buffer_load_dwordx4 v81, s[12:15], s42 offen offset:1024 lds
    s_add_u32 s57, s57, 1
    s_cmp_eq_u32 s57, 56
    s_cselect_b32 s57, 0, s57
    s_add_u32 m0, s41, 49152
    s_nop 0
    buffer_load_dwordx4 v82, s[8:11], s43 offen offset:0 lds
    s_waitcnt lgkmcnt(0)
    v_mfma_f32_16x16x32_bf16 v[8:11], v[24:27], v[40:43], v[8:11]
    ds_read_b128 v[48:51], v63 offset:0
    ds_read_b128 v[52:55], v63 offset:2048
    v_mfma_f32_16x16x32_bf16 v[16:19], v[24:27], v[44:47], v[16:19]
    ds_read_b64_tr_b16 v[32:33], v74 offset:4096
    ds_read_b64_tr_b16 v[34:35], v74 offset:4608
    v_mfma_f32_16x16x32_bf16 v[12:15], v[28:31], v[40:43], v[12:15]
    ds_read_b64_tr_b16 v[36:37], v75 offset:4096
    ds_read_b64_tr_b16 v[38:39], v75 offset:4608
    v_mfma_f32_16x16x32_bf16 v[20:23], v[28:31], v[44:47], v[20:23]
    s_waitcnt vmcnt(12) lgkmcnt(0)
    s_barrier
    v_mfma_f32_16x16x32_bf16 v[8:11], v[32:35], v[48:51], v[8:11]
    ds_read_b128 v[40:43], v64 offset:0
    ds_read_b128 v[44:47], v64 offset:2048
    v_mfma_f32_16x16x32_bf16 v[16:19], v[32:35], v[52:55], v[16:19]
    ds_read_b64_tr_b16 v[24:25], v76 offset:0
    ds_read_b64_tr_b16 v[26:27], v76 offset:512
    v_mfma_f32_16x16x32_bf16 v[12:15], v[36:39], v[48:51], v[12:15]
    ds_read_b64_tr_b16 v[28:29], v77 offset:0
    ds_read_b64_tr_b16 v[30:31], v77 offset:512
    v_mfma_f32_16x16x32_bf16 v[20:23], v[36:39], v[52:55], v[20:23]
    s_add_u32 m0, s40, 73728
    s_lshl_b32 s42, s57, 7
    s_mul_i32 s43, s57, 131072
    buffer_load_dwordx4 v80, s[12:15], s42 offen offset:0 lds
    buffer_load_dwordx4 v81, s[12:15], s42 offen offset:1024 lds
    s_add_u32 s57, s57, 1
    s_cmp_eq_u32 s57, 56
    s_cselect_b32 s57, 0, s57
    s_add_u32 m0, s41, 73728
    s_nop 0
    buffer_load_dwordx4 v82, s[8:11], s43 offen offset:0 lds
    s_waitcnt lgkmcnt(0)
    v_mfma_f32_16x16x32_bf16 v[8:11], v[24:27], v[40:43], v[8:11]
    ds_read_b128 v[48:51], v65 offset:0
    ds_read_b128 v[52:55], v65 offset:2048
    v_mfma_f32_16x16x32_bf16 v[16:19], v[24:27], v[44:47], v[16:19]
    ds_read_b64_tr_b16 v[32:33], v76 offset:4096
    ds_read_b64_tr_b16 v[34:35], v76 offset:4608
    v_mfma_f32_16x16x32_bf16 v[12:15], v[28:31], v[40:43], v[12:15]
    ds_read_b64_tr_b16 v[36:37], v77 offset:4096
    ds_read_b64_tr_b16 v[38:39], v77 offset:4608
    v_mfma_f32_16x16x32_bf16 v[20:23], v[28:31], v[44:47], v[20:23]
    s_waitcnt vmcnt(12) lgkmcnt(0)
    s_barrier
    v_mfma_f32_16x16x32_bf16 v[8:11], v[32:35], v[48:51], v[8:11]
    ds_read_b128 v[40:43], v66 offset:0
    ds_read_b128 v[44:47], v66 offset:2048
    v_mfma_f32_16x16x32_bf16 v[16:19], v[32:35], v[52:55], v[16:19]
    ds_read_b64_tr_b16 v[24:25], v78 offset:0
    ds_read_b64_tr_b16 v[26:27], v78 offset:512
    v_mfma_f32_16x16x32_bf16 v[12:15], v[36:39], v[48:51], v[12:15]
    ds_read_b64_tr_b16 v[28:29], v79 offset:0
    ds_read_b64_tr_b16 v[30:31], v79 offset:512
    v_mfma_f32_16x16x32_bf16 v[20:23], v[36:39], v[52:55], v[20:23]
    s_add_u32 m0, s40, 98304
    s_lshl_b32 s42, s57, 7
    s_mul_i32 s43, s57, 131072
    buffer_load_dwordx4 v80, s[12:15], s42 offen offset:0 lds
    buffer_load_dwordx4 v81, s[12:15], s42 offen offset:1024 lds
    s_add_u32 s57, s57, 1
    s_cmp_eq_u32 s57, 56
    s_cselect_b32 s57, 0, s57
    s_add_u32 m0, s41, 98304
    s_nop 0
    buffer_load_dwordx4 v82, s[8:11], s43 offen offset:0 lds
    s_waitcnt lgkmcnt(0)
    v_mfma_f32_16x16x32_bf16 v[8:11], v[24:27], v[40:43], v[8:11]
    ds_read_b128 v[48:51], v67 offset:0
    ds_read_b128 v[52:55], v67 offset:2048
    v_mfma_f32_16x16x32_bf16 v[16:19], v[24:27], v[44:47], v[16:19]
    ds_read_b64_tr_b16 v[32:33], v78 offset:4096
    ds_read_b64_tr_b16 v[34:35], v78 offset:4608
    v_mfma_f32_16x16x32_bf16 v[12:15], v[28:31], v[40:43], v[12:15]
    ds_read_b64_tr_b16 v[36:37], v79 offset:4096
    ds_read_b64_tr_b16 v[38:39], v79 offset:4608
    v_mfma_f32_16x16x32_bf16 v[20:23], v[28:31], v[44:47], v[20:23]
    s_waitcnt vmcnt(12) lgkmcnt(0)
    s_barrier
    v_mfma_f32_16x16x32_bf16 v[8:11], v[32:35], v[48:51], v[8:11]
    ds_read_b128 v[40:43], v56 offset:0
    ds_read_b128 v[44:47], v56 offset:2048
    v_mfma_f32_16x16x32_bf16 v[16:19], v[32:35], v[52:55], v[16:19]
    ds_read_b64_tr_b16 v[24:25], v68 offset:0
    ds_read_b64_tr_b16 v[26:27], v68 offset:512
    v_mfma_f32_16x16x32_bf16 v[12:15], v[36:39], v[48:51], v[12:15]
    ds_read_b64_tr_b16 v[28:29], v69 offset:0
    ds_read_b64_tr_b16 v[30:31], v69 offset:512
    v_mfma_f32_16x16x32_bf16 v[20:23], v[36:39], v[52:55], v[20:23]
    s_add_u32 m0, s40, 122880
    s_lshl_b32 s42, s57, 7
    s_mul_i32 s43, s57, 131072
    buffer_load_dwordx4 v80, s[12:15], s42 offen offset:0 lds
    buffer_load_dwordx4 v81, s[12:15], s42 offen offset:1024 lds
    s_add_u32 s57, s57, 1
    s_cmp_eq_u32 s57, 56
    s_cselect_b32 s57, 0, s57
    s_add_u32 m0, s41, 122880
    s_nop 0
    buffer_load_dwordx4 v82, s[8:11], s43 offen offset:0 lds
    s_waitcnt lgkmcnt(0)
    v_mfma_f32_16x16x32_bf16 v[8:11], v[24:27], v[40:43], v[8:11]
    ds_read_b128 v[48:51], v57 offset:0
    ds_read_b128 v[52:55], v57 offset:2048
    v_mfma_f32_16x16x32_bf16 v[16:19], v[24:27], v[44:47], v[16:19]
    ds_read_b64_tr_b16 v[32:33], v68 offset:4096
    ds_read_b64_tr_b16 v[34:35], v68 offset:4608
    v_mfma_f32_16x16x32_bf16 v[12:15], v[28:31], v[40:43], v[12:15]
    ds_read_b64_tr_b16 v[36:37], v69 offset:4096
    ds_read_b64_tr_b16 v[38:39], v69 offset:4608
    v_mfma_f32_16x16x32_bf16 v[20:23], v[28:31], v[44:47], v[20:23]
    s_waitcnt vmcnt(12) lgkmcnt(0)
    s_barrier
    v_mfma_f32_16x16x32_bf16 v[8:11], v[32:35], v[48:51], v[8:11]
    ds_read_b128 v[40:43], v58 offset:0
    ds_read_b128 v[44:47], v58 offset:2048
    v_mfma_f32_16x16x32_bf16 v[16:19], v[32:35], v[52:55], v[16:19]
    ds_read_b64_tr_b16 v[24:25], v70 offset:0
    ds_read_b64_tr_b16 v[26:27], v70 offset:512
    v_mfma_f32_16x16x32_bf16 v[12:15], v[36:39], v[48:51], v[12:15]
    ds_read_b64_tr_b16 v[28:29], v71 offset:0
    ds_read_b64_tr_b16 v[30:31], v71 offset:512
    v_mfma_f32_16x16x32_bf16 v[20:23], v[36:39], v[52:55], v[20:23]
    s_add_u32 m0, s40, 0
    s_lshl_b32 s42, s57, 7
    s_mul_i32 s43, s57, 131072
    buffer_load_dwordx4 v80, s[12:15], s42 offen offset:0 lds
    buffer_load_dwordx4 v81, s[12:15], s42 offen offset:1024 lds
    s_add_u32 s57, s57, 1
    s_cmp_eq_u32 s57, 56
    s_cselect_b32 s57, 0, s57
    s_add_u32 m0, s41, 0
    s_nop 0
    buffer_load_dwordx4 v82, s[8:11], s43 offen offset:0 lds
    s_waitcnt lgkmcnt(0)
    v_mfma_f32_16x16x32_bf16 v[8:11], v[24:27], v[40:43], v[8:11]
    ds_read_b128 v[48:51], v59 offset:0
    ds_read_b128 v[52:55], v59 offset:2048
    v_mfma_f32_16x16x32_bf16 v[16:19], v[24:27], v[44:47], v[16:19]
    ds_read_b64_tr_b16 v[32:33], v70 offset:4096
    ds_read_b64_tr_b16 v[34:35], v70 offset:4608
    v_mfma_f32_16x16x32_bf16 v[12:15], v[28:31], v[40:43], v[12:15]
    ds_read_b64_tr_b16 v[36:37], v71 offset:4096
    ds_read_b64_tr_b16 v[38:39], v71 offset:4608
    v_mfma_f32_16x16x32_bf16 v[20:23], v[28:31], v[44:47], v[20:23]
    s_waitcnt vmcnt(12) lgkmcnt(0)
    s_barrier
    v_mfma_f32_16x16x32_bf16 v[8:11], v[32:35], v[48:51], v[8:11]
    ds_read_b128 v[40:43], v60 offset:0
    ds_read_b128 v[44:47], v60 offset:2048
    v_mfma_f32_16x16x32_bf16 v[16:19], v[32:35], v[52:55], v[16:19]
    ds_read_b64_tr_b16 v[24:25], v72 offset:0
    ds_read_b64_tr_b16 v[26:27], v72 offset:512
    v_mfma_f32_16x16x32_bf16 v[12:15], v[36:39], v[48:51], v[12:15]
    ds_read_b64_tr_b16 v[28:29], v73 offset:0
    ds_read_b64_tr_b16 v[30:31], v73 offset:512
    v_mfma_f32_16x16x32_bf16 v[20:23], v[36:39], v[52:55], v[20:23]
    s_add_u32 m0, s40, 24576
    s_lshl_b32 s42, s57, 7
    s_mul_i32 s43, s57, 131072
    buffer_load_dwordx4 v80, s[12:15], s42 offen offset:0 lds
    buffer_load_dwordx4 v81, s[12:15], s42 offen offset:1024 lds
    s_add_u32 s57, s57, 1
    s_cmp_eq_u32 s57, 56
    s_cselect_b32 s57, 0, s57
    s_add_u32 m0, s41, 24576
    s_nop 0
    buffer_load_dwordx4 v82, s[8:11], s43 offen offset:0 lds
    s_waitcnt lgkmcnt(0)
    v_mfma_f32_16x16x32_bf16 v[8:11], v[24:27], v[40:43], v[8:11]
    ds_read_b128 v[48:51], v61 offset:0
    ds_read_b128 v[52:55], v61 offset:2048
    v_mfma_f32_16x16x32_bf16 v[16:19], v[24:27], v[44:47], v[16:19]
    ds_read_b64_tr_b16 v[32:33], v72 offset:4096
    ds_read_b64_tr_b16 v[34:35], v72 offset:4608
    v_mfma_f32_16x16x32_bf16 v[12:15], v[28:31], v[40:43], v[12:15]
    ds_read_b64_tr_b16 v[36:37], v73 offset:4096
    ds_read_b64_tr_b16 v[38:39], v73 offset:4608
    v_mfma_f32_16x16x32_bf16 v[20:23], v[28:31], v[44:47], v[20:23]
    s_waitcnt vmcnt(12) lgkmcnt(0)
    s_barrier
    v_mfma_f32_16x16x32_bf16 v[8:11], v[32:35], v[48:51], v[8:11]
    ds_read_b128 v[40:43], v62 offset:0
    ds_read_b128 v[44:47], v62 offset:2048
    v_mfma_f32_16x16x32_bf16 v[16:19], v[32:35], v[52:55], v[16:19]
    ds_read_b64_tr_b16 v[24:25], v74 offset:0
    ds_read_b64_tr_b16 v[26:27], v74 offset:512
    v_mfma_f32_16x16x32_bf16 v[12:15], v[36:39], v[48:51], v[12:15]
    ds_read_b64_tr_b16 v[28:29], v75 offset:0
    ds_read_b64_tr_b16 v[30:31], v75 offset:512
    v_mfma_f32_16x16x32_bf16 v[20:23], v[36:39], v[52:55], v[20:23]
    s_add_u32 m0, s40, 49152
    s_lshl_b32 s42, s57, 7
    s_mul_i32 s43, s57, 131072
    buffer_load_dwordx4 v80, s[12:15], s42 offen offset:0 lds
    buffer_load_dwordx4 v81, s[12:15], s42 offen offset:1024 lds
    s_add_u32 s57, s57, 1
    s_cmp_eq_u32 s57, 56
    s_cselect_b32 s57, 0, s57
    s_add_u32 m0, s41, 49152
    s_nop 0
    buffer_load_dwordx4 v82, s[8:11], s43 offen offset:0 lds
    s_waitcnt lgkmcnt(0)
    v_mfma_f32_16x16x32_bf16 v[8:11], v[24:27], v[40:43], v[8:11]
    ds_read_b128 v[48:51], v63 offset:0
    ds_read_b128 v[52:55], v63 offset:2048
    v_mfma_f32_16x16x32_bf16 v[16:19], v[24:27], v[44:47], v[16:19]
    ds_read_b64_tr_b16 v[32:33], v74 offset:4096
    ds_read_b64_tr_b16 v[34:35], v74 offset:4608
    v_mfma_f32_16x16x32_bf16 v[12:15], v[28:31], v[40:43], v[12:15]
    ds_read_b64_tr_b16 v[36:37], v75 offset:4096
    ds_read_b64_tr_b16 v[38:39], v75 offset:4608
    v_mfma_f32_16x16x32_bf16 v[20:23], v[28:31], v[44:47], v[20:23]
    s_waitcnt vmcnt(12) lgkmcnt(0)
    s_barrier
    v_mfma_f32_16x16x32_bf16 v[8:11], v[32:35], v[48:51], v[8:11]
    ds_read_b128 v[40:43], v64 offset:0
    ds_read_b128 v[44:47], v64 offset:2048
    v_mfma_f32_16x16x32_bf16 v[16:19], v[32:35], v[52:55], v[16:19]
    ds_read_b64_tr_b16 v[24:25], v76 offset:0
    ds_read_b64_tr_b16 v[26:27], v76 offset:512
    v_mfma_f32_16x16x32_bf16 v[12:15], v[36:39], v[48:51], v[12:15]
    ds_read_b64_tr_b16 v[28:29], v77 offset:0
    ds_read_b64_tr_b16 v[30:31], v77 offset:512
    v_mfma_f32_16x16x32_bf16 v[20:23], v[36:39], v[52:55], v[20:23]
    s_add_u32 m0, s40, 73728
    s_lshl_b32 s42, s57, 7
    s_mul_i32 s43, s57, 131072
    buffer_load_dwordx4 v80, s[12:15], s42 offen offset:0 lds
    buffer_load_dwordx4 v81, s[12:15], s42 offen offset:1024 lds
    s_add_u32 s57, s57, 1
    s_cmp_eq_u32 s57, 56
    s_cselect_b32 s57, 0, s57
    s_add_u32 m0, s41, 73728
    s_nop 0
    buffer_load_dwordx4 v82, s[8:11], s43 offen offset:0 lds
    s_waitcnt lgkmcnt(0)
    v_mfma_f32_16x16x32_bf16 v[8:11], v[24:27], v[40:43], v[8:11]
    ds_read_b128 v[48:51], v65 offset:0
    ds_read_b128 v[52:55], v65 offset:2048
    v_mfma_f32_16x16x32_bf16 v[16:19], v[24:27], v[44:47], v[16:19]
    ds_read_b64_tr_b16 v[32:33], v76 offset:4096
    ds_read_b64_tr_b16 v[34:35], v76 offset:4608
    v_mfma_f32_16x16x32_bf16 v[12:15], v[28:31], v[40:43], v[12:15]
    ds_read_b64_tr_b16 v[36:37], v77 offset:4096
    ds_read_b64_tr_b16 v[38:39], v77 offset:4608
    v_mfma_f32_16x16x32_bf16 v[20:23], v[28:31], v[44:47], v[20:23]
    s_waitcnt vmcnt(12) lgkmcnt(0)
    s_barrier
    v_mfma_f32_16x16x32_bf16 v[8:11], v[32:35], v[48:51], v[8:11]
    ds_read_b128 v[40:43], v66 offset:0
    ds_read_b128 v[44:47], v66 offset:2048
    v_mfma_f32_16x16x32_bf16 v[16:19], v[32:35], v[52:55], v[16:19]
    ds_read_b64_tr_b16 v[24:25], v78 offset:0
    ds_read_b64_tr_b16 v[26:27], v78 offset:512
    v_mfma_f32_16x16x32_bf16 v[12:15], v[36:39], v[48:51], v[12:15]
    ds_read_b64_tr_b16 v[28:29], v79 offset:0
    ds_read_b64_tr_b16 v[30:31], v79 offset:512
    v_mfma_f32_16x16x32_bf16 v[20:23], v[36:39], v[52:55], v[20:23]
    s_add_u32 m0, s40, 98304
    s_lshl_b32 s42, s57, 7
    s_mul_i32 s43, s57, 131072
    buffer_load_dwordx4 v80, s[12:15], s42 offen offset:0 lds
    buffer_load_dwordx4 v81, s[12:15], s42 offen offset:1024 lds
    s_add_u32 s57, s57, 1
    s_cmp_eq_u32 s57, 56
    s_cselect_b32 s57, 0, s57
    s_add_u32 m0, s41, 98304
    s_nop 0
    buffer_load_dwordx4 v82, s[8:11], s43 offen offset:0 lds
    s_waitcnt lgkmcnt(0)
    v_mfma_f32_16x16x32_bf16 v[8:11], v[24:27], v[40:43], v[8:11]
    ds_read_b128 v[48:51], v67 offset:0
    ds_read_b128 v[52:55], v67 offset:2048
    v_mfma_f32_16x16x32_bf16 v[16:19], v[24:27], v[44:47], v[16:19]
    ds_read_b64_tr_b16 v[32:33], v78 offset:4096
    ds_read_b64_tr_b16 v[34:35], v78 offset:4608
    v_mfma_f32_16x16x32_bf16 v[12:15], v[28:31], v[40:43], v[12:15]
    ds_read_b64_tr_b16 v[36:37], v79 offset:4096
    ds_read_b64_tr_b16 v[38:39], v79 offset:4608
    v_mfma_f32_16x16x32_bf16 v[20:23], v[28:31], v[44:47], v[20:23]
    s_waitcnt vmcnt(12) lgkmcnt(0)
    s_barrier
    v_mfma_f32_16x16x32_bf16 v[8:11], v[32:35], v[48:51], v[8:11]
    ds_read_b128 v[40:43], v56 offset:0
    ds_read_b128 v[44:47], v56 offset:2048
    v_mfma_f32_16x16x32_bf16 v[16:19], v[32:35], v[52:55], v[16:19]
    ds_read_b64_tr_b16 v[24:25], v68 offset:0
    ds_read_b64_tr_b16 v[26:27], v68 offset:512
    v_mfma_f32_16x16x32_bf16 v[12:15], v[36:39], v[48:51], v[12:15]
    ds_read_b64_tr_b16 v[28:29], v69 offset:0
    ds_read_b64_tr_b16 v[30:31], v69 offset:512
    v_mfma_f32_16x16x32_bf16 v[20:23], v[36:39], v[52:55], v[20:23]
    s_add_u32 m0, s40, 122880
    s_lshl_b32 s42, s57, 7
    s_mul_i32 s43, s57, 131072
    buffer_load_dwordx4 v80, s[12:15], s42 offen offset:0 lds
    buffer_load_dwordx4 v81, s[12:15], s42 offen offset:1024 lds
    s_add_u32 s57, s57, 1
    s_cmp_eq_u32 s57, 56
    s_cselect_b32 s57, 0, s57
    s_add_u32 m0, s41, 122880
    s_nop 0
    buffer_load_dwordx4 v82, s[8:11], s43 offen offset:0 lds
    s_waitcnt lgkmcnt(0)
    v_mfma_f32_16x16x32_bf16 v[8:11], v[24:27], v[40:43], v[8:11]
    ds_read_b128 v[48:51], v57 offset:0
    ds_read_b128 v[52:55], v57 offset:2048
    v_mfma_f32_16x16x32_bf16 v[16:19], v[24:27], v[44:47], v[16:19]
    ds_read_b64_tr_b16 v[32:33], v68 offset:4096
    ds_read_b64_tr_b16 v[34:35], v68 offset:4608
    v_mfma_f32_16x16x32_bf16 v[12:15], v[28:31], v[40:43], v[12:15]
    ds_read_b64_tr_b16 v[36:37], v69 offset:4096
    ds_read_b64_tr_b16 v[38:39], v69 offset:4608
    v_mfma_f32_16x16x32_bf16 v[20:23], v[28:31], v[44:47], v[20:23]
    s_waitcnt vmcnt(12) lgkmcnt(0)
    s_barrier
    v_mfma_f32_16x16x32_bf16 v[8:11], v[32:35], v[48:51], v[8:11]
    ds_read_b128 v[40:43], v58 offset:0
    ds_read_b128 v[44:47], v58 offset:2048
    v_mfma_f32_16x16x32_bf16 v[16:19], v[32:35], v[52:55], v[16:19]
    ds_read_b64_tr_b16 v[24:25], v70 offset:0
    ds_read_b64_tr_b16 v[26:27], v70 offset:512
    v_mfma_f32_16x16x32_bf16 v[12:15], v[36:39], v[48:51], v[12:15]
    ds_read_b64_tr_b16 v[28:29], v71 offset:0
    ds_read_b64_tr_b16 v[30:31], v71 offset:512
    v_mfma_f32_16x16x32_bf16 v[20:23], v[36:39], v[52:55], v[20:23]
    s_add_u32 m0, s40, 0
    s_lshl_b32 s42, s57, 7
    s_mul_i32 s43, s57, 131072
    buffer_load_dwordx4 v80, s[12:15], s42 offen offset:0 lds
    buffer_load_dwordx4 v81, s[12:15], s42 offen offset:1024 lds
    s_add_u32 s57, s57, 1
    s_cmp_eq_u32 s57, 56
    s_cselect_b32 s57, 0, s57
    s_add_u32 m0, s41, 0
    s_nop 0
    buffer_load_dwordx4 v82, s[8:11], s43 offen offset:0 lds
    s_waitcnt lgkmcnt(0)
    v_mfma_f32_16x16x32_bf16 v[8:11], v[24:27], v[40:43], v[8:11]
    ds_read_b128 v[48:51], v59 offset:0
    ds_read_b128 v[52:55], v59 offset:2048
    v_mfma_f32_16x16x32_bf16 v[16:19], v[24:27], v[44:47], v[16:19]
    ds_read_b64_tr_b16 v[32:33], v70 offset:4096
    ds_read_b64_tr_b16 v[34:35], v70 offset:4608
    v_mfma_f32_16x16x32_bf16 v[12:15], v[28:31], v[40:43], v[12:15]
    ds_read_b64_tr_b16 v[36:37], v71 offset:4096
    ds_read_b64_tr_b16 v[38:39], v71 offset:4608
    v_mfma_f32_16x16x32_bf16 v[20:23], v[28:31], v[44:47], v[20:23]
    s_waitcnt vmcnt(12) lgkmcnt(0)
    s_barrier
    v_mfma_f32_16x16x32_bf16 v[8:11], v[32:35], v[48:51], v[8:11]
    ds_read_b128 v[40:43], v60 offset:0
    ds_read_b128 v[44:47], v60 offset:2048
    v_mfma_f32_16x16x32_bf16 v[16:19], v[32:35], v[52:55], v[16:19]
    ds_read_b64_tr_b16 v[24:25], v72 offset:0
    ds_read_b64_tr_b16 v[26:27], v72 offset:512
    v_mfma_f32_16x16x32_bf16 v[12:15], v[36:39], v[48:51], v[12:15]
    ds_read_b64_tr_b16 v[28:29], v73 offset:0
    ds_read_b64_tr_b16 v[30:31], v73 offset:512
    v_mfma_f32_16x16x32_bf16 v[20:23], v[36:39], v[52:55], v[20:23]
    s_add_u32 m0, s40, 24576
    s_lshl_b32 s42, s57, 7
    s_mul_i32 s43, s57, 131072
    buffer_load_dwordx4 v80, s[12:15], s42 offen offset:0 lds
    buffer_load_dwordx4 v81, s[12:15], s42 offen offset:1024 lds
    s_add_u32 s57, s57, 1
    s_cmp_eq_u32 s57, 56
    s_cselect_b32 s57, 0, s57
    s_add_u32 m0, s41, 24576
    s_nop 0
    buffer_load_dwordx4 v82, s[8:11], s43 offen offset:0 lds
    s_waitcnt lgkmcnt(0)
    v_mfma_f32_16x16x32_bf16 v[8:11], v[24:27], v[40:43], v[8:11]
    ds_read_b128 v[48:51], v61 offset:0
    ds_read_b128 v[52:55], v61 offset:2048
    v_mfma_f32_16x16x32_bf16 v[16:19], v[24:27], v[44:47], v[16:19]
    ds_read_b64_tr_b16 v[32:33], v72 offset:4096
    ds_read_b64_tr_b16 v[34:35], v72 offset:4608
    v_mfma_f32_16x16x32_bf16 v[12:15], v[28:31], v[40:43], v[12:15]
    ds_read_b64_tr_b16 v[36:37], v73 offset:4096
    ds_read_b64_tr_b16 v[38:39], v73 offset:4608
    v_mfma_f32_16x16x32_bf16 v[20:23], v[28:31], v[44:47], v[20:23]
    s_waitcnt vmcnt(12) lgkmcnt(0)
    s_barrier
    v_mfma_f32_16x16x32_bf16 v[8:11], v[32:35], v[48:51], v[8:11]
    ds_read_b128 v[40:43], v62 offset:0
    ds_read_b128 v[44:47], v62 offset:2048
    v_mfma_f32_16x16x32_bf16 v[16:19], v[32:35], v[52:55], v[16:19]
    ds_read_b64_tr_b16 v[24:25], v74 offset:0
    ds_read_b64_tr_b16 v[26:27], v74 offset:512
    v_mfma_f32_16x16x32_bf16 v[12:15], v[36:39], v[48:51], v[12:15]
    ds_read_b64_tr_b16 v[28:29], v75 offset:0
    ds_read_b64_tr_b16 v[30:31], v75 offset:512
    v_mfma_f32_16x16x32_bf16 v[20:23], v[36:39], v[52:55], v[20:23]
    s_add_u32 m0, s40, 49152
    s_lshl_b32 s42, s57, 7
    s_mul_i32 s43, s57, 131072
    buffer_load_dwordx4 v80, s[12:15], s42 offen offset:0 lds
    buffer_load_dwordx4 v81, s[12:15], s42 offen offset:1024 lds
    s_add_u32 s57, s57, 1
    s_cmp_eq_u32 s57, 56
    s_cselect_b32 s57, 0, s57
    s_add_u32 m0, s41, 49152
    s_nop 0
    buffer_load_dwordx4 v82, s[8:11], s43 offen offset:0 lds
    s_waitcnt lgkmcnt(0)
    v_mfma_f32_16x16x32_bf16 v[8:11], v[24:27], v[40:43], v[8:11]
    ds_read_b128 v[48:51], v63 offset:0
    ds_read_b128 v[52:55], v63 offset:2048
    v_mfma_f32_16x16x32_bf16 v[16:19], v[24:27], v[44:47], v[16:19]
    ds_read_b64_tr_b16 v[32:33], v74 offset:4096
    ds_read_b64_tr_b16 v[34:35], v74 offset:4608
    v_mfma_f32_16x16x32_bf16 v[12:15], v[28:31], v[40:43], v[12:15]
    ds_read_b64_tr_b16 v[36:37], v75 offset:4096
    ds_read_b64_tr_b16 v[38:39], v75 offset:4608
    v_mfma_f32_16x16x32_bf16 v[20:23], v[28:31], v[44:47], v[20:23]
    s_waitcnt vmcnt(12) lgkmcnt(0)
    s_barrier
    v_mfma_f32_16x16x32_bf16 v[8:11], v[32:35], v[48:51], v[8:11]
    ds_read_b128 v[40:43], v64 offset:0
    ds_read_b128 v[44:47], v64 offset:2048
    v_mfma_f32_16x16x32_bf16 v[16:19], v[32:35], v[52:55], v[16:19]
    ds_read_b64_tr_b16 v[24:25], v76 offset:0
    ds_read_b64_tr_b16 v[26:27], v76 offset:512
    v_mfma_f32_16x16x32_bf16 v[12:15], v[36:39], v[48:51], v[12:15]
    ds_read_b64_tr_b16 v[28:29], v77 offset:0
    ds_read_b64_tr_b16 v[30:31], v77 offset:512
    v_mfma_f32_16x16x32_bf16 v[20:23], v[36:39], v[52:55], v[20:23]
    s_add_u32 m0, s40, 73728
    s_lshl_b32 s42, s57, 7
    s_mul_i32 s43, s57, 131072
    buffer_load_dwordx4 v80, s[12:15], s42 offen offset:0 lds
    buffer_load_dwordx4 v81, s[12:15], s42 offen offset:1024 lds
    s_add_u32 s57, s57, 1
    s_cmp_eq_u32 s57, 56
    s_cselect_b32 s57, 0, s57
    s_add_u32 m0, s41, 73728
    s_nop 0
    buffer_load_dwordx4 v82, s[8:11], s43 offen offset:0 lds
    s_waitcnt lgkmcnt(0)
    v_mfma_f32_16x16x32_bf16 v[8:11], v[24:27], v[40:43], v[8:11]
    ds_read_b128 v[48:51], v65 offset:0
    ds_read_b128 v[52:55], v65 offset:2048
    v_mfma_f32_16x16x32_bf16 v[16:19], v[24:27], v[44:47], v[16:19]
    ds_read_b64_tr_b16 v[32:33], v76 offset:4096
    ds_read_b64_tr_b16 v[34:35], v76 offset:4608
    v_mfma_f32_16x16x32_bf16 v[12:15], v[28:31], v[40:43], v[12:15]
    ds_read_b64_tr_b16 v[36:37], v77 offset:4096
    ds_read_b64_tr_b16 v[38:39], v77 offset:4608
    v_mfma_f32_16x16x32_bf16 v[20:23], v[28:31], v[44:47], v[20:23]
    s_waitcnt vmcnt(12) lgkmcnt(0)
    s_barrier
    v_mfma_f32_16x16x32_bf16 v[8:11], v[32:35], v[48:51], v[8:11]
    ds_read_b128 v[40:43], v66 offset:0
    ds_read_b128 v[44:47], v66 offset:2048
    v_mfma_f32_16x16x32_bf16 v[16:19], v[32:35], v[52:55], v[16:19]
    ds_read_b64_tr_b16 v[24:25], v78 offset:0
    ds_read_b64_tr_b16 v[26:27], v78 offset:512
    v_mfma_f32_16x16x32_bf16 v[12:15], v[36:39], v[48:51], v[12:15]
    ds_read_b64_tr_b16 v[28:29], v79 offset:0
    ds_read_b64_tr_b16 v[30:31], v79 offset:512
    v_mfma_f32_16x16x32_bf16 v[20:23], v[36:39], v[52:55], v[20:23]
    s_add_u32 m0, s40, 98304
    s_lshl_b32 s42, s57, 7
    s_mul_i32 s43, s57, 131072
    buffer_load_dwordx4 v80, s[12:15], s42 offen offset:0 lds
    buffer_load_dwordx4 v81, s[12:15], s42 offen offset:1024 lds
    s_add_u32 s57, s57, 1
    s_cmp_eq_u32 s57, 56
    s_cselect_b32 s57, 0, s57
    s_add_u32 m0, s41, 98304
    s_nop 0
    buffer_load_dwordx4 v82, s[8:11], s43 offen offset:0 lds
    s_waitcnt lgkmcnt(0)
    v_mfma_f32_16x16x32_bf16 v[8:11], v[24:27], v[40:43], v[8:11]
    ds_read_b128 v[48:51], v67 offset:0
    ds_read_b128 v[52:55], v67 offset:2048
    v_mfma_f32_16x16x32_bf16 v[16:19], v[24:27], v[44:47], v[16:19]
    ds_read_b64_tr_b16 v[32:33], v78 offset:4096
    ds_read_b64_tr_b16 v[34:35], v78 offset:4608
    v_mfma_f32_16x16x32_bf16 v[12:15], v[28:31], v[40:43], v[12:15]
    ds_read_b64_tr_b16 v[36:37], v79 offset:4096
    ds_read_b64_tr_b16 v[38:39], v79 offset:4608
    v_mfma_f32_16x16x32_bf16 v[20:23], v[28:31], v[44:47], v[20:23]
    s_waitcnt vmcnt(12) lgkmcnt(0)
    s_barrier
    v_mfma_f32_16x16x32_bf16 v[8:11], v[32:35], v[48:51], v[8:11]
    ds_read_b128 v[40:43], v56 offset:0
    ds_read_b128 v[44:47], v56 offset:2048
    v_mfma_f32_16x16x32_bf16 v[16:19], v[32:35], v[52:55], v[16:19]
    ds_read_b64_tr_b16 v[24:25], v68 offset:0
    ds_read_b64_tr_b16 v[26:27], v68 offset:512
    v_mfma_f32_16x16x32_bf16 v[12:15], v[36:39], v[48:51], v[12:15]
    ds_read_b64_tr_b16 v[28:29], v69 offset:0
    ds_read_b64_tr_b16 v[30:31], v69 offset:512
    v_mfma_f32_16x16x32_bf16 v[20:23], v[36:39], v[52:55], v[20:23]
    s_add_u32 m0, s40, 122880
    s_lshl_b32 s42, s57, 7
    s_mul_i32 s43, s57, 131072
    buffer_load_dwordx4 v80, s[12:15], s42 offen offset:0 lds
    buffer_load_dwordx4 v81, s[12:15], s42 offen offset:1024 lds
    s_add_u32 s57, s57, 1
    s_cmp_eq_u32 s57, 56
    s_cselect_b32 s57, 0, s57
    s_add_u32 m0, s41, 122880
    s_nop 0
    buffer_load_dwordx4 v82, s[8:11], s43 offen offset:0 lds
    s_waitcnt lgkmcnt(0)
    v_mfma_f32_16x16x32_bf16 v[8:11], v[24:27], v[40:43], v[8:11]
    ds_read_b128 v[48:51], v57 offset:0
    ds_read_b128 v[52:55], v57 offset:2048
    v_mfma_f32_16x16x32_bf16 v[16:19], v[24:27], v[44:47], v[16:19]
    ds_read_b64_tr_b16 v[32:33], v68 offset:4096
    ds_read_b64_tr_b16 v[34:35], v68 offset:4608
    v_mfma_f32_16x16x32_bf16 v[12:15], v[28:31], v[40:43], v[12:15]
    ds_read_b64_tr_b16 v[36:37], v69 offset:4096
    ds_read_b64_tr_b16 v[38:39], v69 offset:4608
    v_mfma_f32_16x16x32_bf16 v[20:23], v[28:31], v[44:47], v[20:23]
    s_waitcnt vmcnt(12) lgkmcnt(0)
    s_barrier
    v_mfma_f32_16x16x32_bf16 v[8:11], v[32:35], v[48:51], v[8:11]
    ds_read_b128 v[40:43], v58 offset:0
    ds_read_b128 v[44:47], v58 offset:2048
    v_mfma_f32_16x16x32_bf16 v[16:19], v[32:35], v[52:55], v[16:19]
    ds_read_b64_tr_b16 v[24:25], v70 offset:0
    ds_read_b64_tr_b16 v[26:27], v70 offset:512
    v_mfma_f32_16x16x32_bf16 v[12:15], v[36:39], v[48:51], v[12:15]
    ds_read_b64_tr_b16 v[28:29], v71 offset:0
    ds_read_b64_tr_b16 v[30:31], v71 offset:512
    v_mfma_f32_16x16x32_bf16 v[20:23], v[36:39], v[52:55], v[20:23]
    s_add_u32 m0, s40, 0
    s_lshl_b32 s42, s57, 7
    s_mul_i32 s43, s57, 131072
    buffer_load_dwordx4 v80, s[12:15], s42 offen offset:0 lds
    buffer_load_dwordx4 v81, s[12:15], s42 offen offset:1024 lds
    s_add_u32 s57, s57, 1
    s_cmp_eq_u32 s57, 56
    s_cselect_b32 s57, 0, s57
    s_add_u32 m0, s41, 0
    s_nop 0
    buffer_load_dwordx4 v82, s[8:11], s43 offen offset:0 lds
    s_waitcnt lgkmcnt(0)
    v_mfma_f32_16x16x32_bf16 v[8:11], v[24:27], v[40:43], v[8:11]
    ds_read_b128 v[48:51], v59 offset:0
    ds_read_b128 v[52:55], v59 offset:2048
    v_mfma_f32_16x16x32_bf16 v[16:19], v[24:27], v[44:47], v[16:19]
    ds_read_b64_tr_b16 v[32:33], v70 offset:4096
    ds_read_b64_tr_b16 v[34:35], v70 offset:4608
    v_mfma_f32_16x16x32_bf16 v[12:15], v[28:31], v[40:43], v[12:15]
    ds_read_b64_tr_b16 v[36:37], v71 offset:4096
    ds_read_b64_tr_b16 v[38:39], v71 offset:4608
    v_mfma_f32_16x16x32_bf16 v[20:23], v[28:31], v[44:47], v[20:23]
    s_waitcnt vmcnt(12) lgkmcnt(0)
    s_barrier
    v_mfma_f32_16x16x32_bf16 v[8:11], v[32:35], v[48:51], v[8:11]
    ds_read_b128 v[40:43], v60 offset:0
    ds_read_b128 v[44:47], v60 offset:2048
    v_mfma_f32_16x16x32_bf16 v[16:19], v[32:35], v[52:55], v[16:19]
    ds_read_b64_tr_b16 v[24:25], v72 offset:0
    ds_read_b64_tr_b16 v[26:27], v72 offset:512
    v_mfma_f32_16x16x32_bf16 v[12:15], v[36:39], v[48:51], v[12:15]
    ds_read_b64_tr_b16 v[28:29], v73 offset:0
    ds_read_b64_tr_b16 v[30:31], v73 offset:512
    v_mfma_f32_16x16x32_bf16 v[20:23], v[36:39], v[52:55], v[20:23]
    s_add_u32 m0, s40, 24576
    s_lshl_b32 s42, s57, 7
    s_mul_i32 s43, s57, 131072
    buffer_load_dwordx4 v80, s[12:15], s42 offen offset:0 lds
    buffer_load_dwordx4 v81, s[12:15], s42 offen offset:1024 lds
    s_add_u32 s57, s57, 1
    s_cmp_eq_u32 s57, 56
    s_cselect_b32 s57, 0, s57
    s_add_u32 m0, s41, 24576
    s_nop 0
    buffer_load_dwordx4 v82, s[8:11], s43 offen offset:0 lds
    s_waitcnt lgkmcnt(0)
    v_mfma_f32_16x16x32_bf16 v[8:11], v[24:27], v[40:43], v[8:11]
    ds_read_b128 v[48:51], v61 offset:0
    ds_read_b128 v[52:55], v61 offset:2048
    v_mfma_f32_16x16x32_bf16 v[16:19], v[24:27], v[44:47], v[16:19]
    ds_read_b64_tr_b16 v[32:33], v72 offset:4096
    ds_read_b64_tr_b16 v[34:35], v72 offset:4608
    v_mfma_f32_16x16x32_bf16 v[12:15], v[28:31], v[40:43], v[12:15]
    ds_read_b64_tr_b16 v[36:37], v73 offset:4096
    ds_read_b64_tr_b16 v[38:39], v73 offset:4608
    v_mfma_f32_16x16x32_bf16 v[20:23], v[28:31], v[44:47], v[20:23]
    s_waitcnt vmcnt(12) lgkmcnt(0)
    s_barrier
    v_mfma_f32_16x16x32_bf16 v[8:11], v[32:35], v[48:51], v[8:11]
    ds_read_b128 v[40:43], v62 offset:0
    ds_read_b128 v[44:47], v62 offset:2048
    v_mfma_f32_16x16x32_bf16 v[16:19], v[32:35], v[52:55], v[16:19]
    ds_read_b64_tr_b16 v[24:25], v74 offset:0
    ds_read_b64_tr_b16 v[26:27], v74 offset:512
    v_mfma_f32_16x16x32_bf16 v[12:15], v[36:39], v[48:51], v[12:15]
    ds_read_b64_tr_b16 v[28:29], v75 offset:0
    ds_read_b64_tr_b16 v[30:31], v75 offset:512
    v_mfma_f32_16x16x32_bf16 v[20:23], v[36:39], v[52:55], v[20:23]
    s_add_u32 m0, s40, 49152
    s_lshl_b32 s42, s57, 7
    s_mul_i32 s43, s57, 131072
    buffer_load_dwordx4 v80, s[12:15], s42 offen offset:0 lds
    buffer_load_dwordx4 v81, s[12:15], s42 offen offset:1024 lds
    s_add_u32 s57, s57, 1
    s_cmp_eq_u32 s57, 56
    s_cselect_b32 s57, 0, s57
    s_add_u32 m0, s41, 49152
    s_nop 0
    buffer_load_dwordx4 v82, s[8:11], s43 offen offset:0 lds
    s_waitcnt lgkmcnt(0)
    v_mfma_f32_16x16x32_bf16 v[8:11], v[24:27], v[40:43], v[8:11]
    ds_read_b128 v[48:51], v63 offset:0
    ds_read_b128 v[52:55], v63 offset:2048
    v_mfma_f32_16x16x32_bf16 v[16:19], v[24:27], v[44:47], v[16:19]
    ds_read_b64_tr_b16 v[32:33], v74 offset:4096
    ds_read_b64_tr_b16 v[34:35], v74 offset:4608
    v_mfma_f32_16x16x32_bf16 v[12:15], v[28:31], v[40:43], v[12:15]
    ds_read_b64_tr_b16 v[36:37], v75 offset:4096
    ds_read_b64_tr_b16 v[38:39], v75 offset:4608
    v_mfma_f32_16x16x32_bf16 v[20:23], v[28:31], v[44:47], v[20:23]
    s_waitcnt vmcnt(12) lgkmcnt(0)
    s_barrier
    v_mfma_f32_16x16x32_bf16 v[8:11], v[32:35], v[48:51], v[8:11]
    ds_read_b128 v[40:43], v64 offset:0
    ds_read_b128 v[44:47], v64 offset:2048
    v_mfma_f32_16x16x32_bf16 v[16:19], v[32:35], v[52:55], v[16:19]
    ds_read_b64_tr_b16 v[24:25], v76 offset:0
    ds_read_b64_tr_b16 v[26:27], v76 offset:512
    v_mfma_f32_16x16x32_bf16 v[12:15], v[36:39], v[48:51], v[12:15]
    ds_read_b64_tr_b16 v[28:29], v77 offset:0
    ds_read_b64_tr_b16 v[30:31], v77 offset:512
    v_mfma_f32_16x16x32_bf16 v[20:23], v[36:39], v[52:55], v[20:23]
    s_add_u32 m0, s40, 73728
    s_lshl_b32 s42, s57, 7
    s_mul_i32 s43, s57, 131072
    buffer_load_dwordx4 v80, s[12:15], s42 offen offset:0 lds
    buffer_load_dwordx4 v81, s[12:15], s42 offen offset:1024 lds
    s_add_u32 s57, s57, 1
    s_cmp_eq_u32 s57, 56
    s_cselect_b32 s57, 0, s57
    s_add_u32 m0, s41, 73728
    s_nop 0
    buffer_load_dwordx4 v82, s[8:11], s43 offen offset:0 lds
    s_waitcnt lgkmcnt(0)
    v_mfma_f32_16x16x32_bf16 v[8:11], v[24:27], v[40:43], v[8:11]
    ds_read_b128 v[48:51], v65 offset:0
    ds_read_b128 v[52:55], v65 offset:2048
    v_mfma_f32_16x16x32_bf16 v[16:19], v[24:27], v[44:47], v[16:19]
    ds_read_b64_tr_b16 v[32:33], v76 offset:4096
    ds_read_b64_tr_b16 v[34:35], v76 offset:4608
    v_mfma_f32_16x16x32_bf16 v[12:15], v[28:31], v[40:43], v[12:15]
    ds_read_b64_tr_b16 v[36:37], v77 offset:4096
    ds_read_b64_tr_b16 v[38:39], v77 offset:4608
    v_mfma_f32_16x16x32_bf16 v[20:23], v[28:31], v[44:47], v[20:23]
    s_waitcnt vmcnt(12) lgkmcnt(0)
    s_barrier
    v_mfma_f32_16x16x32_bf16 v[8:11], v[32:35], v[48:51], v[8:11]
    ds_read_b128 v[40:43], v66 offset:0
    ds_read_b128 v[44:47], v66 offset:2048
    v_mfma_f32_16x16x32_bf16 v[16:19], v[32:35], v[52:55], v[16:19]
    ds_read_b64_tr_b16 v[24:25], v78 offset:0
    ds_read_b64_tr_b16 v[26:27], v78 offset:512
    v_mfma_f32_16x16x32_bf16 v[12:15], v[36:39], v[48:51], v[12:15]
    ds_read_b64_tr_b16 v[28:29], v79 offset:0
    ds_read_b64_tr_b16 v[30:31], v79 offset:512
    v_mfma_f32_16x16x32_bf16 v[20:23], v[36:39], v[52:55], v[20:23]
    s_add_u32 m0, s40, 98304
    s_lshl_b32 s42, s57, 7
    s_mul_i32 s43, s57, 131072
    buffer_load_dwordx4 v80, s[12:15], s42 offen offset:0 lds
    buffer_load_dwordx4 v81, s[12:15], s42 offen offset:1024 lds
    s_add_u32 s57, s57, 1
    s_cmp_eq_u32 s57, 56
    s_cselect_b32 s57, 0, s57
    s_add_u32 m0, s41, 98304
    s_nop 0
    buffer_load_dwordx4 v82, s[8:11], s43 offen offset:0 lds
    s_waitcnt lgkmcnt(0)
    v_mfma_f32_16x16x32_bf16 v[8:11], v[24:27], v[40:43], v[8:11]
    ds_read_b128 v[48:51], v67 offset:0
    ds_read_b128 v[52:55], v67 offset:2048
    v_mfma_f32_16x16x32_bf16 v[16:19], v[24:27], v[44:47], v[16:19]
    ds_read_b64_tr_b16 v[32:33], v78 offset:4096
    ds_read_b64_tr_b16 v[34:35], v78 offset:4608
    v_mfma_f32_16x16x32_bf16 v[12:15], v[28:31], v[40:43], v[12:15]
    ds_read_b64_tr_b16 v[36:37], v79 offset:4096
    ds_read_b64_tr_b16 v[38:39], v79 offset:4608
    v_mfma_f32_16x16x32_bf16 v[20:23], v[28:31], v[44:47], v[20:23]
    s_waitcnt vmcnt(12) lgkmcnt(0)
    s_barrier
    v_mfma_f32_16x16x32_bf16 v[8:11], v[32:35], v[48:51], v[8:11]
    ds_read_b128 v[40:43], v56 offset:0
    ds_read_b128 v[44:47], v56 offset:2048
    v_mfma_f32_16x16x32_bf16 v[16:19], v[32:35], v[52:55], v[16:19]
    ds_read_b64_tr_b16 v[24:25], v68 offset:0
    ds_read_b64_tr_b16 v[26:27], v68 offset:512
    v_mfma_f32_16x16x32_bf16 v[12:15], v[36:39], v[48:51], v[12:15]
    ds_read_b64_tr_b16 v[28:29], v69 offset:0
    ds_read_b64_tr_b16 v[30:31], v69 offset:512
    v_mfma_f32_16x16x32_bf16 v[20:23], v[36:39], v[52:55], v[20:23]
    s_add_u32 m0, s40, 122880
    s_lshl_b32 s42, s57, 7
    s_mul_i32 s43, s57, 131072
    buffer_load_dwordx4 v80, s[12:15], s42 offen offset:0 lds
    buffer_load_dwordx4 v81, s[12:15], s42 offen offset:1024 lds
    s_add_u32 s57, s57, 1
    s_cmp_eq_u32 s57, 56
    s_cselect_b32 s57, 0, s57
    s_add_u32 m0, s41, 122880
    s_nop 0
    buffer_load_dwordx4 v82, s[8:11], s43 offen offset:0 lds
    s_waitcnt lgkmcnt(0)
    v_mfma_f32_16x16x32_bf16 v[8:11], v[24:27], v[40:43], v[8:11]
    ds_read_b128 v[48:51], v57 offset:0
    ds_read_b128 v[52:55], v57 offset:2048
    v_mfma_f32_16x16x32_bf16 v[16:19], v[24:27], v[44:47], v[16:19]
    ds_read_b64_tr_b16 v[32:33], v68 offset:4096
    ds_read_b64_tr_b16 v[34:35], v68 offset:4608
    v_mfma_f32_16x16x32_bf16 v[12:15], v[28:31], v[40:43], v[12:15]
    ds_read_b64_tr_b16 v[36:37], v69 offset:4096
    ds_read_b64_tr_b16 v[38:39], v69 offset:4608
    v_mfma_f32_16x16x32_bf16 v[20:23], v[28:31], v[44:47], v[20:23]
    s_waitcnt vmcnt(12) lgkmcnt(0)
    s_barrier
    v_mfma_f32_16x16x32_bf16 v[8:11], v[32:35], v[48:51], v[8:11]
    ds_read_b128 v[40:43], v58 offset:0
    ds_read_b128 v[44:47], v58 offset:2048
    v_mfma_f32_16x16x32_bf16 v[16:19], v[32:35], v[52:55], v[16:19]
    ds_read_b64_tr_b16 v[24:25], v70 offset:0
    ds_read_b64_tr_b16 v[26:27], v70 offset:512
    v_mfma_f32_16x16x32_bf16 v[12:15], v[36:39], v[48:51], v[12:15]
    ds_read_b64_tr_b16 v[28:29], v71 offset:0
    ds_read_b64_tr_b16 v[30:31], v71 offset:512
    v_mfma_f32_16x16x32_bf16 v[20:23], v[36:39], v[52:55], v[20:23]
    s_add_u32 m0, s40, 0
    s_lshl_b32 s42, s57, 7
    s_mul_i32 s43, s57, 131072
    buffer_load_dwordx4 v80, s[12:15], s42 offen offset:0 lds
    buffer_load_dwordx4 v81, s[12:15], s42 offen offset:1024 lds
    s_add_u32 s57, s57, 1
    s_cmp_eq_u32 s57, 56
    s_cselect_b32 s57, 0, s57
    s_add_u32 m0, s41, 0
    s_nop 0
    buffer_load_dwordx4 v82, s[8:11], s43 offen offset:0 lds
    s_waitcnt lgkmcnt(0)
    v_mfma_f32_16x16x32_bf16 v[8:11], v[24:27], v[40:43], v[8:11]
    ds_read_b128 v[48:51], v59 offset:0
    ds_read_b128 v[52:55], v59 offset:2048
    v_mfma_f32_16x16x32_bf16 v[16:19], v[24:27], v[44:47], v[16:19]
    ds_read_b64_tr_b16 v[32:33], v70 offset:4096
    ds_read_b64_tr_b16 v[34:35], v70 offset:4608
    v_mfma_f32_16x16x32_bf16 v[12:15], v[28:31], v[40:43], v[12:15]
    ds_read_b64_tr_b16 v[36:37], v71 offset:4096
    ds_read_b64_tr_b16 v[38:39], v71 offset:4608
    v_mfma_f32_16x16x32_bf16 v[20:23], v[28:31], v[44:47], v[20:23]
    s_waitcnt vmcnt(12) lgkmcnt(0)
    s_barrier
    v_mfma_f32_16x16x32_bf16 v[8:11], v[32:35], v[48:51], v[8:11]
    ds_read_b128 v[40:43], v60 offset:0
    ds_read_b128 v[44:47], v60 offset:2048
    v_mfma_f32_16x16x32_bf16 v[16:19], v[32:35], v[52:55], v[16:19]
    ds_read_b64_tr_b16 v[24:25], v72 offset:0
    ds_read_b64_tr_b16 v[26:27], v72 offset:512
    v_mfma_f32_16x16x32_bf16 v[12:15], v[36:39], v[48:51], v[12:15]
    ds_read_b64_tr_b16 v[28:29], v73 offset:0
    ds_read_b64_tr_b16 v[30:31], v73 offset:512
    v_mfma_f32_16x16x32_bf16 v[20:23], v[36:39], v[52:55], v[20:23]
    s_add_u32 m0, s40, 24576
    s_lshl_b32 s42, s57, 7
    s_mul_i32 s43, s57, 131072
    buffer_load_dwordx4 v80, s[12:15], s42 offen offset:0 lds
    buffer_load_dwordx4 v81, s[12:15], s42 offen offset:1024 lds
    s_add_u32 s57, s57, 1
    s_cmp_eq_u32 s57, 56
    s_cselect_b32 s57, 0, s57
    s_add_u32 m0, s41, 24576
    s_nop 0
    buffer_load_dwordx4 v82, s[8:11], s43 offen offset:0 lds
    s_waitcnt lgkmcnt(0)
    v_mfma_f32_16x16x32_bf16 v[8:11], v[24:27], v[40:43], v[8:11]
    ds_read_b128 v[48:51], v61 offset:0
    ds_read_b128 v[52:55], v61 offset:2048
    v_mfma_f32_16x16x32_bf16 v[16:19], v[24:27], v[44:47], v[16:19]
    ds_read_b64_tr_b16 v[32:33], v72 offset:4096
    ds_read_b64_tr_b16 v[34:35], v72 offset:4608
    v_mfma_f32_16x16x32_bf16 v[12:15], v[28:31], v[40:43], v[12:15]
    ds_read_b64_tr_b16 v[36:37], v73 offset:4096
    ds_read_b64_tr_b16 v[38:39], v73 offset:4608
    v_mfma_f32_16x16x32_bf16 v[20:23], v[28:31], v[44:47], v[20:23]
    s_waitcnt vmcnt(12) lgkmcnt(0)
    s_barrier
    v_mfma_f32_16x16x32_bf16 v[8:11], v[32:35], v[48:51], v[8:11]
    ds_read_b128 v[40:43], v62 offset:0
    ds_read_b128 v[44:47], v62 offset:2048
    v_mfma_f32_16x16x32_bf16 v[16:19], v[32:35], v[52:55], v[16:19]
    ds_read_b64_tr_b16 v[24:25], v74 offset:0
    ds_read_b64_tr_b16 v[26:27], v74 offset:512
    v_mfma_f32_16x16x32_bf16 v[12:15], v[36:39], v[48:51], v[12:15]
    ds_read_b64_tr_b16 v[28:29], v75 offset:0
    ds_read_b64_tr_b16 v[30:31], v75 offset:512
    v_mfma_f32_16x16x32_bf16 v[20:23], v[36:39], v[52:55], v[20:23]
    s_add_u32 m0, s40, 49152
    s_lshl_b32 s42, s57, 7
    s_mul_i32 s43, s57, 131072
    buffer_load_dwordx4 v80, s[12:15], s42 offen offset:0 lds
    buffer_load_dwordx4 v81, s[12:15], s42 offen offset:1024 lds
    s_add_u32 s57, s57, 1
    s_cmp_eq_u32 s57, 56
    s_cselect_b32 s57, 0, s57
    s_add_u32 m0, s41, 49152
    s_nop 0
    buffer_load_dwordx4 v82, s[8:11], s43 offen offset:0 lds
    s_waitcnt lgkmcnt(0)
    v_mfma_f32_16x16x32_bf16 v[8:11], v[24:27], v[40:43], v[8:11]
    ds_read_b128 v[48:51], v63 offset:0
    ds_read_b128 v[52:55], v63 offset:2048
    v_mfma_f32_16x16x32_bf16 v[16:19], v[24:27], v[44:47], v[16:19]
    ds_read_b64_tr_b16 v[32:33], v74 offset:4096
    ds_read_b64_tr_b16 v[34:35], v74 offset:4608
    v_mfma_f32_16x16x32_bf16 v[12:15], v[28:31], v[40:43], v[12:15]
    ds_read_b64_tr_b16 v[36:37], v75 offset:4096
    ds_read_b64_tr_b16 v[38:39], v75 offset:4608
    v_mfma_f32_16x16x32_bf16 v[20:23], v[28:31], v[44:47], v[20:23]
    s_waitcnt vmcnt(12) lgkmcnt(0)
    s_barrier
    v_mfma_f32_16x16x32_bf16 v[8:11], v[32:35], v[48:51], v[8:11]
    ds_read_b128 v[40:43], v64 offset:0
    ds_read_b128 v[44:47], v64 offset:2048
    v_mfma_f32_16x16x32_bf16 v[16:19], v[32:35], v[52:55], v[16:19]
    ds_read_b64_tr_b16 v[24:25], v76 offset:0
    ds_read_b64_tr_b16 v[26:27], v76 offset:512
    v_mfma_f32_16x16x32_bf16 v[12:15], v[36:39], v[48:51], v[12:15]
    ds_read_b64_tr_b16 v[28:29], v77 offset:0
    ds_read_b64_tr_b16 v[30:31], v77 offset:512
    v_mfma_f32_16x16x32_bf16 v[20:23], v[36:39], v[52:55], v[20:23]
    s_add_u32 m0, s40, 73728
    s_lshl_b32 s42, s57, 7
    s_mul_i32 s43, s57, 131072
    buffer_load_dwordx4 v80, s[12:15], s42 offen offset:0 lds
    buffer_load_dwordx4 v81, s[12:15], s42 offen offset:1024 lds
    s_add_u32 s57, s57, 1
    s_cmp_eq_u32 s57, 56
    s_cselect_b32 s57, 0, s57
    s_add_u32 m0, s41, 73728
    s_nop 0
    buffer_load_dwordx4 v82, s[8:11], s43 offen offset:0 lds
    s_waitcnt lgkmcnt(0)
    v_mfma_f32_16x16x32_bf16 v[8:11], v[24:27], v[40:43], v[8:11]
    ds_read_b128 v[48:51], v65 offset:0
    ds_read_b128 v[52:55], v65 offset:2048
    v_mfma_f32_16x16x32_bf16 v[16:19], v[24:27], v[44:47], v[16:19]
    ds_read_b64_tr_b16 v[32:33], v76 offset:4096
    ds_read_b64_tr_b16 v[34:35], v76 offset:4608
    v_mfma_f32_16x16x32_bf16 v[12:15], v[28:31], v[40:43], v[12:15]
    ds_read_b64_tr_b16 v[36:37], v77 offset:4096
    ds_read_b64_tr_b16 v[38:39], v77 offset:4608
    v_mfma_f32_16x16x32_bf16 v[20:23], v[28:31], v[44:47], v[20:23]
    s_waitcnt vmcnt(12) lgkmcnt(0)
    s_barrier
    v_mfma_f32_16x16x32_bf16 v[8:11], v[32:35], v[48:51], v[8:11]
    ds_read_b128 v[40:43], v66 offset:0
    ds_read_b128 v[44:47], v66 offset:2048
    v_mfma_f32_16x16x32_bf16 v[16:19], v[32:35], v[52:55], v[16:19]
    ds_read_b64_tr_b16 v[24:25], v78 offset:0
    ds_read_b64_tr_b16 v[26:27], v78 offset:512
    v_mfma_f32_16x16x32_bf16 v[12:15], v[36:39], v[48:51], v[12:15]
    ds_read_b64_tr_b16 v[28:29], v79 offset:0
    ds_read_b64_tr_b16 v[30:31], v79 offset:512
    v_mfma_f32_16x16x32_bf16 v[20:23], v[36:39], v[52:55], v[20:23]
    s_add_u32 m0, s40, 98304
    s_lshl_b32 s42, s57, 7
    s_mul_i32 s43, s57, 131072
    buffer_load_dwordx4 v80, s[12:15], s42 offen offset:0 lds
    buffer_load_dwordx4 v81, s[12:15], s42 offen offset:1024 lds
    s_add_u32 s57, s57, 1
    s_cmp_eq_u32 s57, 56
    s_cselect_b32 s57, 0, s57
    s_add_u32 m0, s41, 98304
    s_nop 0
    buffer_load_dwordx4 v82, s[8:11], s43 offen offset:0 lds
    s_waitcnt lgkmcnt(0)
    v_mfma_f32_16x16x32_bf16 v[8:11], v[24:27], v[40:43], v[8:11]
    ds_read_b128 v[48:51], v67 offset:0
    ds_read_b128 v[52:55], v67 offset:2048
    v_mfma_f32_16x16x32_bf16 v[16:19], v[24:27], v[44:47], v[16:19]
    ds_read_b64_tr_b16 v[32:33], v78 offset:4096
    ds_read_b64_tr_b16 v[34:35], v78 offset:4608
    v_mfma_f32_16x16x32_bf16 v[12:15], v[28:31], v[40:43], v[12:15]
    ds_read_b64_tr_b16 v[36:37], v79 offset:4096
    ds_read_b64_tr_b16 v[38:39], v79 offset:4608
    v_mfma_f32_16x16x32_bf16 v[20:23], v[28:31], v[44:47], v[20:23]
    s_waitcnt vmcnt(12) lgkmcnt(0)
    s_barrier
    v_mfma_f32_16x16x32_bf16 v[8:11], v[32:35], v[48:51], v[8:11]
    ds_read_b128 v[40:43], v56 offset:0
    ds_read_b128 v[44:47], v56 offset:2048
    v_mfma_f32_16x16x32_bf16 v[16:19], v[32:35], v[52:55], v[16:19]
    ds_read_b64_tr_b16 v[24:25], v68 offset:0
    ds_read_b64_tr_b16 v[26:27], v68 offset:512
    v_mfma_f32_16x16x32_bf16 v[12:15], v[36:39], v[48:51], v[12:15]
    ds_read_b64_tr_b16 v[28:29], v69 offset:0
    ds_read_b64_tr_b16 v[30:31], v69 offset:512
    v_mfma_f32_16x16x32_bf16 v[20:23], v[36:39], v[52:55], v[20:23]
    s_add_u32 m0, s40, 122880
    s_lshl_b32 s42, s57, 7
    s_mul_i32 s43, s57, 131072
    buffer_load_dwordx4 v80, s[12:15], s42 offen offset:0 lds
    buffer_load_dwordx4 v81, s[12:15], s42 offen offset:1024 lds
    s_add_u32 s57, s57, 1
    s_cmp_eq_u32 s57, 56
    s_cselect_b32 s57, 0, s57
    s_add_u32 m0, s41, 122880
    s_nop 0
    buffer_load_dwordx4 v82, s[8:11], s43 offen offset:0 lds
    s_waitcnt lgkmcnt(0)
    v_mfma_f32_16x16x32_bf16 v[8:11], v[24:27], v[40:43], v[8:11]
    ds_read_b128 v[48:51], v57 offset:0
    ds_read_b128 v[52:55], v57 offset:2048
    v_mfma_f32_16x16x32_bf16 v[16:19], v[24:27], v[44:47], v[16:19]
    ds_read_b64_tr_b16 v[32:33], v68 offset:4096
    ds_read_b64_tr_b16 v[34:35], v68 offset:4608
    v_mfma_f32_16x16x32_bf16 v[12:15], v[28:31], v[40:43], v[12:15]
    ds_read_b64_tr_b16 v[36:37], v69 offset:4096
    ds_read_b64_tr_b16 v[38:39], v69 offset:4608
    v_mfma_f32_16x16x32_bf16 v[20:23], v[28:31], v[44:47], v[20:23]
    s_waitcnt vmcnt(12) lgkmcnt(0)
    s_barrier
    v_mfma_f32_16x16x32_bf16 v[8:11], v[32:35], v[48:51], v[8:11]
    ds_read_b128 v[40:43], v58 offset:0
    ds_read_b128 v[44:47], v58 offset:2048
    v_mfma_f32_16x16x32_bf16 v[16:19], v[32:35], v[52:55], v[16:19]
    ds_read_b64_tr_b16 v[24:25], v70 offset:0
    ds_read_b64_tr_b16 v[26:27], v70 offset:512
    v_mfma_f32_16x16x32_bf16 v[12:15], v[36:39], v[48:51], v[12:15]
    ds_read_b64_tr_b16 v[28:29], v71 offset:0
    ds_read_b64_tr_b16 v[30:31], v71 offset:512
    v_mfma_f32_16x16x32_bf16 v[20:23], v[36:39], v[52:55], v[20:23]
    s_add_u32 m0, s40, 0
    s_lshl_b32 s42, s57, 7
    s_mul_i32 s43, s57, 131072
    buffer_load_dwordx4 v80, s[12:15], s42 offen offset:0 lds
    buffer_load_dwordx4 v81, s[12:15], s42 offen offset:1024 lds
    s_add_u32 s57, s57, 1
    s_cmp_eq_u32 s57, 56
    s_cselect_b32 s57, 0, s57
    s_add_u32 m0, s41, 0
    s_nop 0
    buffer_load_dwordx4 v82, s[8:11], s43 offen offset:0 lds
    s_waitcnt lgkmcnt(0)
    v_mfma_f32_16x16x32_bf16 v[8:11], v[24:27], v[40:43], v[8:11]
    ds_read_b128 v[48:51], v59 offset:0
    ds_read_b128 v[52:55], v59 offset:2048
    v_mfma_f32_16x16x32_bf16 v[16:19], v[24:27], v[44:47], v[16:19]
    ds_read_b64_tr_b16 v[32:33], v70 offset:4096
    ds_read_b64_tr_b16 v[34:35], v70 offset:4608
    v_mfma_f32_16x16x32_bf16 v[12:15], v[28:31], v[40:43], v[12:15]
    ds_read_b64_tr_b16 v[36:37], v71 offset:4096
    ds_read_b64_tr_b16 v[38:39], v71 offset:4608
    v_mfma_f32_16x16x32_bf16 v[20:23], v[28:31], v[44:47], v[20:23]
    s_waitcnt vmcnt(12) lgkmcnt(0)
    s_barrier
    v_mfma_f32_16x16x32_bf16 v[8:11], v[32:35], v[48:51], v[8:11]
    ds_read_b128 v[40:43], v60 offset:0
    ds_read_b128 v[44:47], v60 offset:2048
    v_mfma_f32_16x16x32_bf16 v[16:19], v[32:35], v[52:55], v[16:19]
    ds_read_b64_tr_b16 v[24:25], v72 offset:0
    ds_read_b64_tr_b16 v[26:27], v72 offset:512
    v_mfma_f32_16x16x32_bf16 v[12:15], v[36:39], v[48:51], v[12:15]
    ds_read_b64_tr_b16 v[28:29], v73 offset:0
    ds_read_b64_tr_b16 v[30:31], v73 offset:512
    v_mfma_f32_16x16x32_bf16 v[20:23], v[36:39], v[52:55], v[20:23]
    s_add_u32 m0, s40, 24576
    s_lshl_b32 s42, s57, 7
    s_mul_i32 s43, s57, 131072
    buffer_load_dwordx4 v80, s[12:15], s42 offen offset:0 lds
    buffer_load_dwordx4 v81, s[12:15], s42 offen offset:1024 lds
    s_add_u32 s57, s57, 1
    s_cmp_eq_u32 s57, 56
    s_cselect_b32 s57, 0, s57
    s_add_u32 m0, s41, 24576
    s_nop 0
    buffer_load_dwordx4 v82, s[8:11], s43 offen offset:0 lds
    s_waitcnt lgkmcnt(0)
    v_mfma_f32_16x16x32_bf16 v[8:11], v[24:27], v[40:43], v[8:11]
    ds_read_b128 v[48:51], v61 offset:0
    ds_read_b128 v[52:55], v61 offset:2048
    v_mfma_f32_16x16x32_bf16 v[16:19], v[24:27], v[44:47], v[16:19]
    ds_read_b64_tr_b16 v[32:33], v72 offset:4096
    ds_read_b64_tr_b16 v[34:35], v72 offset:4608
    v_mfma_f32_16x16x32_bf16 v[12:15], v[28:31], v[40:43], v[12:15]
    ds_read_b64_tr_b16 v[36:37], v73 offset:4096
    ds_read_b64_tr_b16 v[38:39], v73 offset:4608
    v_mfma_f32_16x16x32_bf16 v[20:23], v[28:31], v[44:47], v[20:23]
    s_waitcnt vmcnt(12) lgkmcnt(0)
    s_barrier
    v_mfma_f32_16x16x32_bf16 v[8:11], v[32:35], v[48:51], v[8:11]
    ds_read_b128 v[40:43], v62 offset:0
    ds_read_b128 v[44:47], v62 offset:2048
    v_mfma_f32_16x16x32_bf16 v[16:19], v[32:35], v[52:55], v[16:19]
    ds_read_b64_tr_b16 v[24:25], v74 offset:0
    ds_read_b64_tr_b16 v[26:27], v74 offset:512
    v_mfma_f32_16x16x32_bf16 v[12:15], v[36:39], v[48:51], v[12:15]
    ds_read_b64_tr_b16 v[28:29], v75 offset:0
    ds_read_b64_tr_b16 v[30:31], v75 offset:512
    v_mfma_f32_16x16x32_bf16 v[20:23], v[36:39], v[52:55], v[20:23]
    s_waitcnt lgkmcnt(0)
    v_mfma_f32_16x16x32_bf16 v[8:11], v[24:27], v[40:43], v[8:11]
    ds_read_b128 v[48:51], v63 offset:0
    ds_read_b128 v[52:55], v63 offset:2048
    v_mfma_f32_16x16x32_bf16 v[16:19], v[24:27], v[44:47], v[16:19]
    ds_read_b64_tr_b16 v[32:33], v74 offset:4096
    ds_read_b64_tr_b16 v[34:35], v74 offset:4608
    v_mfma_f32_16x16x32_bf16 v[12:15], v[28:31], v[40:43], v[12:15]
    ds_read_b64_tr_b16 v[36:37], v75 offset:4096
    ds_read_b64_tr_b16 v[38:39], v75 offset:4608
    v_mfma_f32_16x16x32_bf16 v[20:23], v[28:31], v[44:47], v[20:23]
    s_waitcnt vmcnt(9) lgkmcnt(0)
    s_barrier
    v_mfma_f32_16x16x32_bf16 v[8:11], v[32:35], v[48:51], v[8:11]
    ds_read_b128 v[40:43], v64 offset:0
    ds_read_b128 v[44:47], v64 offset:2048
    v_mfma_f32_16x16x32_bf16 v[16:19], v[32:35], v[52:55], v[16:19]
    ds_read_b64_tr_b16 v[24:25], v76 offset:0
    ds_read_b64_tr_b16 v[26:27], v76 offset:512
    v_mfma_f32_16x16x32_bf16 v[12:15], v[36:39], v[48:51], v[12:15]
    ds_read_b64_tr_b16 v[28:29], v77 offset:0
    ds_read_b64_tr_b16 v[30:31], v77 offset:512
    v_mfma_f32_16x16x32_bf16 v[20:23], v[36:39], v[52:55], v[20:23]
    s_waitcnt lgkmcnt(0)
    v_mfma_f32_16x16x32_bf16 v[8:11], v[24:27], v[40:43], v[8:11]
    ds_read_b128 v[48:51], v65 offset:0
    ds_read_b128 v[52:55], v65 offset:2048
    v_mfma_f32_16x16x32_bf16 v[16:19], v[24:27], v[44:47], v[16:19]
    ds_read_b64_tr_b16 v[32:33], v76 offset:4096
    ds_read_b64_tr_b16 v[34:35], v76 offset:4608
    v_mfma_f32_16x16x32_bf16 v[12:15], v[28:31], v[40:43], v[12:15]
    ds_read_b64_tr_b16 v[36:37], v77 offset:4096
    ds_read_b64_tr_b16 v[38:39], v77 offset:4608
    v_mfma_f32_16x16x32_bf16 v[20:23], v[28:31], v[44:47], v[20:23]
    s_waitcnt vmcnt(6) lgkmcnt(0)
    s_barrier
    v_mfma_f32_16x16x32_bf16 v[8:11], v[32:35], v[48:51], v[8:11]
    ds_read_b128 v[40:43], v66 offset:0
    ds_read_b128 v[44:47], v66 offset:2048
    v_mfma_f32_16x16x32_bf16 v[16:19], v[32:35], v[52:55], v[16:19]
    ds_read_b64_tr_b16 v[24:25], v78 offset:0
    ds_read_b64_tr_b16 v[26:27], v78 offset:512
    v_mfma_f32_16x16x32_bf16 v[12:15], v[36:39], v[48:51], v[12:15]
    ds_read_b64_tr_b16 v[28:29], v79 offset:0
    ds_read_b64_tr_b16 v[30:31], v79 offset:512
    v_mfma_f32_16x16x32_bf16 v[20:23], v[36:39], v[52:55], v[20:23]
    s_waitcnt lgkmcnt(0)
    v_mfma_f32_16x16x32_bf16 v[8:11], v[24:27], v[40:43], v[8:11]
    ds_read_b128 v[48:51], v67 offset:0
    ds_read_b128 v[52:55], v67 offset:2048
    v_mfma_f32_16x16x32_bf16 v[16:19], v[24:27], v[44:47], v[16:19]
    ds_read_b64_tr_b16 v[32:33], v78 offset:4096
    ds_read_b64_tr_b16 v[34:35], v78 offset:4608
    v_mfma_f32_16x16x32_bf16 v[12:15], v[28:31], v[40:43], v[12:15]
    ds_read_b64_tr_b16 v[36:37], v79 offset:4096
    ds_read_b64_tr_b16 v[38:39], v79 offset:4608
    v_mfma_f32_16x16x32_bf16 v[20:23], v[28:31], v[44:47], v[20:23]
    s_waitcnt vmcnt(3) lgkmcnt(0)
    s_barrier
    v_mfma_f32_16x16x32_bf16 v[8:11], v[32:35], v[48:51], v[8:11]
    ds_read_b128 v[40:43], v56 offset:0
    ds_read_b128 v[44:47], v56 offset:2048
    v_mfma_f32_16x16x32_bf16 v[16:19], v[32:35], v[52:55], v[16:19]
    ds_read_b64_tr_b16 v[24:25], v68 offset:0
    ds_read_b64_tr_b16 v[26:27], v68 offset:512
    v_mfma_f32_16x16x32_bf16 v[12:15], v[36:39], v[48:51], v[12:15]
    ds_read_b64_tr_b16 v[28:29], v69 offset:0
    ds_read_b64_tr_b16 v[30:31], v69 offset:512
    v_mfma_f32_16x16x32_bf16 v[20:23], v[36:39], v[52:55], v[20:23]
    s_waitcnt lgkmcnt(0)
    v_mfma_f32_16x16x32_bf16 v[8:11], v[24:27], v[40:43], v[8:11]
    ds_read_b128 v[48:51], v57 offset:0
    ds_read_b128 v[52:55], v57 offset:2048
    v_mfma_f32_16x16x32_bf16 v[16:19], v[24:27], v[44:47], v[16:19]
    ds_read_b64_tr_b16 v[32:33], v68 offset:4096
    ds_read_b64_tr_b16 v[34:35], v68 offset:4608
    v_mfma_f32_16x16x32_bf16 v[12:15], v[28:31], v[40:43], v[12:15]
    ds_read_b64_tr_b16 v[36:37], v69 offset:4096
    ds_read_b64_tr_b16 v[38:39], v69 offset:4608
    v_mfma_f32_16x16x32_bf16 v[20:23], v[28:31], v[44:47], v[20:23]
    s_waitcnt vmcnt(0) lgkmcnt(0)
    s_barrier
    v_mfma_f32_16x16x32_bf16 v[8:11], v[32:35], v[48:51], v[8:11]
    ds_read_b128 v[40:43], v58 offset:0
    ds_read_b128 v[44:47], v58 offset:2048
    v_mfma_f32_16x16x32_bf16 v[16:19], v[32:35], v[52:55], v[16:19]
    ds_read_b64_tr_b16 v[24:25], v70 offset:0
    ds_read_b64_tr_b16 v[26:27], v70 offset:512
    v_mfma_f32_16x16x32_bf16 v[12:15], v[36:39], v[48:51], v[12:15]
    ds_read_b64_tr_b16 v[28:29], v71 offset:0
    ds_read_b64_tr_b16 v[30:31], v71 offset:512
    v_mfma_f32_16x16x32_bf16 v[20:23], v[36:39], v[52:55], v[20:23]
    s_waitcnt lgkmcnt(0)
    v_mfma_f32_16x16x32_bf16 v[8:11], v[24:27], v[40:43], v[8:11]
    ds_read_b128 v[48:51], v59 offset:0
    ds_read_b128 v[52:55], v59 offset:2048
    v_mfma_f32_16x16x32_bf16 v[16:19], v[24:27], v[44:47], v[16:19]
    ds_read_b64_tr_b16 v[32:33], v70 offset:4096
    ds_read_b64_tr_b16 v[34:35], v70 offset:4608
    v_mfma_f32_16x16x32_bf16 v[12:15], v[28:31], v[40:43], v[12:15]
    ds_read_b64_tr_b16 v[36:37], v71 offset:4096
    ds_read_b64_tr_b16 v[38:39], v71 offset:4608
    v_mfma_f32_16x16x32_bf16 v[20:23], v[28:31], v[44:47], v[20:23]
    s_waitcnt lgkmcnt(0)
    v_mfma_f32_16x16x32_bf16 v[8:11], v[32:35], v[48:51], v[8:11]
    v_mfma_f32_16x16x32_bf16 v[16:19], v[32:35], v[52:55], v[16:19]
    v_mfma_f32_16x16x32_bf16 v[12:15], v[36:39], v[48:51], v[12:15]
    v_mfma_f32_16x16x32_bf16 v[20:23], v[36:39], v[52:55], v[20:23]
    v_and_b32 v5, 3, v2
    v_mul_u32_u24 v5, 32, v5
    v_add_u32 v5, v5, v3
    v_add_u32 v5, s33, v5
    s_mov_b32 s36, 2048
    v_mul_lo_u32 v5, v5, s36
    v_lshrrev_b32 v6, 2, v2
    v_mul_u32_u24 v6, 32, v6
    v_lshl_add_u32 v6, v4, 2, v6
    v_add_u32 v6, s34, v6
    v_lshlrev_b32 v6, 1, v6
    v_add_u32 v5, v5, v6
    s_mov_b32 s43, 0
    buffer_load_dwordx2 v[24:25], v5, s[20:23], s43 offen offset:0
    buffer_load_dwordx2 v[26:27], v5, s[20:23], s43 offen offset:32
    s_mov_b32 s43, 32768
    buffer_load_dwordx2 v[28:29], v5, s[20:23], s43 offen offset:0
    buffer_load_dwordx2 v[30:31], v5, s[20:23], s43 offen offset:32
    s_waitcnt vmcnt(0)
    v_cvt_pk_bf16_f32 v32, v8, v9
    v_lshlrev_b32 v8, 16, v32
    v_and_b32 v9, 0xffff0000, v32
    v_lshlrev_b32 v33, 16, v24
    v_and_b32 v34, 0xffff0000, v24
    v_add_f32 v8, v8, v33
    v_add_f32 v9, v9, v34
    v_cvt_pk_bf16_f32 v8, v8, v9
    v_cvt_pk_bf16_f32 v32, v10, v11
    v_lshlrev_b32 v10, 16, v32
    v_and_b32 v11, 0xffff0000, v32
    v_lshlrev_b32 v33, 16, v25
    v_and_b32 v34, 0xffff0000, v25
    v_add_f32 v10, v10, v33
    v_add_f32 v11, v11, v34
    v_cvt_pk_bf16_f32 v9, v10, v11
    s_mov_b32 s43, 0
    buffer_store_dwordx2 v[8:9], v5, s[24:27], s43 offen offset:0
    v_cvt_pk_bf16_f32 v32, v12, v13
    v_lshlrev_b32 v12, 16, v32
    v_and_b32 v13, 0xffff0000, v32
    v_lshlrev_b32 v33, 16, v26
    v_and_b32 v34, 0xffff0000, v26
    v_add_f32 v12, v12, v33
    v_add_f32 v13, v13, v34
    v_cvt_pk_bf16_f32 v12, v12, v13
    v_cvt_pk_bf16_f32 v32, v14, v15
    v_lshlrev_b32 v14, 16, v32
    v_and_b32 v15, 0xffff0000, v32
    v_lshlrev_b32 v33, 16, v27
    v_and_b32 v34, 0xffff0000, v27
    v_add_f32 v14, v14, v33
    v_add_f32 v15, v15, v34
    v_cvt_pk_bf16_f32 v13, v14, v15
    s_mov_b32 s43, 0
    buffer_store_dwordx2 v[12:13], v5, s[24:27], s43 offen offset:32
    v_cvt_pk_bf16_f32 v32, v16, v17
    v_lshlrev_b32 v16, 16, v32
    v_and_b32 v17, 0xffff0000, v32
    v_lshlrev_b32 v33, 16, v28
    v_and_b32 v34, 0xffff0000, v28
    v_add_f32 v16, v16, v33
    v_add_f32 v17, v17, v34
    v_cvt_pk_bf16_f32 v16, v16, v17
    v_cvt_pk_bf16_f32 v32, v18, v19
    v_lshlrev_b32 v18, 16, v32
    v_and_b32 v19, 0xffff0000, v32
    v_lshlrev_b32 v33, 16, v29
    v_and_b32 v34, 0xffff0000, v29
    v_add_f32 v18, v18, v33
    v_add_f32 v19, v19, v34
    v_cvt_pk_bf16_f32 v17, v18, v19
    s_mov_b32 s43, 32768
    buffer_store_dwordx2 v[16:17], v5, s[24:27], s43 offen offset:0
    v_cvt_pk_bf16_f32 v32, v20, v21
    v_lshlrev_b32 v20, 16, v32
    v_and_b32 v21, 0xffff0000, v32
    v_lshlrev_b32 v33, 16, v30
    v_and_b32 v34, 0xffff0000, v30
    v_add_f32 v20, v20, v33
    v_add_f32 v21, v21, v34
    v_cvt_pk_bf16_f32 v20, v20, v21
    v_cvt_pk_bf16_f32 v32, v22, v23
    v_lshlrev_b32 v22, 16, v32
    v_and_b32 v23, 0xffff0000, v32
    v_lshlrev_b32 v33, 16, v31
    v_and_b32 v34, 0xffff0000, v31
    v_add_f32 v22, v22, v33
    v_add_f32 v23, v23, v34
    v_cvt_pk_bf16_f32 v21, v22, v23
    s_mov_b32 s43, 32768
    buffer_store_dwordx2 v[20:21], v5, s[24:27], s43 offen offset:32
gemm2_kernel_end:
    s_endpgm
.section .rodata,"a"
.p2align 6
.amdhsa_kernel fft_a_kernel
  .amdhsa_next_free_vgpr 120
  .amdhsa_next_free_sgpr 68
  .amdhsa_accum_offset 120
  .amdhsa_group_segment_fixed_size 0
  .amdhsa_kernarg_size 80
  .amdhsa_user_sgpr_count 2
  .amdhsa_user_sgpr_kernarg_segment_ptr 1
  .amdhsa_system_sgpr_workgroup_id_x 1
  .amdhsa_float_denorm_mode_32 3
.end_amdhsa_kernel
.p2align 6
.amdhsa_kernel fft_b_kernel
  .amdhsa_next_free_vgpr 64
  .amdhsa_next_free_sgpr 68
  .amdhsa_accum_offset 64
  .amdhsa_group_segment_fixed_size 0
  .amdhsa_kernarg_size 80
  .amdhsa_user_sgpr_count 2
  .amdhsa_user_sgpr_kernarg_segment_ptr 1
  .amdhsa_system_sgpr_workgroup_id_x 1
  .amdhsa_float_denorm_mode_32 3
.end_amdhsa_kernel
.p2align 6
.amdhsa_kernel fft_c_kernel
  .amdhsa_next_free_vgpr 152
  .amdhsa_next_free_sgpr 61
  .amdhsa_accum_offset 152
  .amdhsa_group_segment_fixed_size 0
  .amdhsa_kernarg_size 80
  .amdhsa_user_sgpr_count 2
  .amdhsa_user_sgpr_kernarg_segment_ptr 1
  .amdhsa_system_sgpr_workgroup_id_x 1
  .amdhsa_float_denorm_mode_32 3
.end_amdhsa_kernel
.p2align 6
.amdhsa_kernel gemm1_kernel
  .amdhsa_next_free_vgpr 171
  .amdhsa_next_free_sgpr 58
  .amdhsa_accum_offset 172
  .amdhsa_group_segment_fixed_size 0
  .amdhsa_kernarg_size 80
  .amdhsa_user_sgpr_count 2
  .amdhsa_user_sgpr_kernarg_segment_ptr 1
  .amdhsa_system_sgpr_workgroup_id_x 1
  .amdhsa_float_denorm_mode_32 3
.end_amdhsa_kernel
.p2align 6
.amdhsa_kernel gemm2_kernel
  .amdhsa_next_free_vgpr 85
  .amdhsa_next_free_sgpr 58
  .amdhsa_accum_offset 88
  .amdhsa_group_segment_fixed_size 0
  .amdhsa_kernarg_size 80
  .amdhsa_user_sgpr_count 2
  .amdhsa_user_sgpr_kernarg_segment_ptr 1
  .amdhsa_system_sgpr_workgroup_id_x 1
  .amdhsa_float_denorm_mode_32 3
.end_amdhsa_kernel
```
